```python
import torch

def _softmax(x, axis=-1):
    return torch.softmax(x, dim=axis)
def _gelu(x):
    return torch.nn.functional.gelu(x, approximate="tanh")
def _silu(x):
    return torch.nn.functional.silu(x)
def _sigmoid(x):
    return torch.sigmoid(x)
def _layernorm(x, axis=-1, eps=1e-5):
    m = x.mean(dim=axis, keepdim=True)
    v = x.var(dim=axis, keepdim=True, unbiased=False)
    return (x - m) / torch.sqrt(v + eps)
def _scatter_add(tgt, idx, src, axis=0):
    return tgt.clone().index_add_(axis, idx, src)
def _segment_sum(src, seg, n):
    out = torch.zeros((n,) + src.shape[1:], dtype=src.dtype)
    return out.index_add_(0, seg, src)
def _pad(x, pw):
    flat = tuple(v for pair in reversed(pw) for v in pair)
    return torch.nn.functional.pad(x, flat)

kernel_name = 'gated_mix__ssm_conv_h3__softmax_full_mha__prompt'

def setup_inputs():

    _w = (lambda a: (lambda t: t.to(torch.bfloat16) if t.is_floating_point() else t)(torch.as_tensor(a)))
    def _A_setup():
        B, S, D = 1, 2048, 512
        ks = 4
        return {
            "q": _w((lambda *s: torch.randn(*s, dtype=torch.bfloat16) * 0.05)(B, S, D)),
            "k": _w((lambda *s: torch.randn(*s, dtype=torch.bfloat16) * 0.4)(B, S, D)),
            "v": _w((lambda *s: torch.randn(*s, dtype=torch.bfloat16) * 0.4)(B, S, D)),
            "shift_k": _w((lambda *s: torch.randn(*s, dtype=torch.bfloat16) * 0.4)(D, ks) * 0.5),
            "ssm_k": _w((lambda *s: torch.randn(*s, dtype=torch.bfloat16) * 1.6)(D, S) * (1.0 / S ** 0.5)),
            "ssm_D": _w((lambda *s: torch.randn(*s, dtype=torch.bfloat16) * 0.4)(D)),
        }
    _A_in = _A_setup()

    def _B_setup():
        B, S, D = 1, 2048, 512
        return {
            "x": _w((lambda *s: torch.randn(*s, dtype=torch.bfloat16) * 0.05)(B, S, D)),
            "wqkv": _w((lambda *s: torch.randn(*s, dtype=torch.bfloat16) * 0.8)(D, 3 * D)),
            "wo": _w((lambda *s: torch.randn(*s, dtype=torch.bfloat16) * 0.05)(D, D)),
        }
    _B_in = _B_setup()

    return {
        "A_q": _A_in["q"],
        "A_k": _A_in["k"],
        "A_v": _A_in["v"],
        "A_shift_k": _A_in["shift_k"],
        "A_ssm_k": _A_in["ssm_k"],
        "A_ssm_D": _A_in["ssm_D"],
        "B_x": _B_in["x"],
        "B_wqkv": _B_in["wqkv"],
        "B_wo": _B_in["wo"],
        "gate_w": _w((lambda *s: torch.randn(*s, dtype=torch.bfloat16) * 0.05)(512) * 16.0),
    }

def reference(A_q, A_k, A_v, A_shift_k, A_ssm_k, A_ssm_D, B_x, B_wqkv, B_wo, gate_w):
    def _A_ref(q, k, v, shift_k, ssm_k, ssm_D):
        B, S, D = q.shape
        ks = shift_k.shape[-1]
        k_pad = _pad(k, ((0, 0), (ks - 1, 0), (0, 0)))
        k_shift = torch.zeros_like(k)
        for t in range(ks):
            k_shift = k_shift + k_pad[:, t:t + S, :] * shift_k[:, ks - 1 - t][None, None, :]
        kv = k_shift * v
        L = 2 * S
        kv_pad = _pad(kv, ((0, 0), (0, S), (0, 0)))
        kf_pad = _pad(ssm_k, ((0, 0), (0, S)))
        kv_f = (lambda x, axes=(-2,-1): torch.fft.rfft2(x.float(), dim=axes))(kv_pad[:, None, :, :], axes=(1, 2))
        kf_f = (lambda x, axes=(-2,-1): torch.fft.rfft2(x.float(), dim=axes))(kf_pad[:, None, :], axes=(1, 2))
        kf_f = (lambda x, *d: x.permute(*d))(kf_f, 1, 2, 0)
        y_f = kv_f * kf_f[None, :, :, :]
        y = (lambda x, s, axes=(-2,-1): torch.fft.irfft2(x, s=s, dim=axes).to(torch.bfloat16))(y_f, (1, L), axes=(1, 2))[:, 0, :S, :]
        y = y + kv * ssm_D[None, None, :]
        return q * y

    def _B_ref(x, wqkv, wo):
        B, S, D = x.shape
        H = 32; Dh = D // H
        qkv = (lambda x, *d: x.permute(*d))((x @ wqkv).reshape(B, S, 3, H, Dh), 2, 0, 3, 1, 4)
        q, k, v = qkv[0], qkv[1], qkv[2]
        scale = Dh ** -0.5
        scores = torch.einsum("bhqd,bhkd->bhqk", q, k) * scale
        p = _softmax(scores, axis=-1)
        o = torch.einsum("bhqk,bhkd->bhqd", p, v)
        return (lambda x, *d: x.permute(*d))(o, 0, 2, 1, 3).reshape(B, S, D) @ wo

    x = A_q
    g = _sigmoid((x * gate_w).sum(-1, keepdims=True))
    a = _A_ref(x, A_k, A_v, A_shift_k, A_ssm_k, A_ssm_D)
    b = _B_ref(x, B_wqkv, B_wo)
    return g * a + (1 - g) * b
```

```asm
; @launch kernel=proj_kernel grid=(256,1,1) block=(512,1,1) lds=131072
; @launch kernel=attn_kernel grid=(256,1,1) block=(768,1,1) lds=162048
; @launch kernel=outp_kernel grid=(256,1,1) block=(256,1,1) lds=131072
.amdgcn_target "amdgcn-amd-amdhsa--gfx950"
.text
.globl proj_kernel
.p2align 8
.type proj_kernel,@function
proj_kernel:
    s_cmp_ge_u32 s2, 256
    s_cbranch_scc1 L_p_exit
    s_cmp_ge_u32 s2, 192
    s_cbranch_scc1 L_prep
    s_load_dwordx2 s[4:5], s[0:1], 0
    s_load_dwordx2 s[6:7], s[0:1], 56
    s_load_dwordx2 s[8:9], s[0:1], 96
    v_and_b32 v1, 63, v0
    v_lshrrev_b32 v2, 6, v0
    s_nop 0
    v_readfirstlane_b32 s26, v2
    s_and_b32 s27, s2, 7
    s_lshr_b32 s34, s2, 3
    s_mul_i32 s35, s34, 43
    s_lshr_b32 s35, s35, 8
    s_mul_i32 s25, s35, 6
    s_sub_u32 s25, s34, s25
    s_lshr_b32 s24, s27, 1
    s_lshl_b32 s24, s24, 2
    s_add_u32 s24, s24, s35
    s_and_b32 s27, s27, 1
    s_mul_i32 s27, s27, 6
    s_add_u32 s25, s25, s27
    s_lshr_b32 s32, s26, 2
    s_and_b32 s33, s26, 3
    v_lshrrev_b32 v2, 3, v1
    v_and_b32 v3, 7, v1
    v_lshrrev_b32 v4, 4, v1
    v_xor_b32 v5, v3, v4
    v_lshlrev_b32 v5, 4, v5
    v_lshl_add_u32 v6, v2, 10, v5
    v_xor_b32 v7, 64, v6
    v_and_b32 v3, 15, v1
    v_lshlrev_b32 v5, 2, v4
    v_xor_b32 v5, v3, v5
    v_lshlrev_b32 v5, 4, v5
    s_movk_i32 s27, 3072
    v_mul_lo_u32 v3, v4, s27
    v_add_u32 v8, v3, v5
    v_and_b32 v2, 31, v1
    v_lshrrev_b32 v3, 5, v1
    v_lshrrev_b32 v4, 1, v2
    v_and_b32 v4, 7, v4
    s_lshl_b32 s27, s32, 13
    v_lshlrev_b32 v5, 7, v2
    v_add_u32 v5, s27, v5
    v_or_b32 v19, 0, v3
    v_xor_b32 v19, v19, v4
    v_lshl_add_u32 v9, v19, 4, v5
    v_or_b32 v19, 2, v3
    v_xor_b32 v19, v19, v4
    v_lshl_add_u32 v10, v19, 4, v5
    v_or_b32 v19, 4, v3
    v_xor_b32 v19, v19, v4
    v_lshl_add_u32 v11, v19, 4, v5
    v_or_b32 v19, 6, v3
    v_xor_b32 v19, v19, v4
    v_lshl_add_u32 v12, v19, 4, v5
    v_lshrrev_b32 v2, 4, v1
    v_and_b32 v3, 15, v1
    v_lshrrev_b32 v4, 2, v3
    v_and_b32 v3, 3, v3
    v_lshrrev_b32 v5, 1, v2
    v_lshl_add_u32 v5, v5, 3, v4
    v_lshlrev_b32 v5, 8, v5
    v_add_u32 v5, 16384, v5
    v_and_b32 v19, 1, v3
    v_lshl_add_u32 v5, v19, 3, v5
    v_and_b32 v2, 1, v2
    v_lshrrev_b32 v3, 1, v3
    v_lshl_add_u32 v2, v2, 1, v3
    s_lshl_b32 s27, s33, 2
    v_add_u32 v2, s27, v2
    v_lshlrev_b32 v4, 2, v4
    v_xor_b32 v19, v2, v4
    v_lshl_add_u32 v13, v19, 4, v5
    s_waitcnt lgkmcnt(0)
    s_mov_b32 s12, s4
    s_and_b32 s13, s5, 0xffff
    s_mov_b32 s14, 2097152
    s_mov_b32 s15, 0x00020000
    s_mov_b32 s16, s6
    s_and_b32 s17, s7, 0xffff
    s_mov_b32 s18, 1572864
    s_mov_b32 s19, 0x00020000
    s_mov_b32 s20, s8
    s_and_b32 s21, s9, 0xffff
    s_mov_b32 s22, 13631488
    s_mov_b32 s23, 0x00020000
    s_lshl_b32 s28, s26, 11
    s_lshl_b32 s27, s24, 7
    s_lshl_b32 s34, s26, 4
    s_add_u32 s27, s27, s34
    s_lshl_b32 s29, s27, 10
    s_mul_i32 s30, s26, 24576
    s_lshl_b32 s27, s25, 8
    s_add_u32 s30, s30, s27
    s_cmp_ge_u32 s25, 8
    s_cbranch_scc1 L_gemm_v
    s_add_u32 m0, s28, 0
    s_add_u32 s27, s29, 0
    buffer_load_dwordx4 v6, s[12:15], s27 offen lds
    s_add_u32 m0, s28, 1024
    s_add_u32 s27, s29, 8192
    buffer_load_dwordx4 v7, s[12:15], s27 offen lds
    s_add_u32 m0, s28, 16384
    s_add_u32 s27, s30, 0
    buffer_load_dwordx4 v8, s[16:19], s27 offen lds
    s_add_u32 m0, s28, 17408
    s_add_u32 s27, s30, 12288
    buffer_load_dwordx4 v8, s[16:19], s27 offen lds
    s_add_u32 m0, s28, 32768
    s_add_u32 s27, s29, 128
    buffer_load_dwordx4 v6, s[12:15], s27 offen lds
    s_add_u32 m0, s28, 33792
    s_add_u32 s27, s29, 8320
    buffer_load_dwordx4 v7, s[12:15], s27 offen lds
    s_add_u32 m0, s28, 49152
    s_add_u32 s27, s30, 196608
    buffer_load_dwordx4 v8, s[16:19], s27 offen lds
    s_add_u32 m0, s28, 50176
    s_add_u32 s27, s30, 208896
    buffer_load_dwordx4 v8, s[16:19], s27 offen lds
    s_add_u32 m0, s28, 65536
    s_add_u32 s27, s29, 256
    buffer_load_dwordx4 v6, s[12:15], s27 offen lds
    s_add_u32 m0, s28, 66560
    s_add_u32 s27, s29, 8448
    buffer_load_dwordx4 v7, s[12:15], s27 offen lds
    s_add_u32 m0, s28, 81920
    s_add_u32 s27, s30, 393216
    buffer_load_dwordx4 v8, s[16:19], s27 offen lds
    s_add_u32 m0, s28, 82944
    s_add_u32 s27, s30, 405504
    buffer_load_dwordx4 v8, s[16:19], s27 offen lds
    s_waitcnt vmcnt(8)
    s_barrier
    s_add_u32 m0, s28, 98304
    s_add_u32 s27, s29, 384
    buffer_load_dwordx4 v6, s[12:15], s27 offen lds
    s_add_u32 m0, s28, 99328
    s_add_u32 s27, s29, 8576
    buffer_load_dwordx4 v7, s[12:15], s27 offen lds
    s_add_u32 m0, s28, 114688
    s_add_u32 s27, s30, 589824
    buffer_load_dwordx4 v8, s[16:19], s27 offen lds
    s_add_u32 m0, s28, 115712
    s_add_u32 s27, s30, 602112
    buffer_load_dwordx4 v8, s[16:19], s27 offen lds
    v_add_u32 v14, 0, v9
    v_add_u32 v15, 0, v10
    v_add_u32 v16, 0, v11
    v_add_u32 v17, 0, v12
    v_add_u32 v18, 0, v13
    ds_read_b128 v[52:55], v14 offset:0
    ds_read_b128 v[56:59], v14 offset:4096
    ds_read_b64_tr_b16 v[68:69], v18 offset:0
    ds_read_b64_tr_b16 v[70:71], v18 offset:1024
    ds_read_b128 v[60:63], v15 offset:0
    ds_read_b128 v[64:67], v15 offset:4096
    ds_read_b64_tr_b16 v[72:73], v18 offset:4096
    ds_read_b64_tr_b16 v[74:75], v18 offset:5120
    s_waitcnt lgkmcnt(4)
    v_mfma_f32_32x32x16_bf16 v[20:35], v[68:71], v[52:55], 0
    v_mfma_f32_32x32x16_bf16 v[36:51], v[68:71], v[56:59], 0
    ds_read_b128 v[52:55], v16 offset:0
    ds_read_b128 v[56:59], v16 offset:4096
    ds_read_b64_tr_b16 v[68:69], v18 offset:8192
    ds_read_b64_tr_b16 v[70:71], v18 offset:9216
    s_waitcnt lgkmcnt(4)
    v_mfma_f32_32x32x16_bf16 v[20:35], v[72:75], v[60:63], v[20:35]
    v_mfma_f32_32x32x16_bf16 v[36:51], v[72:75], v[64:67], v[36:51]
    ds_read_b128 v[60:63], v17 offset:0
    ds_read_b128 v[64:67], v17 offset:4096
    ds_read_b64_tr_b16 v[72:73], v18 offset:12288
    ds_read_b64_tr_b16 v[74:75], v18 offset:13312
    s_waitcnt lgkmcnt(4)
    v_mfma_f32_32x32x16_bf16 v[20:35], v[68:71], v[52:55], v[20:35]
    v_mfma_f32_32x32x16_bf16 v[36:51], v[68:71], v[56:59], v[36:51]
    s_waitcnt vmcnt(8) lgkmcnt(0)
    s_barrier
    s_add_u32 m0, s28, 0
    s_add_u32 s27, s29, 512
    buffer_load_dwordx4 v6, s[12:15], s27 offen lds
    s_add_u32 m0, s28, 1024
    s_add_u32 s27, s29, 8704
    buffer_load_dwordx4 v7, s[12:15], s27 offen lds
    s_add_u32 m0, s28, 16384
    s_add_u32 s27, s30, 786432
    buffer_load_dwordx4 v8, s[16:19], s27 offen lds
    s_add_u32 m0, s28, 17408
    s_add_u32 s27, s30, 798720
    buffer_load_dwordx4 v8, s[16:19], s27 offen lds
    v_add_u32 v14, 32768, v9
    v_add_u32 v15, 32768, v10
    v_add_u32 v16, 32768, v11
    v_add_u32 v17, 32768, v12
    v_add_u32 v18, 32768, v13
    ds_read_b128 v[52:55], v14 offset:0
    ds_read_b128 v[56:59], v14 offset:4096
    ds_read_b64_tr_b16 v[68:69], v18 offset:0
    ds_read_b64_tr_b16 v[70:71], v18 offset:1024
    v_mfma_f32_32x32x16_bf16 v[20:35], v[72:75], v[60:63], v[20:35]
    v_mfma_f32_32x32x16_bf16 v[36:51], v[72:75], v[64:67], v[36:51]
    ds_read_b128 v[60:63], v15 offset:0
    ds_read_b128 v[64:67], v15 offset:4096
    ds_read_b64_tr_b16 v[72:73], v18 offset:4096
    ds_read_b64_tr_b16 v[74:75], v18 offset:5120
    s_waitcnt lgkmcnt(4)
    v_mfma_f32_32x32x16_bf16 v[20:35], v[68:71], v[52:55], v[20:35]
    v_mfma_f32_32x32x16_bf16 v[36:51], v[68:71], v[56:59], v[36:51]
    ds_read_b128 v[52:55], v16 offset:0
    ds_read_b128 v[56:59], v16 offset:4096
    ds_read_b64_tr_b16 v[68:69], v18 offset:8192
    ds_read_b64_tr_b16 v[70:71], v18 offset:9216
    s_waitcnt lgkmcnt(4)
    v_mfma_f32_32x32x16_bf16 v[20:35], v[72:75], v[60:63], v[20:35]
    v_mfma_f32_32x32x16_bf16 v[36:51], v[72:75], v[64:67], v[36:51]
    ds_read_b128 v[60:63], v17 offset:0
    ds_read_b128 v[64:67], v17 offset:4096
    ds_read_b64_tr_b16 v[72:73], v18 offset:12288
    ds_read_b64_tr_b16 v[74:75], v18 offset:13312
    s_waitcnt lgkmcnt(4)
    v_mfma_f32_32x32x16_bf16 v[20:35], v[68:71], v[52:55], v[20:35]
    v_mfma_f32_32x32x16_bf16 v[36:51], v[68:71], v[56:59], v[36:51]
    s_waitcnt vmcnt(8) lgkmcnt(0)
    s_barrier
    s_add_u32 m0, s28, 32768
    s_add_u32 s27, s29, 640
    buffer_load_dwordx4 v6, s[12:15], s27 offen lds
    s_add_u32 m0, s28, 33792
    s_add_u32 s27, s29, 8832
    buffer_load_dwordx4 v7, s[12:15], s27 offen lds
    s_add_u32 m0, s28, 49152
    s_add_u32 s27, s30, 983040
    buffer_load_dwordx4 v8, s[16:19], s27 offen lds
    s_add_u32 m0, s28, 50176
    s_add_u32 s27, s30, 995328
    buffer_load_dwordx4 v8, s[16:19], s27 offen lds
    v_add_u32 v14, 65536, v9
    v_add_u32 v15, 65536, v10
    v_add_u32 v16, 65536, v11
    v_add_u32 v17, 65536, v12
    v_add_u32 v18, 65536, v13
    ds_read_b128 v[52:55], v14 offset:0
    ds_read_b128 v[56:59], v14 offset:4096
    ds_read_b64_tr_b16 v[68:69], v18 offset:0
    ds_read_b64_tr_b16 v[70:71], v18 offset:1024
    v_mfma_f32_32x32x16_bf16 v[20:35], v[72:75], v[60:63], v[20:35]
    v_mfma_f32_32x32x16_bf16 v[36:51], v[72:75], v[64:67], v[36:51]
    ds_read_b128 v[60:63], v15 offset:0
    ds_read_b128 v[64:67], v15 offset:4096
    ds_read_b64_tr_b16 v[72:73], v18 offset:4096
    ds_read_b64_tr_b16 v[74:75], v18 offset:5120
    s_waitcnt lgkmcnt(4)
    v_mfma_f32_32x32x16_bf16 v[20:35], v[68:71], v[52:55], v[20:35]
    v_mfma_f32_32x32x16_bf16 v[36:51], v[68:71], v[56:59], v[36:51]
    ds_read_b128 v[52:55], v16 offset:0
    ds_read_b128 v[56:59], v16 offset:4096
    ds_read_b64_tr_b16 v[68:69], v18 offset:8192
    ds_read_b64_tr_b16 v[70:71], v18 offset:9216
    s_waitcnt lgkmcnt(4)
    v_mfma_f32_32x32x16_bf16 v[20:35], v[72:75], v[60:63], v[20:35]
    v_mfma_f32_32x32x16_bf16 v[36:51], v[72:75], v[64:67], v[36:51]
    ds_read_b128 v[60:63], v17 offset:0
    ds_read_b128 v[64:67], v17 offset:4096
    ds_read_b64_tr_b16 v[72:73], v18 offset:12288
    ds_read_b64_tr_b16 v[74:75], v18 offset:13312
    s_waitcnt lgkmcnt(4)
    v_mfma_f32_32x32x16_bf16 v[20:35], v[68:71], v[52:55], v[20:35]
    v_mfma_f32_32x32x16_bf16 v[36:51], v[68:71], v[56:59], v[36:51]
    s_waitcnt vmcnt(8) lgkmcnt(0)
    s_barrier
    s_add_u32 m0, s28, 65536
    s_add_u32 s27, s29, 768
    buffer_load_dwordx4 v6, s[12:15], s27 offen lds
    s_add_u32 m0, s28, 66560
    s_add_u32 s27, s29, 8960
    buffer_load_dwordx4 v7, s[12:15], s27 offen lds
    s_add_u32 m0, s28, 81920
    s_add_u32 s27, s30, 1179648
    buffer_load_dwordx4 v8, s[16:19], s27 offen lds
    s_add_u32 m0, s28, 82944
    s_add_u32 s27, s30, 1191936
    buffer_load_dwordx4 v8, s[16:19], s27 offen lds
    v_add_u32 v14, 98304, v9
    v_add_u32 v15, 98304, v10
    v_add_u32 v16, 98304, v11
    v_add_u32 v17, 98304, v12
    v_add_u32 v18, 98304, v13
    ds_read_b128 v[52:55], v14 offset:0
    ds_read_b128 v[56:59], v14 offset:4096
    ds_read_b64_tr_b16 v[68:69], v18 offset:0
    ds_read_b64_tr_b16 v[70:71], v18 offset:1024
    v_mfma_f32_32x32x16_bf16 v[20:35], v[72:75], v[60:63], v[20:35]
    v_mfma_f32_32x32x16_bf16 v[36:51], v[72:75], v[64:67], v[36:51]
    ds_read_b128 v[60:63], v15 offset:0
    ds_read_b128 v[64:67], v15 offset:4096
    ds_read_b64_tr_b16 v[72:73], v18 offset:4096
    ds_read_b64_tr_b16 v[74:75], v18 offset:5120
    s_waitcnt lgkmcnt(4)
    v_mfma_f32_32x32x16_bf16 v[20:35], v[68:71], v[52:55], v[20:35]
    v_mfma_f32_32x32x16_bf16 v[36:51], v[68:71], v[56:59], v[36:51]
    ds_read_b128 v[52:55], v16 offset:0
    ds_read_b128 v[56:59], v16 offset:4096
    ds_read_b64_tr_b16 v[68:69], v18 offset:8192
    ds_read_b64_tr_b16 v[70:71], v18 offset:9216
    s_waitcnt lgkmcnt(4)
    v_mfma_f32_32x32x16_bf16 v[20:35], v[72:75], v[60:63], v[20:35]
    v_mfma_f32_32x32x16_bf16 v[36:51], v[72:75], v[64:67], v[36:51]
    ds_read_b128 v[60:63], v17 offset:0
    ds_read_b128 v[64:67], v17 offset:4096
    ds_read_b64_tr_b16 v[72:73], v18 offset:12288
    ds_read_b64_tr_b16 v[74:75], v18 offset:13312
    s_waitcnt lgkmcnt(4)
    v_mfma_f32_32x32x16_bf16 v[20:35], v[68:71], v[52:55], v[20:35]
    v_mfma_f32_32x32x16_bf16 v[36:51], v[68:71], v[56:59], v[36:51]
    s_waitcnt vmcnt(8) lgkmcnt(0)
    s_barrier
    s_add_u32 m0, s28, 98304
    s_add_u32 s27, s29, 896
    buffer_load_dwordx4 v6, s[12:15], s27 offen lds
    s_add_u32 m0, s28, 99328
    s_add_u32 s27, s29, 9088
    buffer_load_dwordx4 v7, s[12:15], s27 offen lds
    s_add_u32 m0, s28, 114688
    s_add_u32 s27, s30, 1376256
    buffer_load_dwordx4 v8, s[16:19], s27 offen lds
    s_add_u32 m0, s28, 115712
    s_add_u32 s27, s30, 1388544
    buffer_load_dwordx4 v8, s[16:19], s27 offen lds
    v_add_u32 v14, 0, v9
    v_add_u32 v15, 0, v10
    v_add_u32 v16, 0, v11
    v_add_u32 v17, 0, v12
    v_add_u32 v18, 0, v13
    ds_read_b128 v[52:55], v14 offset:0
    ds_read_b128 v[56:59], v14 offset:4096
    ds_read_b64_tr_b16 v[68:69], v18 offset:0
    ds_read_b64_tr_b16 v[70:71], v18 offset:1024
    v_mfma_f32_32x32x16_bf16 v[20:35], v[72:75], v[60:63], v[20:35]
    v_mfma_f32_32x32x16_bf16 v[36:51], v[72:75], v[64:67], v[36:51]
    ds_read_b128 v[60:63], v15 offset:0
    ds_read_b128 v[64:67], v15 offset:4096
    ds_read_b64_tr_b16 v[72:73], v18 offset:4096
    ds_read_b64_tr_b16 v[74:75], v18 offset:5120
    s_waitcnt lgkmcnt(4)
    v_mfma_f32_32x32x16_bf16 v[20:35], v[68:71], v[52:55], v[20:35]
    v_mfma_f32_32x32x16_bf16 v[36:51], v[68:71], v[56:59], v[36:51]
    ds_read_b128 v[52:55], v16 offset:0
    ds_read_b128 v[56:59], v16 offset:4096
    ds_read_b64_tr_b16 v[68:69], v18 offset:8192
    ds_read_b64_tr_b16 v[70:71], v18 offset:9216
    s_waitcnt lgkmcnt(4)
    v_mfma_f32_32x32x16_bf16 v[20:35], v[72:75], v[60:63], v[20:35]
    v_mfma_f32_32x32x16_bf16 v[36:51], v[72:75], v[64:67], v[36:51]
    ds_read_b128 v[60:63], v17 offset:0
    ds_read_b128 v[64:67], v17 offset:4096
    ds_read_b64_tr_b16 v[72:73], v18 offset:12288
    ds_read_b64_tr_b16 v[74:75], v18 offset:13312
    s_waitcnt lgkmcnt(4)
    v_mfma_f32_32x32x16_bf16 v[20:35], v[68:71], v[52:55], v[20:35]
    v_mfma_f32_32x32x16_bf16 v[36:51], v[68:71], v[56:59], v[36:51]
    s_waitcnt vmcnt(8) lgkmcnt(0)
    s_barrier
    v_add_u32 v14, 32768, v9
    v_add_u32 v15, 32768, v10
    v_add_u32 v16, 32768, v11
    v_add_u32 v17, 32768, v12
    v_add_u32 v18, 32768, v13
    ds_read_b128 v[52:55], v14 offset:0
    ds_read_b128 v[56:59], v14 offset:4096
    ds_read_b64_tr_b16 v[68:69], v18 offset:0
    ds_read_b64_tr_b16 v[70:71], v18 offset:1024
    v_mfma_f32_32x32x16_bf16 v[20:35], v[72:75], v[60:63], v[20:35]
    v_mfma_f32_32x32x16_bf16 v[36:51], v[72:75], v[64:67], v[36:51]
    ds_read_b128 v[60:63], v15 offset:0
    ds_read_b128 v[64:67], v15 offset:4096
    ds_read_b64_tr_b16 v[72:73], v18 offset:4096
    ds_read_b64_tr_b16 v[74:75], v18 offset:5120
    s_waitcnt lgkmcnt(4)
    v_mfma_f32_32x32x16_bf16 v[20:35], v[68:71], v[52:55], v[20:35]
    v_mfma_f32_32x32x16_bf16 v[36:51], v[68:71], v[56:59], v[36:51]
    ds_read_b128 v[52:55], v16 offset:0
    ds_read_b128 v[56:59], v16 offset:4096
    ds_read_b64_tr_b16 v[68:69], v18 offset:8192
    ds_read_b64_tr_b16 v[70:71], v18 offset:9216
    s_waitcnt lgkmcnt(4)
    v_mfma_f32_32x32x16_bf16 v[20:35], v[72:75], v[60:63], v[20:35]
    v_mfma_f32_32x32x16_bf16 v[36:51], v[72:75], v[64:67], v[36:51]
    ds_read_b128 v[60:63], v17 offset:0
    ds_read_b128 v[64:67], v17 offset:4096
    ds_read_b64_tr_b16 v[72:73], v18 offset:12288
    ds_read_b64_tr_b16 v[74:75], v18 offset:13312
    s_waitcnt lgkmcnt(4)
    v_mfma_f32_32x32x16_bf16 v[20:35], v[68:71], v[52:55], v[20:35]
    v_mfma_f32_32x32x16_bf16 v[36:51], v[68:71], v[56:59], v[36:51]
    s_waitcnt vmcnt(4) lgkmcnt(0)
    s_barrier
    v_add_u32 v14, 65536, v9
    v_add_u32 v15, 65536, v10
    v_add_u32 v16, 65536, v11
    v_add_u32 v17, 65536, v12
    v_add_u32 v18, 65536, v13
    ds_read_b128 v[52:55], v14 offset:0
    ds_read_b128 v[56:59], v14 offset:4096
    ds_read_b64_tr_b16 v[68:69], v18 offset:0
    ds_read_b64_tr_b16 v[70:71], v18 offset:1024
    v_mfma_f32_32x32x16_bf16 v[20:35], v[72:75], v[60:63], v[20:35]
    v_mfma_f32_32x32x16_bf16 v[36:51], v[72:75], v[64:67], v[36:51]
    ds_read_b128 v[60:63], v15 offset:0
    ds_read_b128 v[64:67], v15 offset:4096
    ds_read_b64_tr_b16 v[72:73], v18 offset:4096
    ds_read_b64_tr_b16 v[74:75], v18 offset:5120
    s_waitcnt lgkmcnt(4)
    v_mfma_f32_32x32x16_bf16 v[20:35], v[68:71], v[52:55], v[20:35]
    v_mfma_f32_32x32x16_bf16 v[36:51], v[68:71], v[56:59], v[36:51]
    ds_read_b128 v[52:55], v16 offset:0
    ds_read_b128 v[56:59], v16 offset:4096
    ds_read_b64_tr_b16 v[68:69], v18 offset:8192
    ds_read_b64_tr_b16 v[70:71], v18 offset:9216
    s_waitcnt lgkmcnt(4)
    v_mfma_f32_32x32x16_bf16 v[20:35], v[72:75], v[60:63], v[20:35]
    v_mfma_f32_32x32x16_bf16 v[36:51], v[72:75], v[64:67], v[36:51]
    ds_read_b128 v[60:63], v17 offset:0
    ds_read_b128 v[64:67], v17 offset:4096
    ds_read_b64_tr_b16 v[72:73], v18 offset:12288
    ds_read_b64_tr_b16 v[74:75], v18 offset:13312
    s_waitcnt lgkmcnt(4)
    v_mfma_f32_32x32x16_bf16 v[20:35], v[68:71], v[52:55], v[20:35]
    v_mfma_f32_32x32x16_bf16 v[36:51], v[68:71], v[56:59], v[36:51]
    s_waitcnt vmcnt(0) lgkmcnt(0)
    s_barrier
    v_add_u32 v14, 98304, v9
    v_add_u32 v15, 98304, v10
    v_add_u32 v16, 98304, v11
    v_add_u32 v17, 98304, v12
    v_add_u32 v18, 98304, v13
    ds_read_b128 v[52:55], v14 offset:0
    ds_read_b128 v[56:59], v14 offset:4096
    ds_read_b64_tr_b16 v[68:69], v18 offset:0
    ds_read_b64_tr_b16 v[70:71], v18 offset:1024
    v_mfma_f32_32x32x16_bf16 v[20:35], v[72:75], v[60:63], v[20:35]
    v_mfma_f32_32x32x16_bf16 v[36:51], v[72:75], v[64:67], v[36:51]
    ds_read_b128 v[60:63], v15 offset:0
    ds_read_b128 v[64:67], v15 offset:4096
    ds_read_b64_tr_b16 v[72:73], v18 offset:4096
    ds_read_b64_tr_b16 v[74:75], v18 offset:5120
    s_waitcnt lgkmcnt(4)
    v_mfma_f32_32x32x16_bf16 v[20:35], v[68:71], v[52:55], v[20:35]
    v_mfma_f32_32x32x16_bf16 v[36:51], v[68:71], v[56:59], v[36:51]
    ds_read_b128 v[52:55], v16 offset:0
    ds_read_b128 v[56:59], v16 offset:4096
    ds_read_b64_tr_b16 v[68:69], v18 offset:8192
    ds_read_b64_tr_b16 v[70:71], v18 offset:9216
    s_waitcnt lgkmcnt(4)
    v_mfma_f32_32x32x16_bf16 v[20:35], v[72:75], v[60:63], v[20:35]
    v_mfma_f32_32x32x16_bf16 v[36:51], v[72:75], v[64:67], v[36:51]
    ds_read_b128 v[60:63], v17 offset:0
    ds_read_b128 v[64:67], v17 offset:4096
    ds_read_b64_tr_b16 v[72:73], v18 offset:12288
    ds_read_b64_tr_b16 v[74:75], v18 offset:13312
    s_waitcnt lgkmcnt(4)
    v_mfma_f32_32x32x16_bf16 v[20:35], v[68:71], v[52:55], v[20:35]
    v_mfma_f32_32x32x16_bf16 v[36:51], v[68:71], v[56:59], v[36:51]
    s_waitcnt lgkmcnt(0)
    v_mfma_f32_32x32x16_bf16 v[20:35], v[72:75], v[60:63], v[20:35]
    v_mfma_f32_32x32x16_bf16 v[36:51], v[72:75], v[64:67], v[36:51]
    v_and_b32 v2, 31, v1
    v_lshrrev_b32 v3, 5, v1
    s_lshl_b32 s27, s32, 6
    v_add_u32 v2, s27, v2
    v_lshlrev_b32 v2, 4, v2
    v_lshl_add_u32 v19, v3, 15, v2
    s_and_b32 s27, s25, 3
    s_lshl_b32 s27, s27, 2
    s_add_u32 s27, s27, s33
    s_lshl_b32 s31, s27, 17
    s_lshl_b32 s27, s24, 11
    s_add_u32 s31, s31, s27
    s_lshr_b32 s27, s25, 2
    s_lshl_b32 s27, s27, 21
    s_add_u32 s31, s31, s27
    s_mov_b32 s35, 0x3eb8aa3b
    s_cmp_lt_u32 s25, 4
    s_cselect_b32 s35, s35, 1.0
    s_cmp_lt_u32 s25, 4
    s_cbranch_scc1 L_gemm_qk_store
    v_mul_f32 v94, v20, v20
    v_fmac_f32 v94, v21, v21
    v_fmac_f32 v94, v22, v22
    v_fmac_f32 v94, v23, v23
    v_fmac_f32 v94, v24, v24
    v_fmac_f32 v94, v25, v25
    v_fmac_f32 v94, v26, v26
    v_fmac_f32 v94, v27, v27
    v_mov_b32 v2, v94
    v_mov_b32 v3, v94
    s_nop 1
    v_permlane32_swap_b32 v2, v3
    v_add_f32 v94, v2, v3
    v_mov_b32 v92, v94
    v_mul_f32 v94, v36, v36
    v_fmac_f32 v94, v37, v37
    v_fmac_f32 v94, v38, v38
    v_fmac_f32 v94, v39, v39
    v_fmac_f32 v94, v40, v40
    v_fmac_f32 v94, v41, v41
    v_fmac_f32 v94, v42, v42
    v_fmac_f32 v94, v43, v43
    v_mov_b32 v2, v94
    v_mov_b32 v3, v94
    s_nop 1
    v_permlane32_swap_b32 v2, v3
    v_add_f32 v94, v2, v3
    v_max_f32 v92, v92, v94
    v_mul_f32 v94, v28, v28
    v_fmac_f32 v94, v29, v29
    v_fmac_f32 v94, v30, v30
    v_fmac_f32 v94, v31, v31
    v_fmac_f32 v94, v32, v32
    v_fmac_f32 v94, v33, v33
    v_fmac_f32 v94, v34, v34
    v_fmac_f32 v94, v35, v35
    v_mov_b32 v2, v94
    v_mov_b32 v3, v94
    s_nop 1
    v_permlane32_swap_b32 v2, v3
    v_add_f32 v94, v2, v3
    v_mov_b32 v93, v94
    v_mul_f32 v94, v44, v44
    v_fmac_f32 v94, v45, v45
    v_fmac_f32 v94, v46, v46
    v_fmac_f32 v94, v47, v47
    v_fmac_f32 v94, v48, v48
    v_fmac_f32 v94, v49, v49
    v_fmac_f32 v94, v50, v50
    v_fmac_f32 v94, v51, v51
    v_mov_b32 v2, v94
    v_mov_b32 v3, v94
    s_nop 1
    v_permlane32_swap_b32 v2, v3
    v_add_f32 v94, v2, v3
    v_max_f32 v93, v93, v94
    v_max_f32_dpp v92, v92, v92 row_shr:1 row_mask:0xf bank_mask:0xf
    s_nop 0
    v_max_f32_dpp v93, v93, v93 row_shr:1 row_mask:0xf bank_mask:0xf
    v_max_f32_dpp v92, v92, v92 row_shr:2 row_mask:0xf bank_mask:0xf
    s_nop 0
    v_max_f32_dpp v93, v93, v93 row_shr:2 row_mask:0xf bank_mask:0xf
    v_max_f32_dpp v92, v92, v92 row_shr:4 row_mask:0xf bank_mask:0xf
    s_nop 0
    v_max_f32_dpp v93, v93, v93 row_shr:4 row_mask:0xf bank_mask:0xf
    v_max_f32_dpp v92, v92, v92 row_shr:8 row_mask:0xf bank_mask:0xf
    s_nop 0
    v_max_f32_dpp v93, v93, v93 row_shr:8 row_mask:0xf bank_mask:0xf
    v_max_f32_dpp v92, v92, v92 row_bcast:15 row_mask:0xa bank_mask:0xf
    s_nop 0
    v_max_f32_dpp v93, v93, v93 row_bcast:15 row_mask:0xa bank_mask:0xf
    s_and_b32 s27, s25, 3
    s_lshl_b32 s27, s27, 3
    s_lshl_b32 s34, s33, 1
    s_add_u32 s27, s27, s34
    s_lshl_b32 s27, s27, 7
    s_lshl_b32 s34, s24, 1
    s_add_u32 s34, s34, s32
    s_lshl_b32 s34, s34, 2
    s_add_u32 s27, s27, s34
    s_add_u32 s27, s27, 12648448
    v_mov_b32 v2, 0
    s_mov_b32 exec_lo, 0x80000000
    s_mov_b32 exec_hi, 0
    buffer_store_dword v92, v2, s[20:23], s27 offen offset:0
    buffer_store_dword v93, v2, s[20:23], s27 offen offset:128
    s_mov_b64 exec, -1
L_gemm_qk_store:
    v_mul_f32 v20, s35, v20
    v_mul_f32 v21, s35, v21
    v_mul_f32 v22, s35, v22
    v_mul_f32 v23, s35, v23
    v_mul_f32 v24, s35, v24
    v_mul_f32 v25, s35, v25
    v_mul_f32 v26, s35, v26
    v_mul_f32 v27, s35, v27
    v_mul_f32 v28, s35, v28
    v_mul_f32 v29, s35, v29
    v_mul_f32 v30, s35, v30
    v_mul_f32 v31, s35, v31
    v_mul_f32 v32, s35, v32
    v_mul_f32 v33, s35, v33
    v_mul_f32 v34, s35, v34
    v_mul_f32 v35, s35, v35
    v_cvt_pk_bf16_f32 v76, v20, v21
    v_cvt_pk_bf16_f32 v77, v22, v23
    v_cvt_pk_bf16_f32 v78, v24, v25
    v_cvt_pk_bf16_f32 v79, v26, v27
    v_cvt_pk_bf16_f32 v80, v28, v29
    v_cvt_pk_bf16_f32 v81, v30, v31
    v_cvt_pk_bf16_f32 v82, v32, v33
    v_cvt_pk_bf16_f32 v83, v34, v35
    s_add_u32 s27, s31, 0
    buffer_store_dwordx4 v[76:79], v19, s[20:23], s27 offen offset:0
    s_add_u32 s27, s31, 65536
    buffer_store_dwordx4 v[80:83], v19, s[20:23], s27 offen offset:0
    v_mul_f32 v36, s35, v36
    v_mul_f32 v37, s35, v37
    v_mul_f32 v38, s35, v38
    v_mul_f32 v39, s35, v39
    v_mul_f32 v40, s35, v40
    v_mul_f32 v41, s35, v41
    v_mul_f32 v42, s35, v42
    v_mul_f32 v43, s35, v43
    v_mul_f32 v44, s35, v44
    v_mul_f32 v45, s35, v45
    v_mul_f32 v46, s35, v46
    v_mul_f32 v47, s35, v47
    v_mul_f32 v48, s35, v48
    v_mul_f32 v49, s35, v49
    v_mul_f32 v50, s35, v50
    v_mul_f32 v51, s35, v51
    v_cvt_pk_bf16_f32 v84, v36, v37
    v_cvt_pk_bf16_f32 v85, v38, v39
    v_cvt_pk_bf16_f32 v86, v40, v41
    v_cvt_pk_bf16_f32 v87, v42, v43
    v_cvt_pk_bf16_f32 v88, v44, v45
    v_cvt_pk_bf16_f32 v89, v46, v47
    v_cvt_pk_bf16_f32 v90, v48, v49
    v_cvt_pk_bf16_f32 v91, v50, v51
    s_add_u32 s27, s31, 0
    buffer_store_dwordx4 v[84:87], v19, s[20:23], s27 offen offset:512
    s_add_u32 s27, s31, 65536
    buffer_store_dwordx4 v[88:91], v19, s[20:23], s27 offen offset:512
    s_endpgm
L_gemm_v:
    s_add_u32 m0, s28, 0
    s_add_u32 s27, s29, 0
    buffer_load_dwordx4 v6, s[12:15], s27 offen lds
    s_add_u32 m0, s28, 1024
    s_add_u32 s27, s29, 8192
    buffer_load_dwordx4 v7, s[12:15], s27 offen lds
    s_add_u32 m0, s28, 16384
    s_add_u32 s27, s30, 0
    buffer_load_dwordx4 v8, s[16:19], s27 offen lds
    s_add_u32 m0, s28, 17408
    s_add_u32 s27, s30, 12288
    buffer_load_dwordx4 v8, s[16:19], s27 offen lds
    s_add_u32 m0, s28, 32768
    s_add_u32 s27, s29, 128
    buffer_load_dwordx4 v6, s[12:15], s27 offen lds
    s_add_u32 m0, s28, 33792
    s_add_u32 s27, s29, 8320
    buffer_load_dwordx4 v7, s[12:15], s27 offen lds
    s_add_u32 m0, s28, 49152
    s_add_u32 s27, s30, 196608
    buffer_load_dwordx4 v8, s[16:19], s27 offen lds
    s_add_u32 m0, s28, 50176
    s_add_u32 s27, s30, 208896
    buffer_load_dwordx4 v8, s[16:19], s27 offen lds
    s_add_u32 m0, s28, 65536
    s_add_u32 s27, s29, 256
    buffer_load_dwordx4 v6, s[12:15], s27 offen lds
    s_add_u32 m0, s28, 66560
    s_add_u32 s27, s29, 8448
    buffer_load_dwordx4 v7, s[12:15], s27 offen lds
    s_add_u32 m0, s28, 81920
    s_add_u32 s27, s30, 393216
    buffer_load_dwordx4 v8, s[16:19], s27 offen lds
    s_add_u32 m0, s28, 82944
    s_add_u32 s27, s30, 405504
    buffer_load_dwordx4 v8, s[16:19], s27 offen lds
    s_waitcnt vmcnt(8)
    s_barrier
    s_add_u32 m0, s28, 98304
    s_add_u32 s27, s29, 384
    buffer_load_dwordx4 v6, s[12:15], s27 offen lds
    s_add_u32 m0, s28, 99328
    s_add_u32 s27, s29, 8576
    buffer_load_dwordx4 v7, s[12:15], s27 offen lds
    s_add_u32 m0, s28, 114688
    s_add_u32 s27, s30, 589824
    buffer_load_dwordx4 v8, s[16:19], s27 offen lds
    s_add_u32 m0, s28, 115712
    s_add_u32 s27, s30, 602112
    buffer_load_dwordx4 v8, s[16:19], s27 offen lds
    v_add_u32 v14, 0, v9
    v_add_u32 v15, 0, v10
    v_add_u32 v16, 0, v11
    v_add_u32 v17, 0, v12
    v_add_u32 v18, 0, v13
    ds_read_b128 v[52:55], v14 offset:0
    ds_read_b128 v[56:59], v14 offset:4096
    ds_read_b64_tr_b16 v[68:69], v18 offset:0
    ds_read_b64_tr_b16 v[70:71], v18 offset:1024
    ds_read_b128 v[60:63], v15 offset:0
    ds_read_b128 v[64:67], v15 offset:4096
    ds_read_b64_tr_b16 v[72:73], v18 offset:4096
    ds_read_b64_tr_b16 v[74:75], v18 offset:5120
    s_waitcnt lgkmcnt(4)
    v_mfma_f32_32x32x16_bf16 v[20:35], v[52:55], v[68:71], 0
    v_mfma_f32_32x32x16_bf16 v[36:51], v[56:59], v[68:71], 0
    ds_read_b128 v[52:55], v16 offset:0
    ds_read_b128 v[56:59], v16 offset:4096
    ds_read_b64_tr_b16 v[68:69], v18 offset:8192
    ds_read_b64_tr_b16 v[70:71], v18 offset:9216
    s_waitcnt lgkmcnt(4)
    v_mfma_f32_32x32x16_bf16 v[20:35], v[60:63], v[72:75], v[20:35]
    v_mfma_f32_32x32x16_bf16 v[36:51], v[64:67], v[72:75], v[36:51]
    ds_read_b128 v[60:63], v17 offset:0
    ds_read_b128 v[64:67], v17 offset:4096
    ds_read_b64_tr_b16 v[72:73], v18 offset:12288
    ds_read_b64_tr_b16 v[74:75], v18 offset:13312
    s_waitcnt lgkmcnt(4)
    v_mfma_f32_32x32x16_bf16 v[20:35], v[52:55], v[68:71], v[20:35]
    v_mfma_f32_32x32x16_bf16 v[36:51], v[56:59], v[68:71], v[36:51]
    s_waitcnt vmcnt(8) lgkmcnt(0)
    s_barrier
    s_add_u32 m0, s28, 0
    s_add_u32 s27, s29, 512
    buffer_load_dwordx4 v6, s[12:15], s27 offen lds
    s_add_u32 m0, s28, 1024
    s_add_u32 s27, s29, 8704
    buffer_load_dwordx4 v7, s[12:15], s27 offen lds
    s_add_u32 m0, s28, 16384
    s_add_u32 s27, s30, 786432
    buffer_load_dwordx4 v8, s[16:19], s27 offen lds
    s_add_u32 m0, s28, 17408
    s_add_u32 s27, s30, 798720
    buffer_load_dwordx4 v8, s[16:19], s27 offen lds
    v_add_u32 v14, 32768, v9
    v_add_u32 v15, 32768, v10
    v_add_u32 v16, 32768, v11
    v_add_u32 v17, 32768, v12
    v_add_u32 v18, 32768, v13
    ds_read_b128 v[52:55], v14 offset:0
    ds_read_b128 v[56:59], v14 offset:4096
    ds_read_b64_tr_b16 v[68:69], v18 offset:0
    ds_read_b64_tr_b16 v[70:71], v18 offset:1024
    v_mfma_f32_32x32x16_bf16 v[20:35], v[60:63], v[72:75], v[20:35]
    v_mfma_f32_32x32x16_bf16 v[36:51], v[64:67], v[72:75], v[36:51]
    ds_read_b128 v[60:63], v15 offset:0
    ds_read_b128 v[64:67], v15 offset:4096
    ds_read_b64_tr_b16 v[72:73], v18 offset:4096
    ds_read_b64_tr_b16 v[74:75], v18 offset:5120
    s_waitcnt lgkmcnt(4)
    v_mfma_f32_32x32x16_bf16 v[20:35], v[52:55], v[68:71], v[20:35]
    v_mfma_f32_32x32x16_bf16 v[36:51], v[56:59], v[68:71], v[36:51]
    ds_read_b128 v[52:55], v16 offset:0
    ds_read_b128 v[56:59], v16 offset:4096
    ds_read_b64_tr_b16 v[68:69], v18 offset:8192
    ds_read_b64_tr_b16 v[70:71], v18 offset:9216
    s_waitcnt lgkmcnt(4)
    v_mfma_f32_32x32x16_bf16 v[20:35], v[60:63], v[72:75], v[20:35]
    v_mfma_f32_32x32x16_bf16 v[36:51], v[64:67], v[72:75], v[36:51]
    ds_read_b128 v[60:63], v17 offset:0
    ds_read_b128 v[64:67], v17 offset:4096
    ds_read_b64_tr_b16 v[72:73], v18 offset:12288
    ds_read_b64_tr_b16 v[74:75], v18 offset:13312
    s_waitcnt lgkmcnt(4)
    v_mfma_f32_32x32x16_bf16 v[20:35], v[52:55], v[68:71], v[20:35]
    v_mfma_f32_32x32x16_bf16 v[36:51], v[56:59], v[68:71], v[36:51]
    s_waitcnt vmcnt(8) lgkmcnt(0)
    s_barrier
    s_add_u32 m0, s28, 32768
    s_add_u32 s27, s29, 640
    buffer_load_dwordx4 v6, s[12:15], s27 offen lds
    s_add_u32 m0, s28, 33792
    s_add_u32 s27, s29, 8832
    buffer_load_dwordx4 v7, s[12:15], s27 offen lds
    s_add_u32 m0, s28, 49152
    s_add_u32 s27, s30, 983040
    buffer_load_dwordx4 v8, s[16:19], s27 offen lds
    s_add_u32 m0, s28, 50176
    s_add_u32 s27, s30, 995328
    buffer_load_dwordx4 v8, s[16:19], s27 offen lds
    v_add_u32 v14, 65536, v9
    v_add_u32 v15, 65536, v10
    v_add_u32 v16, 65536, v11
    v_add_u32 v17, 65536, v12
    v_add_u32 v18, 65536, v13
    ds_read_b128 v[52:55], v14 offset:0
    ds_read_b128 v[56:59], v14 offset:4096
    ds_read_b64_tr_b16 v[68:69], v18 offset:0
    ds_read_b64_tr_b16 v[70:71], v18 offset:1024
    v_mfma_f32_32x32x16_bf16 v[20:35], v[60:63], v[72:75], v[20:35]
    v_mfma_f32_32x32x16_bf16 v[36:51], v[64:67], v[72:75], v[36:51]
    ds_read_b128 v[60:63], v15 offset:0
    ds_read_b128 v[64:67], v15 offset:4096
    ds_read_b64_tr_b16 v[72:73], v18 offset:4096
    ds_read_b64_tr_b16 v[74:75], v18 offset:5120
    s_waitcnt lgkmcnt(4)
    v_mfma_f32_32x32x16_bf16 v[20:35], v[52:55], v[68:71], v[20:35]
    v_mfma_f32_32x32x16_bf16 v[36:51], v[56:59], v[68:71], v[36:51]
    ds_read_b128 v[52:55], v16 offset:0
    ds_read_b128 v[56:59], v16 offset:4096
    ds_read_b64_tr_b16 v[68:69], v18 offset:8192
    ds_read_b64_tr_b16 v[70:71], v18 offset:9216
    s_waitcnt lgkmcnt(4)
    v_mfma_f32_32x32x16_bf16 v[20:35], v[60:63], v[72:75], v[20:35]
    v_mfma_f32_32x32x16_bf16 v[36:51], v[64:67], v[72:75], v[36:51]
    ds_read_b128 v[60:63], v17 offset:0
    ds_read_b128 v[64:67], v17 offset:4096
    ds_read_b64_tr_b16 v[72:73], v18 offset:12288
    ds_read_b64_tr_b16 v[74:75], v18 offset:13312
    s_waitcnt lgkmcnt(4)
    v_mfma_f32_32x32x16_bf16 v[20:35], v[52:55], v[68:71], v[20:35]
    v_mfma_f32_32x32x16_bf16 v[36:51], v[56:59], v[68:71], v[36:51]
    s_waitcnt vmcnt(8) lgkmcnt(0)
    s_barrier
    s_add_u32 m0, s28, 65536
    s_add_u32 s27, s29, 768
    buffer_load_dwordx4 v6, s[12:15], s27 offen lds
    s_add_u32 m0, s28, 66560
    s_add_u32 s27, s29, 8960
    buffer_load_dwordx4 v7, s[12:15], s27 offen lds
    s_add_u32 m0, s28, 81920
    s_add_u32 s27, s30, 1179648
    buffer_load_dwordx4 v8, s[16:19], s27 offen lds
    s_add_u32 m0, s28, 82944
    s_add_u32 s27, s30, 1191936
    buffer_load_dwordx4 v8, s[16:19], s27 offen lds
    v_add_u32 v14, 98304, v9
    v_add_u32 v15, 98304, v10
    v_add_u32 v16, 98304, v11
    v_add_u32 v17, 98304, v12
    v_add_u32 v18, 98304, v13
    ds_read_b128 v[52:55], v14 offset:0
    ds_read_b128 v[56:59], v14 offset:4096
    ds_read_b64_tr_b16 v[68:69], v18 offset:0
    ds_read_b64_tr_b16 v[70:71], v18 offset:1024
    v_mfma_f32_32x32x16_bf16 v[20:35], v[60:63], v[72:75], v[20:35]
    v_mfma_f32_32x32x16_bf16 v[36:51], v[64:67], v[72:75], v[36:51]
    ds_read_b128 v[60:63], v15 offset:0
    ds_read_b128 v[64:67], v15 offset:4096
    ds_read_b64_tr_b16 v[72:73], v18 offset:4096
    ds_read_b64_tr_b16 v[74:75], v18 offset:5120
    s_waitcnt lgkmcnt(4)
    v_mfma_f32_32x32x16_bf16 v[20:35], v[52:55], v[68:71], v[20:35]
    v_mfma_f32_32x32x16_bf16 v[36:51], v[56:59], v[68:71], v[36:51]
    ds_read_b128 v[52:55], v16 offset:0
    ds_read_b128 v[56:59], v16 offset:4096
    ds_read_b64_tr_b16 v[68:69], v18 offset:8192
    ds_read_b64_tr_b16 v[70:71], v18 offset:9216
    s_waitcnt lgkmcnt(4)
    v_mfma_f32_32x32x16_bf16 v[20:35], v[60:63], v[72:75], v[20:35]
    v_mfma_f32_32x32x16_bf16 v[36:51], v[64:67], v[72:75], v[36:51]
    ds_read_b128 v[60:63], v17 offset:0
    ds_read_b128 v[64:67], v17 offset:4096
    ds_read_b64_tr_b16 v[72:73], v18 offset:12288
    ds_read_b64_tr_b16 v[74:75], v18 offset:13312
    s_waitcnt lgkmcnt(4)
    v_mfma_f32_32x32x16_bf16 v[20:35], v[52:55], v[68:71], v[20:35]
    v_mfma_f32_32x32x16_bf16 v[36:51], v[56:59], v[68:71], v[36:51]
    s_waitcnt vmcnt(8) lgkmcnt(0)
    s_barrier
    s_add_u32 m0, s28, 98304
    s_add_u32 s27, s29, 896
    buffer_load_dwordx4 v6, s[12:15], s27 offen lds
    s_add_u32 m0, s28, 99328
    s_add_u32 s27, s29, 9088
    buffer_load_dwordx4 v7, s[12:15], s27 offen lds
    s_add_u32 m0, s28, 114688
    s_add_u32 s27, s30, 1376256
    buffer_load_dwordx4 v8, s[16:19], s27 offen lds
    s_add_u32 m0, s28, 115712
    s_add_u32 s27, s30, 1388544
    buffer_load_dwordx4 v8, s[16:19], s27 offen lds
    v_add_u32 v14, 0, v9
    v_add_u32 v15, 0, v10
    v_add_u32 v16, 0, v11
    v_add_u32 v17, 0, v12
    v_add_u32 v18, 0, v13
    ds_read_b128 v[52:55], v14 offset:0
    ds_read_b128 v[56:59], v14 offset:4096
    ds_read_b64_tr_b16 v[68:69], v18 offset:0
    ds_read_b64_tr_b16 v[70:71], v18 offset:1024
    v_mfma_f32_32x32x16_bf16 v[20:35], v[60:63], v[72:75], v[20:35]
    v_mfma_f32_32x32x16_bf16 v[36:51], v[64:67], v[72:75], v[36:51]
    ds_read_b128 v[60:63], v15 offset:0
    ds_read_b128 v[64:67], v15 offset:4096
    ds_read_b64_tr_b16 v[72:73], v18 offset:4096
    ds_read_b64_tr_b16 v[74:75], v18 offset:5120
    s_waitcnt lgkmcnt(4)
    v_mfma_f32_32x32x16_bf16 v[20:35], v[52:55], v[68:71], v[20:35]
    v_mfma_f32_32x32x16_bf16 v[36:51], v[56:59], v[68:71], v[36:51]
    ds_read_b128 v[52:55], v16 offset:0
    ds_read_b128 v[56:59], v16 offset:4096
    ds_read_b64_tr_b16 v[68:69], v18 offset:8192
    ds_read_b64_tr_b16 v[70:71], v18 offset:9216
    s_waitcnt lgkmcnt(4)
    v_mfma_f32_32x32x16_bf16 v[20:35], v[60:63], v[72:75], v[20:35]
    v_mfma_f32_32x32x16_bf16 v[36:51], v[64:67], v[72:75], v[36:51]
    ds_read_b128 v[60:63], v17 offset:0
    ds_read_b128 v[64:67], v17 offset:4096
    ds_read_b64_tr_b16 v[72:73], v18 offset:12288
    ds_read_b64_tr_b16 v[74:75], v18 offset:13312
    s_waitcnt lgkmcnt(4)
    v_mfma_f32_32x32x16_bf16 v[20:35], v[52:55], v[68:71], v[20:35]
    v_mfma_f32_32x32x16_bf16 v[36:51], v[56:59], v[68:71], v[36:51]
    s_waitcnt vmcnt(8) lgkmcnt(0)
    s_barrier
    v_add_u32 v14, 32768, v9
    v_add_u32 v15, 32768, v10
    v_add_u32 v16, 32768, v11
    v_add_u32 v17, 32768, v12
    v_add_u32 v18, 32768, v13
    ds_read_b128 v[52:55], v14 offset:0
    ds_read_b128 v[56:59], v14 offset:4096
    ds_read_b64_tr_b16 v[68:69], v18 offset:0
    ds_read_b64_tr_b16 v[70:71], v18 offset:1024
    v_mfma_f32_32x32x16_bf16 v[20:35], v[60:63], v[72:75], v[20:35]
    v_mfma_f32_32x32x16_bf16 v[36:51], v[64:67], v[72:75], v[36:51]
    ds_read_b128 v[60:63], v15 offset:0
    ds_read_b128 v[64:67], v15 offset:4096
    ds_read_b64_tr_b16 v[72:73], v18 offset:4096
    ds_read_b64_tr_b16 v[74:75], v18 offset:5120
    s_waitcnt lgkmcnt(4)
    v_mfma_f32_32x32x16_bf16 v[20:35], v[52:55], v[68:71], v[20:35]
    v_mfma_f32_32x32x16_bf16 v[36:51], v[56:59], v[68:71], v[36:51]
    ds_read_b128 v[52:55], v16 offset:0
    ds_read_b128 v[56:59], v16 offset:4096
    ds_read_b64_tr_b16 v[68:69], v18 offset:8192
    ds_read_b64_tr_b16 v[70:71], v18 offset:9216
    s_waitcnt lgkmcnt(4)
    v_mfma_f32_32x32x16_bf16 v[20:35], v[60:63], v[72:75], v[20:35]
    v_mfma_f32_32x32x16_bf16 v[36:51], v[64:67], v[72:75], v[36:51]
    ds_read_b128 v[60:63], v17 offset:0
    ds_read_b128 v[64:67], v17 offset:4096
    ds_read_b64_tr_b16 v[72:73], v18 offset:12288
    ds_read_b64_tr_b16 v[74:75], v18 offset:13312
    s_waitcnt lgkmcnt(4)
    v_mfma_f32_32x32x16_bf16 v[20:35], v[52:55], v[68:71], v[20:35]
    v_mfma_f32_32x32x16_bf16 v[36:51], v[56:59], v[68:71], v[36:51]
    s_waitcnt vmcnt(4) lgkmcnt(0)
    s_barrier
    v_add_u32 v14, 65536, v9
    v_add_u32 v15, 65536, v10
    v_add_u32 v16, 65536, v11
    v_add_u32 v17, 65536, v12
    v_add_u32 v18, 65536, v13
    ds_read_b128 v[52:55], v14 offset:0
    ds_read_b128 v[56:59], v14 offset:4096
    ds_read_b64_tr_b16 v[68:69], v18 offset:0
    ds_read_b64_tr_b16 v[70:71], v18 offset:1024
    v_mfma_f32_32x32x16_bf16 v[20:35], v[60:63], v[72:75], v[20:35]
    v_mfma_f32_32x32x16_bf16 v[36:51], v[64:67], v[72:75], v[36:51]
    ds_read_b128 v[60:63], v15 offset:0
    ds_read_b128 v[64:67], v15 offset:4096
    ds_read_b64_tr_b16 v[72:73], v18 offset:4096
    ds_read_b64_tr_b16 v[74:75], v18 offset:5120
    s_waitcnt lgkmcnt(4)
    v_mfma_f32_32x32x16_bf16 v[20:35], v[52:55], v[68:71], v[20:35]
    v_mfma_f32_32x32x16_bf16 v[36:51], v[56:59], v[68:71], v[36:51]
    ds_read_b128 v[52:55], v16 offset:0
    ds_read_b128 v[56:59], v16 offset:4096
    ds_read_b64_tr_b16 v[68:69], v18 offset:8192
    ds_read_b64_tr_b16 v[70:71], v18 offset:9216
    s_waitcnt lgkmcnt(4)
    v_mfma_f32_32x32x16_bf16 v[20:35], v[60:63], v[72:75], v[20:35]
    v_mfma_f32_32x32x16_bf16 v[36:51], v[64:67], v[72:75], v[36:51]
    ds_read_b128 v[60:63], v17 offset:0
    ds_read_b128 v[64:67], v17 offset:4096
    ds_read_b64_tr_b16 v[72:73], v18 offset:12288
    ds_read_b64_tr_b16 v[74:75], v18 offset:13312
    s_waitcnt lgkmcnt(4)
    v_mfma_f32_32x32x16_bf16 v[20:35], v[52:55], v[68:71], v[20:35]
    v_mfma_f32_32x32x16_bf16 v[36:51], v[56:59], v[68:71], v[36:51]
    s_waitcnt vmcnt(0) lgkmcnt(0)
    s_barrier
    v_add_u32 v14, 98304, v9
    v_add_u32 v15, 98304, v10
    v_add_u32 v16, 98304, v11
    v_add_u32 v17, 98304, v12
    v_add_u32 v18, 98304, v13
    ds_read_b128 v[52:55], v14 offset:0
    ds_read_b128 v[56:59], v14 offset:4096
    ds_read_b64_tr_b16 v[68:69], v18 offset:0
    ds_read_b64_tr_b16 v[70:71], v18 offset:1024
    v_mfma_f32_32x32x16_bf16 v[20:35], v[60:63], v[72:75], v[20:35]
    v_mfma_f32_32x32x16_bf16 v[36:51], v[64:67], v[72:75], v[36:51]
    ds_read_b128 v[60:63], v15 offset:0
    ds_read_b128 v[64:67], v15 offset:4096
    ds_read_b64_tr_b16 v[72:73], v18 offset:4096
    ds_read_b64_tr_b16 v[74:75], v18 offset:5120
    s_waitcnt lgkmcnt(4)
    v_mfma_f32_32x32x16_bf16 v[20:35], v[52:55], v[68:71], v[20:35]
    v_mfma_f32_32x32x16_bf16 v[36:51], v[56:59], v[68:71], v[36:51]
    ds_read_b128 v[52:55], v16 offset:0
    ds_read_b128 v[56:59], v16 offset:4096
    ds_read_b64_tr_b16 v[68:69], v18 offset:8192
    ds_read_b64_tr_b16 v[70:71], v18 offset:9216
    s_waitcnt lgkmcnt(4)
    v_mfma_f32_32x32x16_bf16 v[20:35], v[60:63], v[72:75], v[20:35]
    v_mfma_f32_32x32x16_bf16 v[36:51], v[64:67], v[72:75], v[36:51]
    ds_read_b128 v[60:63], v17 offset:0
    ds_read_b128 v[64:67], v17 offset:4096
    ds_read_b64_tr_b16 v[72:73], v18 offset:12288
    ds_read_b64_tr_b16 v[74:75], v18 offset:13312
    s_waitcnt lgkmcnt(4)
    v_mfma_f32_32x32x16_bf16 v[20:35], v[52:55], v[68:71], v[20:35]
    v_mfma_f32_32x32x16_bf16 v[36:51], v[56:59], v[68:71], v[36:51]
    s_waitcnt lgkmcnt(0)
    v_mfma_f32_32x32x16_bf16 v[20:35], v[60:63], v[72:75], v[20:35]
    v_mfma_f32_32x32x16_bf16 v[36:51], v[64:67], v[72:75], v[36:51]
    v_and_b32 v2, 15, v1
    v_lshlrev_b32 v2, 5, v2
    v_lshrrev_b32 v3, 5, v1
    v_lshl_add_u32 v2, v3, 4, v2
    v_bfe_u32 v3, v1, 4, 1
    v_lshl_add_u32 v19, v3, 16, v2
    s_and_b32 s27, s25, 3
    s_lshl_b32 s27, s27, 2
    s_add_u32 s27, s27, s33
    s_lshl_b32 s31, s27, 17
    s_lshl_b32 s27, s24, 3
    s_lshl_b32 s34, s32, 2
    s_add_u32 s27, s27, s34
    s_lshl_b32 s27, s27, 9
    s_add_u32 s31, s31, s27
    s_add_u32 s31, s31, 4194304
    v_cvt_pk_bf16_f32 v76, v20, v21
    v_cvt_pk_bf16_f32 v77, v22, v23
    v_cvt_pk_bf16_f32 v78, v24, v25
    v_cvt_pk_bf16_f32 v79, v26, v27
    v_cvt_pk_bf16_f32 v80, v28, v29
    v_cvt_pk_bf16_f32 v81, v30, v31
    v_cvt_pk_bf16_f32 v82, v32, v33
    v_cvt_pk_bf16_f32 v83, v34, v35
    buffer_store_dwordx4 v[76:79], v19, s[20:23], s31 offen offset:0
    buffer_store_dwordx4 v[80:83], v19, s[20:23], s31 offen offset:512
    v_cvt_pk_bf16_f32 v84, v36, v37
    v_cvt_pk_bf16_f32 v85, v38, v39
    v_cvt_pk_bf16_f32 v86, v40, v41
    v_cvt_pk_bf16_f32 v87, v42, v43
    v_cvt_pk_bf16_f32 v88, v44, v45
    v_cvt_pk_bf16_f32 v89, v46, v47
    v_cvt_pk_bf16_f32 v90, v48, v49
    v_cvt_pk_bf16_f32 v91, v50, v51
    buffer_store_dwordx4 v[84:87], v19, s[20:23], s31 offen offset:1024
    buffer_store_dwordx4 v[88:91], v19, s[20:23], s31 offen offset:1536
    s_endpgm
L_prep:
    s_load_dwordx2 s[4:5], s[0:1], 8
    s_load_dwordx2 s[6:7], s[0:1], 16
    s_load_dwordx2 s[8:9], s[0:1], 0
    s_load_dwordx2 s[10:11], s[0:1], 24
    s_load_dwordx2 s[12:13], s[0:1], 72
    s_load_dwordx2 s[14:15], s[0:1], 96
    v_and_b32 v1, 63, v0
    v_lshrrev_b32 v3, 6, v0
    s_nop 0
    v_readfirstlane_b32 s40, v3
    v_lshlrev_b32 v2, 4, v1
    s_sub_u32 s41, s2, 192
    s_lshl_b32 s41, s41, 5
    s_lshl_b32 s43, s40, 2
    s_add_u32 s42, s41, s43
    s_waitcnt lgkmcnt(0)
    s_mov_b32 s16, s4
    s_and_b32 s17, s5, 0xffff
    s_mov_b32 s18, 2097152
    s_mov_b32 s19, 0x00020000
    s_mov_b32 s20, s6
    s_and_b32 s21, s7, 0xffff
    s_mov_b32 s22, 2097152
    s_mov_b32 s23, 0x00020000
    s_mov_b32 s24, s8
    s_and_b32 s25, s9, 0xffff
    s_mov_b32 s26, 2097152
    s_mov_b32 s27, 0x00020000
    s_mov_b32 s28, s10
    s_and_b32 s29, s11, 0xffff
    s_mov_b32 s30, 4096
    s_mov_b32 s31, 0x00020000
    s_mov_b32 s32, s12
    s_and_b32 s33, s13, 0xffff
    s_mov_b32 s34, 1024
    s_mov_b32 s35, 0x00020000
    s_mov_b32 s36, s14
    s_and_b32 s37, s15, 0xffff
    s_mov_b32 s38, 13631488
    s_mov_b32 s39, 0x00020000
    s_sub_u32 s43, s42, 3
    s_lshl_b32 s43, s43, 10
    s_add_u32 s44, s43, 0
    buffer_load_dwordx4 v[6:9], v2, s[16:19], s44 offen
    s_add_u32 s44, s43, 1024
    buffer_load_dwordx4 v[10:13], v2, s[16:19], s44 offen
    s_add_u32 s44, s43, 2048
    buffer_load_dwordx4 v[14:17], v2, s[16:19], s44 offen
    s_add_u32 s44, s43, 3072
    buffer_load_dwordx4 v[18:21], v2, s[16:19], s44 offen
    s_add_u32 s44, s43, 4096
    buffer_load_dwordx4 v[22:25], v2, s[16:19], s44 offen
    s_add_u32 s44, s43, 5120
    buffer_load_dwordx4 v[26:29], v2, s[16:19], s44 offen
    s_add_u32 s44, s43, 6144
    buffer_load_dwordx4 v[30:33], v2, s[16:19], s44 offen
    v_lshlrev_b32 v3, 6, v1
    buffer_load_dwordx4 v[66:69], v3, s[28:31], 0 offen offset:0
    buffer_load_dwordx4 v[70:73], v3, s[28:31], 0 offen offset:16
    buffer_load_dwordx4 v[74:77], v3, s[28:31], 0 offen offset:32
    buffer_load_dwordx4 v[78:81], v3, s[28:31], 0 offen offset:48
    s_lshl_b32 s43, s42, 10
    s_add_u32 s44, s43, 0
    buffer_load_dwordx4 v[34:37], v2, s[20:23], s44 offen
    s_add_u32 s44, s43, 1024
    buffer_load_dwordx4 v[38:41], v2, s[20:23], s44 offen
    s_add_u32 s44, s43, 2048
    buffer_load_dwordx4 v[42:45], v2, s[20:23], s44 offen
    s_add_u32 s44, s43, 3072
    buffer_load_dwordx4 v[46:49], v2, s[20:23], s44 offen
    s_add_u32 s44, s43, 0
    buffer_load_dwordx4 v[50:53], v2, s[24:27], s44 offen
    s_add_u32 s44, s43, 1024
    buffer_load_dwordx4 v[54:57], v2, s[24:27], s44 offen
    s_add_u32 s44, s43, 2048
    buffer_load_dwordx4 v[58:61], v2, s[24:27], s44 offen
    s_add_u32 s44, s43, 3072
    buffer_load_dwordx4 v[62:65], v2, s[24:27], s44 offen
    buffer_load_dwordx4 v[82:85], v2, s[32:35], 0 offen
    s_waitcnt vmcnt(12)
    v_lshlrev_b32 v86, 16, v66
    v_and_b32 v94, 0xffff0000, v66
    v_lshlrev_b32 v102, 16, v67
    v_and_b32 v110, 0xffff0000, v67
    v_lshlrev_b32 v87, 16, v68
    v_and_b32 v95, 0xffff0000, v68
    v_lshlrev_b32 v103, 16, v69
    v_and_b32 v111, 0xffff0000, v69
    s_waitcnt vmcnt(11)
    v_lshlrev_b32 v88, 16, v70
    v_and_b32 v96, 0xffff0000, v70
    v_lshlrev_b32 v104, 16, v71
    v_and_b32 v112, 0xffff0000, v71
    v_lshlrev_b32 v89, 16, v72
    v_and_b32 v97, 0xffff0000, v72
    v_lshlrev_b32 v105, 16, v73
    v_and_b32 v113, 0xffff0000, v73
    s_waitcnt vmcnt(10)
    v_lshlrev_b32 v90, 16, v74
    v_and_b32 v98, 0xffff0000, v74
    v_lshlrev_b32 v106, 16, v75
    v_and_b32 v114, 0xffff0000, v75
    v_lshlrev_b32 v91, 16, v76
    v_and_b32 v99, 0xffff0000, v76
    v_lshlrev_b32 v107, 16, v77
    v_and_b32 v115, 0xffff0000, v77
    s_waitcnt vmcnt(9)
    v_lshlrev_b32 v92, 16, v78
    v_and_b32 v100, 0xffff0000, v78
    v_lshlrev_b32 v108, 16, v79
    v_and_b32 v116, 0xffff0000, v79
    v_lshlrev_b32 v93, 16, v80
    v_and_b32 v101, 0xffff0000, v80
    v_lshlrev_b32 v109, 16, v81
    v_and_b32 v117, 0xffff0000, v81
    v_lshlrev_b32 v118, 16, v6
    v_and_b32 v119, 0xffff0000, v6
    v_lshlrev_b32 v120, 16, v7
    v_and_b32 v121, 0xffff0000, v7
    v_lshlrev_b32 v122, 16, v8
    v_and_b32 v123, 0xffff0000, v8
    v_lshlrev_b32 v124, 16, v9
    v_and_b32 v125, 0xffff0000, v9
    v_lshlrev_b32 v126, 16, v10
    v_and_b32 v127, 0xffff0000, v10
    v_lshlrev_b32 v128, 16, v11
    v_and_b32 v129, 0xffff0000, v11
    v_lshlrev_b32 v130, 16, v12
    v_and_b32 v131, 0xffff0000, v12
    v_lshlrev_b32 v132, 16, v13
    v_and_b32 v133, 0xffff0000, v13
    v_lshlrev_b32 v134, 16, v14
    v_and_b32 v135, 0xffff0000, v14
    v_lshlrev_b32 v136, 16, v15
    v_and_b32 v137, 0xffff0000, v15
    v_lshlrev_b32 v138, 16, v16
    v_and_b32 v139, 0xffff0000, v16
    v_lshlrev_b32 v140, 16, v17
    v_and_b32 v141, 0xffff0000, v17
    s_lshl_b32 s43, s40, 12
    v_add_u32 v4, s43, v2
    v_lshlrev_b32 v142, 16, v18
    v_and_b32 v143, 0xffff0000, v18
    v_lshlrev_b32 v144, 16, v19
    v_and_b32 v145, 0xffff0000, v19
    v_lshlrev_b32 v146, 16, v20
    v_and_b32 v147, 0xffff0000, v20
    v_lshlrev_b32 v148, 16, v21
    v_and_b32 v149, 0xffff0000, v21
    s_waitcnt vmcnt(8)
    v_lshlrev_b32 v150, 16, v34
    v_and_b32 v151, 0xffff0000, v34
    v_lshlrev_b32 v152, 16, v35
    v_and_b32 v153, 0xffff0000, v35
    v_lshlrev_b32 v154, 16, v36
    v_and_b32 v155, 0xffff0000, v36
    v_lshlrev_b32 v156, 16, v37
    v_and_b32 v157, 0xffff0000, v37
    v_mul_f32 v158, v118, v110
    v_mul_f32 v159, v119, v111
    v_cvt_pk_bf16_f32 v162, v158, v159
    v_lshlrev_b32 v158, 16, v162
    v_and_b32 v159, 0xffff0000, v162
    v_mul_f32 v160, v126, v102
    v_mul_f32 v161, v127, v103
    v_cvt_pk_bf16_f32 v162, v160, v161
    v_lshlrev_b32 v160, 16, v162
    v_and_b32 v161, 0xffff0000, v162
    v_add_f32 v158, v158, v160
    v_add_f32 v159, v159, v161
    v_cvt_pk_bf16_f32 v162, v158, v159
    v_lshlrev_b32 v158, 16, v162
    v_and_b32 v159, 0xffff0000, v162
    v_mul_f32 v160, v134, v94
    v_mul_f32 v161, v135, v95
    v_cvt_pk_bf16_f32 v162, v160, v161
    v_lshlrev_b32 v160, 16, v162
    v_and_b32 v161, 0xffff0000, v162
    v_add_f32 v158, v158, v160
    v_add_f32 v159, v159, v161
    v_cvt_pk_bf16_f32 v162, v158, v159
    v_lshlrev_b32 v158, 16, v162
    v_and_b32 v159, 0xffff0000, v162
    v_mul_f32 v160, v142, v86
    v_mul_f32 v161, v143, v87
    v_cvt_pk_bf16_f32 v162, v160, v161
    v_lshlrev_b32 v160, 16, v162
    v_and_b32 v161, 0xffff0000, v162
    v_add_f32 v158, v158, v160
    v_add_f32 v159, v159, v161
    v_cvt_pk_bf16_f32 v162, v158, v159
    v_lshlrev_b32 v158, 16, v162
    v_and_b32 v159, 0xffff0000, v162
    v_mul_f32 v158, v158, v150
    v_mul_f32 v159, v159, v151
    v_cvt_pk_bf16_f32 v164, v158, v159
    v_mul_f32 v158, v120, v112
    v_mul_f32 v159, v121, v113
    v_cvt_pk_bf16_f32 v162, v158, v159
    v_lshlrev_b32 v158, 16, v162
    v_and_b32 v159, 0xffff0000, v162
    v_mul_f32 v160, v128, v104
    v_mul_f32 v161, v129, v105
    v_cvt_pk_bf16_f32 v162, v160, v161
    v_lshlrev_b32 v160, 16, v162
    v_and_b32 v161, 0xffff0000, v162
    v_add_f32 v158, v158, v160
    v_add_f32 v159, v159, v161
    v_cvt_pk_bf16_f32 v162, v158, v159
    v_lshlrev_b32 v158, 16, v162
    v_and_b32 v159, 0xffff0000, v162
    v_mul_f32 v160, v136, v96
    v_mul_f32 v161, v137, v97
    v_cvt_pk_bf16_f32 v162, v160, v161
    v_lshlrev_b32 v160, 16, v162
    v_and_b32 v161, 0xffff0000, v162
    v_add_f32 v158, v158, v160
    v_add_f32 v159, v159, v161
    v_cvt_pk_bf16_f32 v162, v158, v159
    v_lshlrev_b32 v158, 16, v162
    v_and_b32 v159, 0xffff0000, v162
    v_mul_f32 v160, v144, v88
    v_mul_f32 v161, v145, v89
    v_cvt_pk_bf16_f32 v162, v160, v161
    v_lshlrev_b32 v160, 16, v162
    v_and_b32 v161, 0xffff0000, v162
    v_add_f32 v158, v158, v160
    v_add_f32 v159, v159, v161
    v_cvt_pk_bf16_f32 v162, v158, v159
    v_lshlrev_b32 v158, 16, v162
    v_and_b32 v159, 0xffff0000, v162
    v_mul_f32 v158, v158, v152
    v_mul_f32 v159, v159, v153
    v_cvt_pk_bf16_f32 v165, v158, v159
    v_mul_f32 v158, v122, v114
    v_mul_f32 v159, v123, v115
    v_cvt_pk_bf16_f32 v162, v158, v159
    v_lshlrev_b32 v158, 16, v162
    v_and_b32 v159, 0xffff0000, v162
    v_mul_f32 v160, v130, v106
    v_mul_f32 v161, v131, v107
    v_cvt_pk_bf16_f32 v162, v160, v161
    v_lshlrev_b32 v160, 16, v162
    v_and_b32 v161, 0xffff0000, v162
    v_add_f32 v158, v158, v160
    v_add_f32 v159, v159, v161
    v_cvt_pk_bf16_f32 v162, v158, v159
    v_lshlrev_b32 v158, 16, v162
    v_and_b32 v159, 0xffff0000, v162
    v_mul_f32 v160, v138, v98
    v_mul_f32 v161, v139, v99
    v_cvt_pk_bf16_f32 v162, v160, v161
    v_lshlrev_b32 v160, 16, v162
    v_and_b32 v161, 0xffff0000, v162
    v_add_f32 v158, v158, v160
    v_add_f32 v159, v159, v161
    v_cvt_pk_bf16_f32 v162, v158, v159
    v_lshlrev_b32 v158, 16, v162
    v_and_b32 v159, 0xffff0000, v162
    v_mul_f32 v160, v146, v90
    v_mul_f32 v161, v147, v91
    v_cvt_pk_bf16_f32 v162, v160, v161
    v_lshlrev_b32 v160, 16, v162
    v_and_b32 v161, 0xffff0000, v162
    v_add_f32 v158, v158, v160
    v_add_f32 v159, v159, v161
    v_cvt_pk_bf16_f32 v162, v158, v159
    v_lshlrev_b32 v158, 16, v162
    v_and_b32 v159, 0xffff0000, v162
    v_mul_f32 v158, v158, v154
    v_mul_f32 v159, v159, v155
    v_cvt_pk_bf16_f32 v166, v158, v159
    v_mul_f32 v158, v124, v116
    v_mul_f32 v159, v125, v117
    v_cvt_pk_bf16_f32 v162, v158, v159
    v_lshlrev_b32 v158, 16, v162
    v_and_b32 v159, 0xffff0000, v162
    v_mul_f32 v160, v132, v108
    v_mul_f32 v161, v133, v109
    v_cvt_pk_bf16_f32 v162, v160, v161
    v_lshlrev_b32 v160, 16, v162
    v_and_b32 v161, 0xffff0000, v162
    v_add_f32 v158, v158, v160
    v_add_f32 v159, v159, v161
    v_cvt_pk_bf16_f32 v162, v158, v159
    v_lshlrev_b32 v158, 16, v162
    v_and_b32 v159, 0xffff0000, v162
    v_mul_f32 v160, v140, v100
    v_mul_f32 v161, v141, v101
    v_cvt_pk_bf16_f32 v162, v160, v161
    v_lshlrev_b32 v160, 16, v162
    v_and_b32 v161, 0xffff0000, v162
    v_add_f32 v158, v158, v160
    v_add_f32 v159, v159, v161
    v_cvt_pk_bf16_f32 v162, v158, v159
    v_lshlrev_b32 v158, 16, v162
    v_and_b32 v159, 0xffff0000, v162
    v_mul_f32 v160, v148, v92
    v_mul_f32 v161, v149, v93
    v_cvt_pk_bf16_f32 v162, v160, v161
    v_lshlrev_b32 v160, 16, v162
    v_and_b32 v161, 0xffff0000, v162
    v_add_f32 v158, v158, v160
    v_add_f32 v159, v159, v161
    v_cvt_pk_bf16_f32 v162, v158, v159
    v_lshlrev_b32 v158, 16, v162
    v_and_b32 v159, 0xffff0000, v162
    v_mul_f32 v158, v158, v156
    v_mul_f32 v159, v159, v157
    v_cvt_pk_bf16_f32 v167, v158, v159
    ds_write_b128 v4, v[164:167] offset:0
    v_lshlrev_b32 v118, 16, v22
    v_and_b32 v119, 0xffff0000, v22
    v_lshlrev_b32 v120, 16, v23
    v_and_b32 v121, 0xffff0000, v23
    v_lshlrev_b32 v122, 16, v24
    v_and_b32 v123, 0xffff0000, v24
    v_lshlrev_b32 v124, 16, v25
    v_and_b32 v125, 0xffff0000, v25
    s_waitcnt vmcnt(7)
    v_lshlrev_b32 v150, 16, v38
    v_and_b32 v151, 0xffff0000, v38
    v_lshlrev_b32 v152, 16, v39
    v_and_b32 v153, 0xffff0000, v39
    v_lshlrev_b32 v154, 16, v40
    v_and_b32 v155, 0xffff0000, v40
    v_lshlrev_b32 v156, 16, v41
    v_and_b32 v157, 0xffff0000, v41
    v_mul_f32 v158, v126, v110
    v_mul_f32 v159, v127, v111
    v_cvt_pk_bf16_f32 v162, v158, v159
    v_lshlrev_b32 v158, 16, v162
    v_and_b32 v159, 0xffff0000, v162
    v_mul_f32 v160, v134, v102
    v_mul_f32 v161, v135, v103
    v_cvt_pk_bf16_f32 v162, v160, v161
    v_lshlrev_b32 v160, 16, v162
    v_and_b32 v161, 0xffff0000, v162
    v_add_f32 v158, v158, v160
    v_add_f32 v159, v159, v161
    v_cvt_pk_bf16_f32 v162, v158, v159
    v_lshlrev_b32 v158, 16, v162
    v_and_b32 v159, 0xffff0000, v162
    v_mul_f32 v160, v142, v94
    v_mul_f32 v161, v143, v95
    v_cvt_pk_bf16_f32 v162, v160, v161
    v_lshlrev_b32 v160, 16, v162
    v_and_b32 v161, 0xffff0000, v162
    v_add_f32 v158, v158, v160
    v_add_f32 v159, v159, v161
    v_cvt_pk_bf16_f32 v162, v158, v159
    v_lshlrev_b32 v158, 16, v162
    v_and_b32 v159, 0xffff0000, v162
    v_mul_f32 v160, v118, v86
    v_mul_f32 v161, v119, v87
    v_cvt_pk_bf16_f32 v162, v160, v161
    v_lshlrev_b32 v160, 16, v162
    v_and_b32 v161, 0xffff0000, v162
    v_add_f32 v158, v158, v160
    v_add_f32 v159, v159, v161
    v_cvt_pk_bf16_f32 v162, v158, v159
    v_lshlrev_b32 v158, 16, v162
    v_and_b32 v159, 0xffff0000, v162
    v_mul_f32 v158, v158, v150
    v_mul_f32 v159, v159, v151
    v_cvt_pk_bf16_f32 v164, v158, v159
    v_mul_f32 v158, v128, v112
    v_mul_f32 v159, v129, v113
    v_cvt_pk_bf16_f32 v162, v158, v159
    v_lshlrev_b32 v158, 16, v162
    v_and_b32 v159, 0xffff0000, v162
    v_mul_f32 v160, v136, v104
    v_mul_f32 v161, v137, v105
    v_cvt_pk_bf16_f32 v162, v160, v161
    v_lshlrev_b32 v160, 16, v162
    v_and_b32 v161, 0xffff0000, v162
    v_add_f32 v158, v158, v160
    v_add_f32 v159, v159, v161
    v_cvt_pk_bf16_f32 v162, v158, v159
    v_lshlrev_b32 v158, 16, v162
    v_and_b32 v159, 0xffff0000, v162
    v_mul_f32 v160, v144, v96
    v_mul_f32 v161, v145, v97
    v_cvt_pk_bf16_f32 v162, v160, v161
    v_lshlrev_b32 v160, 16, v162
    v_and_b32 v161, 0xffff0000, v162
    v_add_f32 v158, v158, v160
    v_add_f32 v159, v159, v161
    v_cvt_pk_bf16_f32 v162, v158, v159
    v_lshlrev_b32 v158, 16, v162
    v_and_b32 v159, 0xffff0000, v162
    v_mul_f32 v160, v120, v88
    v_mul_f32 v161, v121, v89
    v_cvt_pk_bf16_f32 v162, v160, v161
    v_lshlrev_b32 v160, 16, v162
    v_and_b32 v161, 0xffff0000, v162
    v_add_f32 v158, v158, v160
    v_add_f32 v159, v159, v161
    v_cvt_pk_bf16_f32 v162, v158, v159
    v_lshlrev_b32 v158, 16, v162
    v_and_b32 v159, 0xffff0000, v162
    v_mul_f32 v158, v158, v152
    v_mul_f32 v159, v159, v153
    v_cvt_pk_bf16_f32 v165, v158, v159
    v_mul_f32 v158, v130, v114
    v_mul_f32 v159, v131, v115
    v_cvt_pk_bf16_f32 v162, v158, v159
    v_lshlrev_b32 v158, 16, v162
    v_and_b32 v159, 0xffff0000, v162
    v_mul_f32 v160, v138, v106
    v_mul_f32 v161, v139, v107
    v_cvt_pk_bf16_f32 v162, v160, v161
    v_lshlrev_b32 v160, 16, v162
    v_and_b32 v161, 0xffff0000, v162
    v_add_f32 v158, v158, v160
    v_add_f32 v159, v159, v161
    v_cvt_pk_bf16_f32 v162, v158, v159
    v_lshlrev_b32 v158, 16, v162
    v_and_b32 v159, 0xffff0000, v162
    v_mul_f32 v160, v146, v98
    v_mul_f32 v161, v147, v99
    v_cvt_pk_bf16_f32 v162, v160, v161
    v_lshlrev_b32 v160, 16, v162
    v_and_b32 v161, 0xffff0000, v162
    v_add_f32 v158, v158, v160
    v_add_f32 v159, v159, v161
    v_cvt_pk_bf16_f32 v162, v158, v159
    v_lshlrev_b32 v158, 16, v162
    v_and_b32 v159, 0xffff0000, v162
    v_mul_f32 v160, v122, v90
    v_mul_f32 v161, v123, v91
    v_cvt_pk_bf16_f32 v162, v160, v161
    v_lshlrev_b32 v160, 16, v162
    v_and_b32 v161, 0xffff0000, v162
    v_add_f32 v158, v158, v160
    v_add_f32 v159, v159, v161
    v_cvt_pk_bf16_f32 v162, v158, v159
    v_lshlrev_b32 v158, 16, v162
    v_and_b32 v159, 0xffff0000, v162
    v_mul_f32 v158, v158, v154
    v_mul_f32 v159, v159, v155
    v_cvt_pk_bf16_f32 v166, v158, v159
    v_mul_f32 v158, v132, v116
    v_mul_f32 v159, v133, v117
    v_cvt_pk_bf16_f32 v162, v158, v159
    v_lshlrev_b32 v158, 16, v162
    v_and_b32 v159, 0xffff0000, v162
    v_mul_f32 v160, v140, v108
    v_mul_f32 v161, v141, v109
    v_cvt_pk_bf16_f32 v162, v160, v161
    v_lshlrev_b32 v160, 16, v162
    v_and_b32 v161, 0xffff0000, v162
    v_add_f32 v158, v158, v160
    v_add_f32 v159, v159, v161
    v_cvt_pk_bf16_f32 v162, v158, v159
    v_lshlrev_b32 v158, 16, v162
    v_and_b32 v159, 0xffff0000, v162
    v_mul_f32 v160, v148, v100
    v_mul_f32 v161, v149, v101
    v_cvt_pk_bf16_f32 v162, v160, v161
    v_lshlrev_b32 v160, 16, v162
    v_and_b32 v161, 0xffff0000, v162
    v_add_f32 v158, v158, v160
    v_add_f32 v159, v159, v161
    v_cvt_pk_bf16_f32 v162, v158, v159
    v_lshlrev_b32 v158, 16, v162
    v_and_b32 v159, 0xffff0000, v162
    v_mul_f32 v160, v124, v92
    v_mul_f32 v161, v125, v93
    v_cvt_pk_bf16_f32 v162, v160, v161
    v_lshlrev_b32 v160, 16, v162
    v_and_b32 v161, 0xffff0000, v162
    v_add_f32 v158, v158, v160
    v_add_f32 v159, v159, v161
    v_cvt_pk_bf16_f32 v162, v158, v159
    v_lshlrev_b32 v158, 16, v162
    v_and_b32 v159, 0xffff0000, v162
    v_mul_f32 v158, v158, v156
    v_mul_f32 v159, v159, v157
    v_cvt_pk_bf16_f32 v167, v158, v159
    ds_write_b128 v4, v[164:167] offset:1024
    v_lshlrev_b32 v126, 16, v26
    v_and_b32 v127, 0xffff0000, v26
    v_lshlrev_b32 v128, 16, v27
    v_and_b32 v129, 0xffff0000, v27
    v_lshlrev_b32 v130, 16, v28
    v_and_b32 v131, 0xffff0000, v28
    v_lshlrev_b32 v132, 16, v29
    v_and_b32 v133, 0xffff0000, v29
    s_waitcnt vmcnt(6)
    v_lshlrev_b32 v150, 16, v42
    v_and_b32 v151, 0xffff0000, v42
    v_lshlrev_b32 v152, 16, v43
    v_and_b32 v153, 0xffff0000, v43
    v_lshlrev_b32 v154, 16, v44
    v_and_b32 v155, 0xffff0000, v44
    v_lshlrev_b32 v156, 16, v45
    v_and_b32 v157, 0xffff0000, v45
    v_mul_f32 v158, v134, v110
    v_mul_f32 v159, v135, v111
    v_cvt_pk_bf16_f32 v162, v158, v159
    v_lshlrev_b32 v158, 16, v162
    v_and_b32 v159, 0xffff0000, v162
    v_mul_f32 v160, v142, v102
    v_mul_f32 v161, v143, v103
    v_cvt_pk_bf16_f32 v162, v160, v161
    v_lshlrev_b32 v160, 16, v162
    v_and_b32 v161, 0xffff0000, v162
    v_add_f32 v158, v158, v160
    v_add_f32 v159, v159, v161
    v_cvt_pk_bf16_f32 v162, v158, v159
    v_lshlrev_b32 v158, 16, v162
    v_and_b32 v159, 0xffff0000, v162
    v_mul_f32 v160, v118, v94
    v_mul_f32 v161, v119, v95
    v_cvt_pk_bf16_f32 v162, v160, v161
    v_lshlrev_b32 v160, 16, v162
    v_and_b32 v161, 0xffff0000, v162
    v_add_f32 v158, v158, v160
    v_add_f32 v159, v159, v161
    v_cvt_pk_bf16_f32 v162, v158, v159
    v_lshlrev_b32 v158, 16, v162
    v_and_b32 v159, 0xffff0000, v162
    v_mul_f32 v160, v126, v86
    v_mul_f32 v161, v127, v87
    v_cvt_pk_bf16_f32 v162, v160, v161
    v_lshlrev_b32 v160, 16, v162
    v_and_b32 v161, 0xffff0000, v162
    v_add_f32 v158, v158, v160
    v_add_f32 v159, v159, v161
    v_cvt_pk_bf16_f32 v162, v158, v159
    v_lshlrev_b32 v158, 16, v162
    v_and_b32 v159, 0xffff0000, v162
    v_mul_f32 v158, v158, v150
    v_mul_f32 v159, v159, v151
    v_cvt_pk_bf16_f32 v164, v158, v159
    v_mul_f32 v158, v136, v112
    v_mul_f32 v159, v137, v113
    v_cvt_pk_bf16_f32 v162, v158, v159
    v_lshlrev_b32 v158, 16, v162
    v_and_b32 v159, 0xffff0000, v162
    v_mul_f32 v160, v144, v104
    v_mul_f32 v161, v145, v105
    v_cvt_pk_bf16_f32 v162, v160, v161
    v_lshlrev_b32 v160, 16, v162
    v_and_b32 v161, 0xffff0000, v162
    v_add_f32 v158, v158, v160
    v_add_f32 v159, v159, v161
    v_cvt_pk_bf16_f32 v162, v158, v159
    v_lshlrev_b32 v158, 16, v162
    v_and_b32 v159, 0xffff0000, v162
    v_mul_f32 v160, v120, v96
    v_mul_f32 v161, v121, v97
    v_cvt_pk_bf16_f32 v162, v160, v161
    v_lshlrev_b32 v160, 16, v162
    v_and_b32 v161, 0xffff0000, v162
    v_add_f32 v158, v158, v160
    v_add_f32 v159, v159, v161
    v_cvt_pk_bf16_f32 v162, v158, v159
    v_lshlrev_b32 v158, 16, v162
    v_and_b32 v159, 0xffff0000, v162
    v_mul_f32 v160, v128, v88
    v_mul_f32 v161, v129, v89
    v_cvt_pk_bf16_f32 v162, v160, v161
    v_lshlrev_b32 v160, 16, v162
    v_and_b32 v161, 0xffff0000, v162
    v_add_f32 v158, v158, v160
    v_add_f32 v159, v159, v161
    v_cvt_pk_bf16_f32 v162, v158, v159
    v_lshlrev_b32 v158, 16, v162
    v_and_b32 v159, 0xffff0000, v162
    v_mul_f32 v158, v158, v152
    v_mul_f32 v159, v159, v153
    v_cvt_pk_bf16_f32 v165, v158, v159
    v_mul_f32 v158, v138, v114
    v_mul_f32 v159, v139, v115
    v_cvt_pk_bf16_f32 v162, v158, v159
    v_lshlrev_b32 v158, 16, v162
    v_and_b32 v159, 0xffff0000, v162
    v_mul_f32 v160, v146, v106
    v_mul_f32 v161, v147, v107
    v_cvt_pk_bf16_f32 v162, v160, v161
    v_lshlrev_b32 v160, 16, v162
    v_and_b32 v161, 0xffff0000, v162
    v_add_f32 v158, v158, v160
    v_add_f32 v159, v159, v161
    v_cvt_pk_bf16_f32 v162, v158, v159
    v_lshlrev_b32 v158, 16, v162
    v_and_b32 v159, 0xffff0000, v162
    v_mul_f32 v160, v122, v98
    v_mul_f32 v161, v123, v99
    v_cvt_pk_bf16_f32 v162, v160, v161
    v_lshlrev_b32 v160, 16, v162
    v_and_b32 v161, 0xffff0000, v162
    v_add_f32 v158, v158, v160
    v_add_f32 v159, v159, v161
    v_cvt_pk_bf16_f32 v162, v158, v159
    v_lshlrev_b32 v158, 16, v162
    v_and_b32 v159, 0xffff0000, v162
    v_mul_f32 v160, v130, v90
    v_mul_f32 v161, v131, v91
    v_cvt_pk_bf16_f32 v162, v160, v161
    v_lshlrev_b32 v160, 16, v162
    v_and_b32 v161, 0xffff0000, v162
    v_add_f32 v158, v158, v160
    v_add_f32 v159, v159, v161
    v_cvt_pk_bf16_f32 v162, v158, v159
    v_lshlrev_b32 v158, 16, v162
    v_and_b32 v159, 0xffff0000, v162
    v_mul_f32 v158, v158, v154
    v_mul_f32 v159, v159, v155
    v_cvt_pk_bf16_f32 v166, v158, v159
    v_mul_f32 v158, v140, v116
    v_mul_f32 v159, v141, v117
    v_cvt_pk_bf16_f32 v162, v158, v159
    v_lshlrev_b32 v158, 16, v162
    v_and_b32 v159, 0xffff0000, v162
    v_mul_f32 v160, v148, v108
    v_mul_f32 v161, v149, v109
    v_cvt_pk_bf16_f32 v162, v160, v161
    v_lshlrev_b32 v160, 16, v162
    v_and_b32 v161, 0xffff0000, v162
    v_add_f32 v158, v158, v160
    v_add_f32 v159, v159, v161
    v_cvt_pk_bf16_f32 v162, v158, v159
    v_lshlrev_b32 v158, 16, v162
    v_and_b32 v159, 0xffff0000, v162
    v_mul_f32 v160, v124, v100
    v_mul_f32 v161, v125, v101
    v_cvt_pk_bf16_f32 v162, v160, v161
    v_lshlrev_b32 v160, 16, v162
    v_and_b32 v161, 0xffff0000, v162
    v_add_f32 v158, v158, v160
    v_add_f32 v159, v159, v161
    v_cvt_pk_bf16_f32 v162, v158, v159
    v_lshlrev_b32 v158, 16, v162
    v_and_b32 v159, 0xffff0000, v162
    v_mul_f32 v160, v132, v92
    v_mul_f32 v161, v133, v93
    v_cvt_pk_bf16_f32 v162, v160, v161
    v_lshlrev_b32 v160, 16, v162
    v_and_b32 v161, 0xffff0000, v162
    v_add_f32 v158, v158, v160
    v_add_f32 v159, v159, v161
    v_cvt_pk_bf16_f32 v162, v158, v159
    v_lshlrev_b32 v158, 16, v162
    v_and_b32 v159, 0xffff0000, v162
    v_mul_f32 v158, v158, v156
    v_mul_f32 v159, v159, v157
    v_cvt_pk_bf16_f32 v167, v158, v159
    ds_write_b128 v4, v[164:167] offset:2048
    v_lshlrev_b32 v134, 16, v30
    v_and_b32 v135, 0xffff0000, v30
    v_lshlrev_b32 v136, 16, v31
    v_and_b32 v137, 0xffff0000, v31
    v_lshlrev_b32 v138, 16, v32
    v_and_b32 v139, 0xffff0000, v32
    v_lshlrev_b32 v140, 16, v33
    v_and_b32 v141, 0xffff0000, v33
    s_waitcnt vmcnt(5)
    v_lshlrev_b32 v150, 16, v46
    v_and_b32 v151, 0xffff0000, v46
    v_lshlrev_b32 v152, 16, v47
    v_and_b32 v153, 0xffff0000, v47
    v_lshlrev_b32 v154, 16, v48
    v_and_b32 v155, 0xffff0000, v48
    v_lshlrev_b32 v156, 16, v49
    v_and_b32 v157, 0xffff0000, v49
    v_mul_f32 v158, v142, v110
    v_mul_f32 v159, v143, v111
    v_cvt_pk_bf16_f32 v162, v158, v159
    v_lshlrev_b32 v158, 16, v162
    v_and_b32 v159, 0xffff0000, v162
    v_mul_f32 v160, v118, v102
    v_mul_f32 v161, v119, v103
    v_cvt_pk_bf16_f32 v162, v160, v161
    v_lshlrev_b32 v160, 16, v162
    v_and_b32 v161, 0xffff0000, v162
    v_add_f32 v158, v158, v160
    v_add_f32 v159, v159, v161
    v_cvt_pk_bf16_f32 v162, v158, v159
    v_lshlrev_b32 v158, 16, v162
    v_and_b32 v159, 0xffff0000, v162
    v_mul_f32 v160, v126, v94
    v_mul_f32 v161, v127, v95
    v_cvt_pk_bf16_f32 v162, v160, v161
    v_lshlrev_b32 v160, 16, v162
    v_and_b32 v161, 0xffff0000, v162
    v_add_f32 v158, v158, v160
    v_add_f32 v159, v159, v161
    v_cvt_pk_bf16_f32 v162, v158, v159
    v_lshlrev_b32 v158, 16, v162
    v_and_b32 v159, 0xffff0000, v162
    v_mul_f32 v160, v134, v86
    v_mul_f32 v161, v135, v87
    v_cvt_pk_bf16_f32 v162, v160, v161
    v_lshlrev_b32 v160, 16, v162
    v_and_b32 v161, 0xffff0000, v162
    v_add_f32 v158, v158, v160
    v_add_f32 v159, v159, v161
    v_cvt_pk_bf16_f32 v162, v158, v159
    v_lshlrev_b32 v158, 16, v162
    v_and_b32 v159, 0xffff0000, v162
    v_mul_f32 v158, v158, v150
    v_mul_f32 v159, v159, v151
    v_cvt_pk_bf16_f32 v164, v158, v159
    v_mul_f32 v158, v144, v112
    v_mul_f32 v159, v145, v113
    v_cvt_pk_bf16_f32 v162, v158, v159
    v_lshlrev_b32 v158, 16, v162
    v_and_b32 v159, 0xffff0000, v162
    v_mul_f32 v160, v120, v104
    v_mul_f32 v161, v121, v105
    v_cvt_pk_bf16_f32 v162, v160, v161
    v_lshlrev_b32 v160, 16, v162
    v_and_b32 v161, 0xffff0000, v162
    v_add_f32 v158, v158, v160
    v_add_f32 v159, v159, v161
    v_cvt_pk_bf16_f32 v162, v158, v159
    v_lshlrev_b32 v158, 16, v162
    v_and_b32 v159, 0xffff0000, v162
    v_mul_f32 v160, v128, v96
    v_mul_f32 v161, v129, v97
    v_cvt_pk_bf16_f32 v162, v160, v161
    v_lshlrev_b32 v160, 16, v162
    v_and_b32 v161, 0xffff0000, v162
    v_add_f32 v158, v158, v160
    v_add_f32 v159, v159, v161
    v_cvt_pk_bf16_f32 v162, v158, v159
    v_lshlrev_b32 v158, 16, v162
    v_and_b32 v159, 0xffff0000, v162
    v_mul_f32 v160, v136, v88
    v_mul_f32 v161, v137, v89
    v_cvt_pk_bf16_f32 v162, v160, v161
    v_lshlrev_b32 v160, 16, v162
    v_and_b32 v161, 0xffff0000, v162
    v_add_f32 v158, v158, v160
    v_add_f32 v159, v159, v161
    v_cvt_pk_bf16_f32 v162, v158, v159
    v_lshlrev_b32 v158, 16, v162
    v_and_b32 v159, 0xffff0000, v162
    v_mul_f32 v158, v158, v152
    v_mul_f32 v159, v159, v153
    v_cvt_pk_bf16_f32 v165, v158, v159
    v_mul_f32 v158, v146, v114
    v_mul_f32 v159, v147, v115
    v_cvt_pk_bf16_f32 v162, v158, v159
    v_lshlrev_b32 v158, 16, v162
    v_and_b32 v159, 0xffff0000, v162
    v_mul_f32 v160, v122, v106
    v_mul_f32 v161, v123, v107
    v_cvt_pk_bf16_f32 v162, v160, v161
    v_lshlrev_b32 v160, 16, v162
    v_and_b32 v161, 0xffff0000, v162
    v_add_f32 v158, v158, v160
    v_add_f32 v159, v159, v161
    v_cvt_pk_bf16_f32 v162, v158, v159
    v_lshlrev_b32 v158, 16, v162
    v_and_b32 v159, 0xffff0000, v162
    v_mul_f32 v160, v130, v98
    v_mul_f32 v161, v131, v99
    v_cvt_pk_bf16_f32 v162, v160, v161
    v_lshlrev_b32 v160, 16, v162
    v_and_b32 v161, 0xffff0000, v162
    v_add_f32 v158, v158, v160
    v_add_f32 v159, v159, v161
    v_cvt_pk_bf16_f32 v162, v158, v159
    v_lshlrev_b32 v158, 16, v162
    v_and_b32 v159, 0xffff0000, v162
    v_mul_f32 v160, v138, v90
    v_mul_f32 v161, v139, v91
    v_cvt_pk_bf16_f32 v162, v160, v161
    v_lshlrev_b32 v160, 16, v162
    v_and_b32 v161, 0xffff0000, v162
    v_add_f32 v158, v158, v160
    v_add_f32 v159, v159, v161
    v_cvt_pk_bf16_f32 v162, v158, v159
    v_lshlrev_b32 v158, 16, v162
    v_and_b32 v159, 0xffff0000, v162
    v_mul_f32 v158, v158, v154
    v_mul_f32 v159, v159, v155
    v_cvt_pk_bf16_f32 v166, v158, v159
    v_mul_f32 v158, v148, v116
    v_mul_f32 v159, v149, v117
    v_cvt_pk_bf16_f32 v162, v158, v159
    v_lshlrev_b32 v158, 16, v162
    v_and_b32 v159, 0xffff0000, v162
    v_mul_f32 v160, v124, v108
    v_mul_f32 v161, v125, v109
    v_cvt_pk_bf16_f32 v162, v160, v161
    v_lshlrev_b32 v160, 16, v162
    v_and_b32 v161, 0xffff0000, v162
    v_add_f32 v158, v158, v160
    v_add_f32 v159, v159, v161
    v_cvt_pk_bf16_f32 v162, v158, v159
    v_lshlrev_b32 v158, 16, v162
    v_and_b32 v159, 0xffff0000, v162
    v_mul_f32 v160, v132, v100
    v_mul_f32 v161, v133, v101
    v_cvt_pk_bf16_f32 v162, v160, v161
    v_lshlrev_b32 v160, 16, v162
    v_and_b32 v161, 0xffff0000, v162
    v_add_f32 v158, v158, v160
    v_add_f32 v159, v159, v161
    v_cvt_pk_bf16_f32 v162, v158, v159
    v_lshlrev_b32 v158, 16, v162
    v_and_b32 v159, 0xffff0000, v162
    v_mul_f32 v160, v140, v92
    v_mul_f32 v161, v141, v93
    v_cvt_pk_bf16_f32 v162, v160, v161
    v_lshlrev_b32 v160, 16, v162
    v_and_b32 v161, 0xffff0000, v162
    v_add_f32 v158, v158, v160
    v_add_f32 v159, v159, v161
    v_cvt_pk_bf16_f32 v162, v158, v159
    v_lshlrev_b32 v158, 16, v162
    v_and_b32 v159, 0xffff0000, v162
    v_mul_f32 v158, v158, v156
    v_mul_f32 v159, v159, v157
    v_cvt_pk_bf16_f32 v167, v158, v159
    ds_write_b128 v4, v[164:167] offset:3072
    s_waitcnt vmcnt(0)
    v_lshlrev_b32 v118, 16, v82
    v_and_b32 v119, 0xffff0000, v82
    v_lshlrev_b32 v120, 16, v83
    v_and_b32 v121, 0xffff0000, v83
    v_lshlrev_b32 v122, 16, v84
    v_and_b32 v123, 0xffff0000, v84
    v_lshlrev_b32 v124, 16, v85
    v_and_b32 v125, 0xffff0000, v85
    v_lshlrev_b32 v150, 16, v50
    v_and_b32 v151, 0xffff0000, v50
    v_lshlrev_b32 v152, 16, v51
    v_and_b32 v153, 0xffff0000, v51
    v_lshlrev_b32 v154, 16, v52
    v_and_b32 v155, 0xffff0000, v52
    v_lshlrev_b32 v156, 16, v53
    v_and_b32 v157, 0xffff0000, v53
    v_mul_f32 v158, v150, v118
    v_mul_f32 v159, v151, v119
    v_cvt_pk_bf16_f32 v162, v158, v159
    v_lshlrev_b32 v158, 16, v162
    v_and_b32 v159, 0xffff0000, v162
    v_add_f32 v168, v158, v159
    v_mul_f32 v158, v152, v120
    v_mul_f32 v159, v153, v121
    v_cvt_pk_bf16_f32 v162, v158, v159
    v_lshlrev_b32 v158, 16, v162
    v_and_b32 v159, 0xffff0000, v162
    v_add_f32 v168, v168, v158
    v_add_f32 v168, v168, v159
    v_mul_f32 v158, v154, v122
    v_mul_f32 v159, v155, v123
    v_cvt_pk_bf16_f32 v162, v158, v159
    v_lshlrev_b32 v158, 16, v162
    v_and_b32 v159, 0xffff0000, v162
    v_add_f32 v168, v168, v158
    v_add_f32 v168, v168, v159
    v_mul_f32 v158, v156, v124
    v_mul_f32 v159, v157, v125
    v_cvt_pk_bf16_f32 v162, v158, v159
    v_lshlrev_b32 v158, 16, v162
    v_and_b32 v159, 0xffff0000, v162
    v_add_f32 v168, v168, v158
    v_add_f32 v168, v168, v159
    v_lshlrev_b32 v150, 16, v54
    v_and_b32 v151, 0xffff0000, v54
    v_lshlrev_b32 v152, 16, v55
    v_and_b32 v153, 0xffff0000, v55
    v_lshlrev_b32 v154, 16, v56
    v_and_b32 v155, 0xffff0000, v56
    v_lshlrev_b32 v156, 16, v57
    v_and_b32 v157, 0xffff0000, v57
    v_mul_f32 v158, v150, v118
    v_mul_f32 v159, v151, v119
    v_cvt_pk_bf16_f32 v162, v158, v159
    v_lshlrev_b32 v158, 16, v162
    v_and_b32 v159, 0xffff0000, v162
    v_add_f32 v169, v158, v159
    v_mul_f32 v158, v152, v120
    v_mul_f32 v159, v153, v121
    v_cvt_pk_bf16_f32 v162, v158, v159
    v_lshlrev_b32 v158, 16, v162
    v_and_b32 v159, 0xffff0000, v162
    v_add_f32 v169, v169, v158
    v_add_f32 v169, v169, v159
    v_mul_f32 v158, v154, v122
    v_mul_f32 v159, v155, v123
    v_cvt_pk_bf16_f32 v162, v158, v159
    v_lshlrev_b32 v158, 16, v162
    v_and_b32 v159, 0xffff0000, v162
    v_add_f32 v169, v169, v158
    v_add_f32 v169, v169, v159
    v_mul_f32 v158, v156, v124
    v_mul_f32 v159, v157, v125
    v_cvt_pk_bf16_f32 v162, v158, v159
    v_lshlrev_b32 v158, 16, v162
    v_and_b32 v159, 0xffff0000, v162
    v_add_f32 v169, v169, v158
    v_add_f32 v169, v169, v159
    v_lshlrev_b32 v150, 16, v58
    v_and_b32 v151, 0xffff0000, v58
    v_lshlrev_b32 v152, 16, v59
    v_and_b32 v153, 0xffff0000, v59
    v_lshlrev_b32 v154, 16, v60
    v_and_b32 v155, 0xffff0000, v60
    v_lshlrev_b32 v156, 16, v61
    v_and_b32 v157, 0xffff0000, v61
    v_mul_f32 v158, v150, v118
    v_mul_f32 v159, v151, v119
    v_cvt_pk_bf16_f32 v162, v158, v159
    v_lshlrev_b32 v158, 16, v162
    v_and_b32 v159, 0xffff0000, v162
    v_add_f32 v170, v158, v159
    v_mul_f32 v158, v152, v120
    v_mul_f32 v159, v153, v121
    v_cvt_pk_bf16_f32 v162, v158, v159
    v_lshlrev_b32 v158, 16, v162
    v_and_b32 v159, 0xffff0000, v162
    v_add_f32 v170, v170, v158
    v_add_f32 v170, v170, v159
    v_mul_f32 v158, v154, v122
    v_mul_f32 v159, v155, v123
    v_cvt_pk_bf16_f32 v162, v158, v159
    v_lshlrev_b32 v158, 16, v162
    v_and_b32 v159, 0xffff0000, v162
    v_add_f32 v170, v170, v158
    v_add_f32 v170, v170, v159
    v_mul_f32 v158, v156, v124
    v_mul_f32 v159, v157, v125
    v_cvt_pk_bf16_f32 v162, v158, v159
    v_lshlrev_b32 v158, 16, v162
    v_and_b32 v159, 0xffff0000, v162
    v_add_f32 v170, v170, v158
    v_add_f32 v170, v170, v159
    v_lshlrev_b32 v150, 16, v62
    v_and_b32 v151, 0xffff0000, v62
    v_lshlrev_b32 v152, 16, v63
    v_and_b32 v153, 0xffff0000, v63
    v_lshlrev_b32 v154, 16, v64
    v_and_b32 v155, 0xffff0000, v64
    v_lshlrev_b32 v156, 16, v65
    v_and_b32 v157, 0xffff0000, v65
    v_mul_f32 v158, v150, v118
    v_mul_f32 v159, v151, v119
    v_cvt_pk_bf16_f32 v162, v158, v159
    v_lshlrev_b32 v158, 16, v162
    v_and_b32 v159, 0xffff0000, v162
    v_add_f32 v171, v158, v159
    v_mul_f32 v158, v152, v120
    v_mul_f32 v159, v153, v121
    v_cvt_pk_bf16_f32 v162, v158, v159
    v_lshlrev_b32 v158, 16, v162
    v_and_b32 v159, 0xffff0000, v162
    v_add_f32 v171, v171, v158
    v_add_f32 v171, v171, v159
    v_mul_f32 v158, v154, v122
    v_mul_f32 v159, v155, v123
    v_cvt_pk_bf16_f32 v162, v158, v159
    v_lshlrev_b32 v158, 16, v162
    v_and_b32 v159, 0xffff0000, v162
    v_add_f32 v171, v171, v158
    v_add_f32 v171, v171, v159
    v_mul_f32 v158, v156, v124
    v_mul_f32 v159, v157, v125
    v_cvt_pk_bf16_f32 v162, v158, v159
    v_lshlrev_b32 v158, 16, v162
    v_and_b32 v159, 0xffff0000, v162
    v_add_f32 v171, v171, v158
    v_add_f32 v171, v171, v159
    v_add_f32_dpp v168, v168, v168 row_shr:1 row_mask:0xf bank_mask:0xf bound_ctrl:0
    v_add_f32_dpp v169, v169, v169 row_shr:1 row_mask:0xf bank_mask:0xf bound_ctrl:0
    v_add_f32_dpp v170, v170, v170 row_shr:1 row_mask:0xf bank_mask:0xf bound_ctrl:0
    v_add_f32_dpp v171, v171, v171 row_shr:1 row_mask:0xf bank_mask:0xf bound_ctrl:0
    v_add_f32_dpp v168, v168, v168 row_shr:2 row_mask:0xf bank_mask:0xf bound_ctrl:0
    v_add_f32_dpp v169, v169, v169 row_shr:2 row_mask:0xf bank_mask:0xf bound_ctrl:0
    v_add_f32_dpp v170, v170, v170 row_shr:2 row_mask:0xf bank_mask:0xf bound_ctrl:0
    v_add_f32_dpp v171, v171, v171 row_shr:2 row_mask:0xf bank_mask:0xf bound_ctrl:0
    v_add_f32_dpp v168, v168, v168 row_shr:4 row_mask:0xf bank_mask:0xf bound_ctrl:0
    v_add_f32_dpp v169, v169, v169 row_shr:4 row_mask:0xf bank_mask:0xf bound_ctrl:0
    v_add_f32_dpp v170, v170, v170 row_shr:4 row_mask:0xf bank_mask:0xf bound_ctrl:0
    v_add_f32_dpp v171, v171, v171 row_shr:4 row_mask:0xf bank_mask:0xf bound_ctrl:0
    v_add_f32_dpp v168, v168, v168 row_shr:8 row_mask:0xf bank_mask:0xf bound_ctrl:0
    v_add_f32_dpp v169, v169, v169 row_shr:8 row_mask:0xf bank_mask:0xf bound_ctrl:0
    v_add_f32_dpp v170, v170, v170 row_shr:8 row_mask:0xf bank_mask:0xf bound_ctrl:0
    v_add_f32_dpp v171, v171, v171 row_shr:8 row_mask:0xf bank_mask:0xf bound_ctrl:0
    v_add_f32_dpp v168, v168, v168 row_bcast:15 row_mask:0xa bank_mask:0xf
    v_add_f32_dpp v169, v169, v169 row_bcast:15 row_mask:0xa bank_mask:0xf
    v_add_f32_dpp v170, v170, v170 row_bcast:15 row_mask:0xa bank_mask:0xf
    v_add_f32_dpp v171, v171, v171 row_bcast:15 row_mask:0xa bank_mask:0xf
    v_add_f32_dpp v168, v168, v168 row_bcast:31 row_mask:0xc bank_mask:0xf
    v_add_f32_dpp v169, v169, v169 row_bcast:31 row_mask:0xc bank_mask:0xf
    v_add_f32_dpp v170, v170, v170 row_bcast:31 row_mask:0xc bank_mask:0xf
    v_add_f32_dpp v171, v171, v171 row_bcast:31 row_mask:0xc bank_mask:0xf
    s_mov_b32 s43, 0xbfb8aa3b
    v_cvt_pk_bf16_f32 v168, v168, v168
    v_lshlrev_b32 v168, 16, v168
    v_mul_f32 v168, s43, v168
    v_exp_f32 v168, v168
    s_nop 0
    v_add_f32 v168, 1.0, v168
    v_rcp_f32 v168, v168
    s_nop 0
    v_cvt_pk_bf16_f32 v168, v168, v168
    v_lshlrev_b32 v168, 16, v168
    v_cvt_pk_bf16_f32 v169, v169, v169
    v_lshlrev_b32 v169, 16, v169
    v_mul_f32 v169, s43, v169
    v_exp_f32 v169, v169
    s_nop 0
    v_add_f32 v169, 1.0, v169
    v_rcp_f32 v169, v169
    s_nop 0
    v_cvt_pk_bf16_f32 v169, v169, v169
    v_lshlrev_b32 v169, 16, v169
    v_cvt_pk_bf16_f32 v170, v170, v170
    v_lshlrev_b32 v170, 16, v170
    v_mul_f32 v170, s43, v170
    v_exp_f32 v170, v170
    s_nop 0
    v_add_f32 v170, 1.0, v170
    v_rcp_f32 v170, v170
    s_nop 0
    v_cvt_pk_bf16_f32 v170, v170, v170
    v_lshlrev_b32 v170, 16, v170
    v_cvt_pk_bf16_f32 v171, v171, v171
    v_lshlrev_b32 v171, 16, v171
    v_mul_f32 v171, s43, v171
    v_exp_f32 v171, v171
    s_nop 0
    v_add_f32 v171, 1.0, v171
    v_rcp_f32 v171, v171
    s_nop 0
    v_cvt_pk_bf16_f32 v171, v171, v171
    v_lshlrev_b32 v171, 16, v171
    s_lshl_b32 s43, s42, 2
    s_add_u32 s43, s43, 12582912
    v_mov_b32 v3, 0
    s_mov_b32 s44, 0x80000000
    s_mov_b32 exec_lo, 0
    s_mov_b32 exec_hi, s44
    buffer_store_dword v168, v3, s[36:39], s43 offen offset:0
    buffer_store_dword v169, v3, s[36:39], s43 offen offset:4
    buffer_store_dword v170, v3, s[36:39], s43 offen offset:8
    buffer_store_dword v171, v3, s[36:39], s43 offen offset:12
    s_mov_b64 exec, -1
    s_waitcnt lgkmcnt(0)
    s_barrier
    v_and_b32 v3, 15, v1
    v_lshrrev_b32 v4, 2, v3
    v_and_b32 v3, 3, v3
    v_lshlrev_b32 v3, 3, v3
    v_lshl_add_u32 v3, v4, 10, v3
    v_lshrrev_b32 v4, 4, v1
    v_lshl_add_u32 v3, v4, 5, v3
    s_lshl_b32 s43, s40, 7
    v_add_u32 v3, s43, v3
    v_lshlrev_b32 v4, 12, v1
    s_lshl_b32 s43, s40, 18
    s_lshl_b32 s44, s41, 1
    s_add_u32 s43, s43, s44
    s_add_u32 s43, s43, 8388608
    ds_read_b64_tr_b16 v[172:173], v3 offset:0
    ds_read_b64_tr_b16 v[174:175], v3 offset:4096
    ds_read_b64_tr_b16 v[176:177], v3 offset:8192
    ds_read_b64_tr_b16 v[178:179], v3 offset:12288
    ds_read_b64_tr_b16 v[180:181], v3 offset:16384
    ds_read_b64_tr_b16 v[182:183], v3 offset:20480
    ds_read_b64_tr_b16 v[184:185], v3 offset:24576
    ds_read_b64_tr_b16 v[186:187], v3 offset:28672
    s_add_u32 s44, s43, 0
    s_waitcnt lgkmcnt(6)
    buffer_store_dwordx4 v[172:175], v4, s[36:39], s44 offen
    s_add_u32 s44, s43, 16
    s_waitcnt lgkmcnt(4)
    buffer_store_dwordx4 v[176:179], v4, s[36:39], s44 offen
    s_add_u32 s44, s43, 32
    s_waitcnt lgkmcnt(2)
    buffer_store_dwordx4 v[180:183], v4, s[36:39], s44 offen
    s_add_u32 s44, s43, 48
    s_waitcnt lgkmcnt(0)
    buffer_store_dwordx4 v[184:187], v4, s[36:39], s44 offen
    s_endpgm
L_p_exit:
    s_endpgm
.globl attn_kernel
.p2align 8
.type attn_kernel,@function
attn_kernel:
    s_cmp_ge_u32 s2, 256
    s_cbranch_scc1 L_a_exit
    v_lshrrev_b32 v1, 6, v0
    s_nop 0
    v_readfirstlane_b32 s12, v1
    s_nop 3
    s_cmp_ge_u32 s12, 8
    s_cbranch_scc1 L_a_conv
    s_load_dwordx2 s[4:5], s[0:1], 96
    v_and_b32 v1, 63, v0
    s_and_b32 s13, s2, 31
    s_lshr_b32 s14, s2, 5
    v_lshlrev_b32 v5, 4, v1
    v_and_b32 v2, 31, v1
    v_lshrrev_b32 v3, 5, v1
    v_lshlrev_b32 v4, 4, v2
    v_lshl_add_u32 v6, v3, 15, v4
    v_lshlrev_b32 v4, 5, v2
    v_lshl_add_u32 v4, v3, 4, v4
    v_add_u32 v7, 65536, v4
    s_mov_b32 s20, 0x0000ffff
    s_mov_b32 s21, 0x0000ffff
    s_waitcnt lgkmcnt(0)
    s_mov_b32 s8, s4
    s_and_b32 s9, s5, 0xffff
    s_mov_b32 s10, 13631488
    s_mov_b32 s11, 0x00020000
    s_lshl_b32 s17, s13, 16
    s_lshl_b32 s15, s14, 8
    s_lshl_b32 s16, s12, 5
    s_add_u32 s14, s15, s16
    s_lshl_b32 s15, s14, 4
    s_add_u32 s15, s15, s17
    buffer_load_dwordx4 v[10:13], v6, s[8:11], s15 offen
    v_and_b32 v4, 31, v1
    v_lshlrev_b32 v4, 2, v4
    s_lshl_b32 s15, s13, 7
    s_add_u32 s15, s15, 12648448
    buffer_load_dword v9, v4, s[8:11], s15 offen
    s_lshr_b32 s15, s12, 2
    s_lshl_b32 s15, s15, 15
    s_and_b32 s16, s12, 3
    s_lshl_b32 s16, s16, 12
    s_add_u32 s16, s16, s15
    s_add_u32 m0, s16, 0
    s_add_u32 s15, s17, s16
    s_add_u32 s15, s15, 2097152
    buffer_load_dwordx4 v5, s[8:11], s15 offen offset:0 lds
    buffer_load_dwordx4 v5, s[8:11], s15 offen offset:1024 lds
    buffer_load_dwordx4 v5, s[8:11], s15 offen offset:2048 lds
    buffer_load_dwordx4 v5, s[8:11], s15 offen offset:3072 lds
    s_lshl_b32 s15, s12, 12
    s_add_u32 m0, s15, 65536
    s_add_u32 s15, s15, s17
    s_add_u32 s15, s15, 4194304
    buffer_load_dwordx4 v5, s[8:11], s15 offen offset:0 lds
    buffer_load_dwordx4 v5, s[8:11], s15 offen offset:1024 lds
    buffer_load_dwordx4 v5, s[8:11], s15 offen offset:2048 lds
    buffer_load_dwordx4 v5, s[8:11], s15 offen offset:3072 lds
    s_add_u32 m0, s16, 16384
    s_add_u32 s15, s17, s16
    s_add_u32 s15, s15, 2113536
    buffer_load_dwordx4 v5, s[8:11], s15 offen offset:0 lds
    buffer_load_dwordx4 v5, s[8:11], s15 offen offset:1024 lds
    buffer_load_dwordx4 v5, s[8:11], s15 offen offset:2048 lds
    buffer_load_dwordx4 v5, s[8:11], s15 offen offset:3072 lds
    s_lshl_b32 s15, s12, 12
    s_add_u32 m0, s15, 98304
    s_add_u32 s15, s15, s17
    s_add_u32 s15, s15, 4227072
    buffer_load_dwordx4 v5, s[8:11], s15 offen offset:0 lds
    buffer_load_dwordx4 v5, s[8:11], s15 offen offset:1024 lds
    buffer_load_dwordx4 v5, s[8:11], s15 offen offset:2048 lds
    buffer_load_dwordx4 v5, s[8:11], s15 offen offset:3072 lds
    v_and_b32 v2, 31, v1
    v_and_b32 v3, 27, v2
    v_mov_b32 v4, 0x3f803f80
    v_cmp_eq_u32 vcc, 16, v3
    s_nop 1
    v_cndmask_b32 v4, 0, v4, vcc
    v_mov_b32 v90, v4
    v_mov_b32 v91, v4
    v_mov_b32 v92, v4
    v_mov_b32 v93, v4
    v_mov_b32 v94, v4
    v_mov_b32 v95, v4
    v_mov_b32 v96, v4
    v_mov_b32 v97, v4
    v_mov_b32 v98, v4
    v_mov_b32 v99, v4
    v_mov_b32 v100, v4
    v_mov_b32 v101, v4
    v_mov_b32 v102, v4
    v_mov_b32 v103, v4
    v_mov_b32 v104, v4
    v_mov_b32 v105, v4
    s_waitcnt vmcnt(17)
    v_lshlrev_b32 v2, 16, v10
    v_and_b32 v3, 0xffff0000, v10
    v_mul_f32 v8, v2, v2
    v_fmac_f32 v8, v3, v3
    v_lshlrev_b32 v2, 16, v11
    v_and_b32 v3, 0xffff0000, v11
    v_fmac_f32 v8, v2, v2
    v_fmac_f32 v8, v3, v3
    v_lshlrev_b32 v2, 16, v12
    v_and_b32 v3, 0xffff0000, v12
    v_fmac_f32 v8, v2, v2
    v_fmac_f32 v8, v3, v3
    v_lshlrev_b32 v2, 16, v13
    v_and_b32 v3, 0xffff0000, v13
    v_fmac_f32 v8, v2, v2
    v_fmac_f32 v8, v3, v3
    v_mov_b32 v2, v8
    s_nop 1
    v_permlane32_swap_b32 v8, v2
    v_add_f32 v8, v8, v2
    s_waitcnt vmcnt(16)
    v_max_f32_dpp v9, v9, v9 row_shr:1 row_mask:0xf bank_mask:0xf
    s_nop 1
    v_max_f32_dpp v9, v9, v9 row_shr:2 row_mask:0xf bank_mask:0xf
    s_nop 1
    v_max_f32_dpp v9, v9, v9 row_shr:4 row_mask:0xf bank_mask:0xf
    s_nop 1
    v_max_f32_dpp v9, v9, v9 row_shr:8 row_mask:0xf bank_mask:0xf
    s_nop 1
    v_max_f32_dpp v9, v9, v9 row_bcast:15 row_mask:0xa bank_mask:0xf
    s_nop 0
    v_readlane_b32 s15, v9, 31
    s_nop 1
    v_mul_f32 v8, s15, v8
    v_sqrt_f32 v8, v8
    s_nop 0
    v_mul_f32 v8, 0x3f8147ae, v8
    v_sub_f32 v58, 0, v8
    v_sub_f32 v59, 0, v8
    v_sub_f32 v60, 0, v8
    v_sub_f32 v61, 0, v8
    v_sub_f32 v62, 0, v8
    v_sub_f32 v63, 0, v8
    v_sub_f32 v64, 0, v8
    v_sub_f32 v65, 0, v8
    v_sub_f32 v66, 0, v8
    v_sub_f32 v67, 0, v8
    v_sub_f32 v68, 0, v8
    v_sub_f32 v69, 0, v8
    v_sub_f32 v70, 0, v8
    v_sub_f32 v71, 0, v8
    v_sub_f32 v72, 0, v8
    v_sub_f32 v73, 0, v8
    s_waitcnt vmcnt(8)
    s_barrier
    ds_read_b128 v[14:17], v6 offset:0
    ds_read_b128 v[18:21], v6 offset:512
    s_waitcnt lgkmcnt(1)
    v_mfma_f32_32x32x16_bf16 v[26:41], v[14:17], v[10:13], v[58:73]
    ds_read_b128 v[22:25], v6 offset:1024
    s_waitcnt lgkmcnt(1)
    v_mfma_f32_32x32x16_bf16 v[42:57], v[18:21], v[10:13], v[58:73]
    s_mov_b64 exec, s[20:21]
    ds_read_b128 v[90:93], v7 offset:0
    ds_read_b128 v[94:97], v7 offset:512
    s_mov_b64 exec, -1
    s_nop 4
    v_exp_f32 v26, v26
    v_exp_f32 v27, v27
    v_exp_f32 v28, v28
    v_exp_f32 v29, v29
    v_exp_f32 v30, v30
    v_exp_f32 v31, v31
    v_exp_f32 v32, v32
    v_exp_f32 v33, v33
    v_exp_f32 v34, v34
    v_exp_f32 v35, v35
    v_exp_f32 v36, v36
    v_exp_f32 v37, v37
    v_exp_f32 v38, v38
    v_exp_f32 v39, v39
    v_exp_f32 v40, v40
    v_exp_f32 v41, v41
    v_cvt_pk_bf16_f32 v74, v26, v27
    v_cvt_pk_bf16_f32 v75, v28, v29
    v_cvt_pk_bf16_f32 v76, v30, v31
    v_cvt_pk_bf16_f32 v77, v32, v33
    v_cvt_pk_bf16_f32 v78, v34, v35
    v_cvt_pk_bf16_f32 v79, v36, v37
    v_cvt_pk_bf16_f32 v80, v38, v39
    v_cvt_pk_bf16_f32 v81, v40, v41
    ds_read_b128 v[14:17], v6 offset:1536
    s_waitcnt lgkmcnt(3)
    v_mfma_f32_32x32x16_bf16 v[26:41], v[22:25], v[10:13], v[58:73]
    s_mov_b64 exec, s[20:21]
    ds_read_b128 v[98:101], v7 offset:1024
    ds_read_b128 v[102:105], v7 offset:1536
    s_mov_b64 exec, -1
    v_exp_f32 v42, v42
    v_exp_f32 v43, v43
    v_exp_f32 v44, v44
    v_exp_f32 v45, v45
    v_exp_f32 v46, v46
    v_exp_f32 v47, v47
    v_exp_f32 v48, v48
    v_exp_f32 v49, v49
    s_waitcnt lgkmcnt(4)
    v_mfma_f32_32x32x16_bf16 v[106:121], v[90:93], v[74:77], 0
    v_exp_f32 v50, v50
    v_exp_f32 v51, v51
    v_exp_f32 v52, v52
    v_exp_f32 v53, v53
    v_exp_f32 v54, v54
    v_exp_f32 v55, v55
    v_exp_f32 v56, v56
    v_exp_f32 v57, v57
    s_waitcnt lgkmcnt(3)
    v_mfma_f32_32x32x16_bf16 v[106:121], v[94:97], v[78:81], v[106:121]
    v_cvt_pk_bf16_f32 v82, v42, v43
    v_cvt_pk_bf16_f32 v83, v44, v45
    v_cvt_pk_bf16_f32 v84, v46, v47
    v_cvt_pk_bf16_f32 v85, v48, v49
    v_cvt_pk_bf16_f32 v86, v50, v51
    v_cvt_pk_bf16_f32 v87, v52, v53
    v_cvt_pk_bf16_f32 v88, v54, v55
    v_cvt_pk_bf16_f32 v89, v56, v57
    ds_read_b128 v[18:21], v6 offset:2048
    s_waitcnt lgkmcnt(3)
    v_mfma_f32_32x32x16_bf16 v[42:57], v[14:17], v[10:13], v[58:73]
    s_mov_b64 exec, s[20:21]
    ds_read_b128 v[90:93], v7 offset:2048
    ds_read_b128 v[94:97], v7 offset:2560
    s_mov_b64 exec, -1
    v_exp_f32 v26, v26
    v_exp_f32 v27, v27
    v_exp_f32 v28, v28
    v_exp_f32 v29, v29
    v_exp_f32 v30, v30
    v_exp_f32 v31, v31
    v_exp_f32 v32, v32
    v_exp_f32 v33, v33
    s_waitcnt lgkmcnt(4)
    v_mfma_f32_32x32x16_bf16 v[106:121], v[98:101], v[82:85], v[106:121]
    v_exp_f32 v34, v34
    v_exp_f32 v35, v35
    v_exp_f32 v36, v36
    v_exp_f32 v37, v37
    v_exp_f32 v38, v38
    v_exp_f32 v39, v39
    v_exp_f32 v40, v40
    v_exp_f32 v41, v41
    s_waitcnt lgkmcnt(3)
    v_mfma_f32_32x32x16_bf16 v[106:121], v[102:105], v[86:89], v[106:121]
    v_cvt_pk_bf16_f32 v74, v26, v27
    v_cvt_pk_bf16_f32 v75, v28, v29
    v_cvt_pk_bf16_f32 v76, v30, v31
    v_cvt_pk_bf16_f32 v77, v32, v33
    v_cvt_pk_bf16_f32 v78, v34, v35
    v_cvt_pk_bf16_f32 v79, v36, v37
    v_cvt_pk_bf16_f32 v80, v38, v39
    v_cvt_pk_bf16_f32 v81, v40, v41
    ds_read_b128 v[22:25], v6 offset:2560
    s_waitcnt lgkmcnt(3)
    v_mfma_f32_32x32x16_bf16 v[26:41], v[18:21], v[10:13], v[58:73]
    s_mov_b64 exec, s[20:21]
    ds_read_b128 v[98:101], v7 offset:3072
    ds_read_b128 v[102:105], v7 offset:3584
    s_mov_b64 exec, -1
    v_exp_f32 v42, v42
    v_exp_f32 v43, v43
    v_exp_f32 v44, v44
    v_exp_f32 v45, v45
    v_exp_f32 v46, v46
    v_exp_f32 v47, v47
    v_exp_f32 v48, v48
    v_exp_f32 v49, v49
    s_waitcnt lgkmcnt(4)
    v_mfma_f32_32x32x16_bf16 v[106:121], v[90:93], v[74:77], v[106:121]
    v_exp_f32 v50, v50
    v_exp_f32 v51, v51
    v_exp_f32 v52, v52
    v_exp_f32 v53, v53
    v_exp_f32 v54, v54
    v_exp_f32 v55, v55
    v_exp_f32 v56, v56
    v_exp_f32 v57, v57
    s_waitcnt lgkmcnt(3)
    v_mfma_f32_32x32x16_bf16 v[106:121], v[94:97], v[78:81], v[106:121]
    v_cvt_pk_bf16_f32 v82, v42, v43
    v_cvt_pk_bf16_f32 v83, v44, v45
    v_cvt_pk_bf16_f32 v84, v46, v47
    v_cvt_pk_bf16_f32 v85, v48, v49
    v_cvt_pk_bf16_f32 v86, v50, v51
    v_cvt_pk_bf16_f32 v87, v52, v53
    v_cvt_pk_bf16_f32 v88, v54, v55
    v_cvt_pk_bf16_f32 v89, v56, v57
    ds_read_b128 v[14:17], v6 offset:3072
    s_waitcnt lgkmcnt(3)
    v_mfma_f32_32x32x16_bf16 v[42:57], v[22:25], v[10:13], v[58:73]
    s_mov_b64 exec, s[20:21]
    ds_read_b128 v[90:93], v7 offset:4096
    ds_read_b128 v[94:97], v7 offset:4608
    s_mov_b64 exec, -1
    v_exp_f32 v26, v26
    v_exp_f32 v27, v27
    v_exp_f32 v28, v28
    v_exp_f32 v29, v29
    v_exp_f32 v30, v30
    v_exp_f32 v31, v31
    v_exp_f32 v32, v32
    v_exp_f32 v33, v33
    s_waitcnt lgkmcnt(4)
    v_mfma_f32_32x32x16_bf16 v[106:121], v[98:101], v[82:85], v[106:121]
    v_exp_f32 v34, v34
    v_exp_f32 v35, v35
    v_exp_f32 v36, v36
    v_exp_f32 v37, v37
    v_exp_f32 v38, v38
    v_exp_f32 v39, v39
    v_exp_f32 v40, v40
    v_exp_f32 v41, v41
    s_waitcnt lgkmcnt(3)
    v_mfma_f32_32x32x16_bf16 v[106:121], v[102:105], v[86:89], v[106:121]
    v_cvt_pk_bf16_f32 v74, v26, v27
    v_cvt_pk_bf16_f32 v75, v28, v29
    v_cvt_pk_bf16_f32 v76, v30, v31
    v_cvt_pk_bf16_f32 v77, v32, v33
    v_cvt_pk_bf16_f32 v78, v34, v35
    v_cvt_pk_bf16_f32 v79, v36, v37
    v_cvt_pk_bf16_f32 v80, v38, v39
    v_cvt_pk_bf16_f32 v81, v40, v41
    ds_read_b128 v[18:21], v6 offset:3584
    s_waitcnt lgkmcnt(3)
    v_mfma_f32_32x32x16_bf16 v[26:41], v[14:17], v[10:13], v[58:73]
    s_mov_b64 exec, s[20:21]
    ds_read_b128 v[98:101], v7 offset:5120
    ds_read_b128 v[102:105], v7 offset:5632
    s_mov_b64 exec, -1
    v_exp_f32 v42, v42
    v_exp_f32 v43, v43
    v_exp_f32 v44, v44
    v_exp_f32 v45, v45
    v_exp_f32 v46, v46
    v_exp_f32 v47, v47
    v_exp_f32 v48, v48
    v_exp_f32 v49, v49
    s_waitcnt lgkmcnt(4)
    v_mfma_f32_32x32x16_bf16 v[106:121], v[90:93], v[74:77], v[106:121]
    v_exp_f32 v50, v50
    v_exp_f32 v51, v51
    v_exp_f32 v52, v52
    v_exp_f32 v53, v53
    v_exp_f32 v54, v54
    v_exp_f32 v55, v55
    v_exp_f32 v56, v56
    v_exp_f32 v57, v57
    s_waitcnt lgkmcnt(3)
    v_mfma_f32_32x32x16_bf16 v[106:121], v[94:97], v[78:81], v[106:121]
    v_cvt_pk_bf16_f32 v82, v42, v43
    v_cvt_pk_bf16_f32 v83, v44, v45
    v_cvt_pk_bf16_f32 v84, v46, v47
    v_cvt_pk_bf16_f32 v85, v48, v49
    v_cvt_pk_bf16_f32 v86, v50, v51
    v_cvt_pk_bf16_f32 v87, v52, v53
    v_cvt_pk_bf16_f32 v88, v54, v55
    v_cvt_pk_bf16_f32 v89, v56, v57
    ds_read_b128 v[22:25], v6 offset:4096
    s_waitcnt lgkmcnt(3)
    v_mfma_f32_32x32x16_bf16 v[42:57], v[18:21], v[10:13], v[58:73]
    s_mov_b64 exec, s[20:21]
    ds_read_b128 v[90:93], v7 offset:6144
    ds_read_b128 v[94:97], v7 offset:6656
    s_mov_b64 exec, -1
    v_exp_f32 v26, v26
    v_exp_f32 v27, v27
    v_exp_f32 v28, v28
    v_exp_f32 v29, v29
    v_exp_f32 v30, v30
    v_exp_f32 v31, v31
    v_exp_f32 v32, v32
    v_exp_f32 v33, v33
    s_waitcnt lgkmcnt(4)
    v_mfma_f32_32x32x16_bf16 v[106:121], v[98:101], v[82:85], v[106:121]
    v_exp_f32 v34, v34
    v_exp_f32 v35, v35
    v_exp_f32 v36, v36
    v_exp_f32 v37, v37
    v_exp_f32 v38, v38
    v_exp_f32 v39, v39
    v_exp_f32 v40, v40
    v_exp_f32 v41, v41
    s_waitcnt lgkmcnt(3)
    v_mfma_f32_32x32x16_bf16 v[106:121], v[102:105], v[86:89], v[106:121]
    v_cvt_pk_bf16_f32 v74, v26, v27
    v_cvt_pk_bf16_f32 v75, v28, v29
    v_cvt_pk_bf16_f32 v76, v30, v31
    v_cvt_pk_bf16_f32 v77, v32, v33
    v_cvt_pk_bf16_f32 v78, v34, v35
    v_cvt_pk_bf16_f32 v79, v36, v37
    v_cvt_pk_bf16_f32 v80, v38, v39
    v_cvt_pk_bf16_f32 v81, v40, v41
    ds_read_b128 v[14:17], v6 offset:4608
    s_waitcnt lgkmcnt(3)
    v_mfma_f32_32x32x16_bf16 v[26:41], v[22:25], v[10:13], v[58:73]
    s_mov_b64 exec, s[20:21]
    ds_read_b128 v[98:101], v7 offset:7168
    ds_read_b128 v[102:105], v7 offset:7680
    s_mov_b64 exec, -1
    v_exp_f32 v42, v42
    v_exp_f32 v43, v43
    v_exp_f32 v44, v44
    v_exp_f32 v45, v45
    v_exp_f32 v46, v46
    v_exp_f32 v47, v47
    v_exp_f32 v48, v48
    v_exp_f32 v49, v49
    s_waitcnt lgkmcnt(4)
    v_mfma_f32_32x32x16_bf16 v[106:121], v[90:93], v[74:77], v[106:121]
    v_exp_f32 v50, v50
    v_exp_f32 v51, v51
    v_exp_f32 v52, v52
    v_exp_f32 v53, v53
    v_exp_f32 v54, v54
    v_exp_f32 v55, v55
    v_exp_f32 v56, v56
    v_exp_f32 v57, v57
    s_waitcnt lgkmcnt(3)
    v_mfma_f32_32x32x16_bf16 v[106:121], v[94:97], v[78:81], v[106:121]
    v_cvt_pk_bf16_f32 v82, v42, v43
    v_cvt_pk_bf16_f32 v83, v44, v45
    v_cvt_pk_bf16_f32 v84, v46, v47
    v_cvt_pk_bf16_f32 v85, v48, v49
    v_cvt_pk_bf16_f32 v86, v50, v51
    v_cvt_pk_bf16_f32 v87, v52, v53
    v_cvt_pk_bf16_f32 v88, v54, v55
    v_cvt_pk_bf16_f32 v89, v56, v57
    ds_read_b128 v[18:21], v6 offset:5120
    s_waitcnt lgkmcnt(3)
    v_mfma_f32_32x32x16_bf16 v[42:57], v[14:17], v[10:13], v[58:73]
    s_mov_b64 exec, s[20:21]
    ds_read_b128 v[90:93], v7 offset:8192
    ds_read_b128 v[94:97], v7 offset:8704
    s_mov_b64 exec, -1
    v_exp_f32 v26, v26
    v_exp_f32 v27, v27
    v_exp_f32 v28, v28
    v_exp_f32 v29, v29
    v_exp_f32 v30, v30
    v_exp_f32 v31, v31
    v_exp_f32 v32, v32
    v_exp_f32 v33, v33
    s_waitcnt lgkmcnt(4)
    v_mfma_f32_32x32x16_bf16 v[106:121], v[98:101], v[82:85], v[106:121]
    v_exp_f32 v34, v34
    v_exp_f32 v35, v35
    v_exp_f32 v36, v36
    v_exp_f32 v37, v37
    v_exp_f32 v38, v38
    v_exp_f32 v39, v39
    v_exp_f32 v40, v40
    v_exp_f32 v41, v41
    s_waitcnt lgkmcnt(3)
    v_mfma_f32_32x32x16_bf16 v[106:121], v[102:105], v[86:89], v[106:121]
    v_cvt_pk_bf16_f32 v74, v26, v27
    v_cvt_pk_bf16_f32 v75, v28, v29
    v_cvt_pk_bf16_f32 v76, v30, v31
    v_cvt_pk_bf16_f32 v77, v32, v33
    v_cvt_pk_bf16_f32 v78, v34, v35
    v_cvt_pk_bf16_f32 v79, v36, v37
    v_cvt_pk_bf16_f32 v80, v38, v39
    v_cvt_pk_bf16_f32 v81, v40, v41
    ds_read_b128 v[22:25], v6 offset:5632
    s_waitcnt lgkmcnt(3)
    v_mfma_f32_32x32x16_bf16 v[26:41], v[18:21], v[10:13], v[58:73]
    s_mov_b64 exec, s[20:21]
    ds_read_b128 v[98:101], v7 offset:9216
    ds_read_b128 v[102:105], v7 offset:9728
    s_mov_b64 exec, -1
    v_exp_f32 v42, v42
    v_exp_f32 v43, v43
    v_exp_f32 v44, v44
    v_exp_f32 v45, v45
    v_exp_f32 v46, v46
    v_exp_f32 v47, v47
    v_exp_f32 v48, v48
    v_exp_f32 v49, v49
    s_waitcnt lgkmcnt(4)
    v_mfma_f32_32x32x16_bf16 v[106:121], v[90:93], v[74:77], v[106:121]
    v_exp_f32 v50, v50
    v_exp_f32 v51, v51
    v_exp_f32 v52, v52
    v_exp_f32 v53, v53
    v_exp_f32 v54, v54
    v_exp_f32 v55, v55
    v_exp_f32 v56, v56
    v_exp_f32 v57, v57
    s_waitcnt lgkmcnt(3)
    v_mfma_f32_32x32x16_bf16 v[106:121], v[94:97], v[78:81], v[106:121]
    v_cvt_pk_bf16_f32 v82, v42, v43
    v_cvt_pk_bf16_f32 v83, v44, v45
    v_cvt_pk_bf16_f32 v84, v46, v47
    v_cvt_pk_bf16_f32 v85, v48, v49
    v_cvt_pk_bf16_f32 v86, v50, v51
    v_cvt_pk_bf16_f32 v87, v52, v53
    v_cvt_pk_bf16_f32 v88, v54, v55
    v_cvt_pk_bf16_f32 v89, v56, v57
    ds_read_b128 v[14:17], v6 offset:6144
    s_waitcnt lgkmcnt(3)
    v_mfma_f32_32x32x16_bf16 v[42:57], v[22:25], v[10:13], v[58:73]
    s_mov_b64 exec, s[20:21]
    ds_read_b128 v[90:93], v7 offset:10240
    ds_read_b128 v[94:97], v7 offset:10752
    s_mov_b64 exec, -1
    v_exp_f32 v26, v26
    v_exp_f32 v27, v27
    v_exp_f32 v28, v28
    v_exp_f32 v29, v29
    v_exp_f32 v30, v30
    v_exp_f32 v31, v31
    v_exp_f32 v32, v32
    v_exp_f32 v33, v33
    s_waitcnt lgkmcnt(4)
    v_mfma_f32_32x32x16_bf16 v[106:121], v[98:101], v[82:85], v[106:121]
    v_exp_f32 v34, v34
    v_exp_f32 v35, v35
    v_exp_f32 v36, v36
    v_exp_f32 v37, v37
    v_exp_f32 v38, v38
    v_exp_f32 v39, v39
    v_exp_f32 v40, v40
    v_exp_f32 v41, v41
    s_waitcnt lgkmcnt(3)
    v_mfma_f32_32x32x16_bf16 v[106:121], v[102:105], v[86:89], v[106:121]
    v_cvt_pk_bf16_f32 v74, v26, v27
    v_cvt_pk_bf16_f32 v75, v28, v29
    v_cvt_pk_bf16_f32 v76, v30, v31
    v_cvt_pk_bf16_f32 v77, v32, v33
    v_cvt_pk_bf16_f32 v78, v34, v35
    v_cvt_pk_bf16_f32 v79, v36, v37
    v_cvt_pk_bf16_f32 v80, v38, v39
    v_cvt_pk_bf16_f32 v81, v40, v41
    ds_read_b128 v[18:21], v6 offset:6656
    s_waitcnt lgkmcnt(3)
    v_mfma_f32_32x32x16_bf16 v[26:41], v[14:17], v[10:13], v[58:73]
    s_mov_b64 exec, s[20:21]
    ds_read_b128 v[98:101], v7 offset:11264
    ds_read_b128 v[102:105], v7 offset:11776
    s_mov_b64 exec, -1
    v_exp_f32 v42, v42
    v_exp_f32 v43, v43
    v_exp_f32 v44, v44
    v_exp_f32 v45, v45
    v_exp_f32 v46, v46
    v_exp_f32 v47, v47
    v_exp_f32 v48, v48
    v_exp_f32 v49, v49
    s_waitcnt lgkmcnt(4)
    v_mfma_f32_32x32x16_bf16 v[106:121], v[90:93], v[74:77], v[106:121]
    v_exp_f32 v50, v50
    v_exp_f32 v51, v51
    v_exp_f32 v52, v52
    v_exp_f32 v53, v53
    v_exp_f32 v54, v54
    v_exp_f32 v55, v55
    v_exp_f32 v56, v56
    v_exp_f32 v57, v57
    s_waitcnt lgkmcnt(3)
    v_mfma_f32_32x32x16_bf16 v[106:121], v[94:97], v[78:81], v[106:121]
    v_cvt_pk_bf16_f32 v82, v42, v43
    v_cvt_pk_bf16_f32 v83, v44, v45
    v_cvt_pk_bf16_f32 v84, v46, v47
    v_cvt_pk_bf16_f32 v85, v48, v49
    v_cvt_pk_bf16_f32 v86, v50, v51
    v_cvt_pk_bf16_f32 v87, v52, v53
    v_cvt_pk_bf16_f32 v88, v54, v55
    v_cvt_pk_bf16_f32 v89, v56, v57
    ds_read_b128 v[22:25], v6 offset:7168
    s_waitcnt lgkmcnt(3)
    v_mfma_f32_32x32x16_bf16 v[42:57], v[18:21], v[10:13], v[58:73]
    s_mov_b64 exec, s[20:21]
    ds_read_b128 v[90:93], v7 offset:12288
    ds_read_b128 v[94:97], v7 offset:12800
    s_mov_b64 exec, -1
    v_exp_f32 v26, v26
    v_exp_f32 v27, v27
    v_exp_f32 v28, v28
    v_exp_f32 v29, v29
    v_exp_f32 v30, v30
    v_exp_f32 v31, v31
    v_exp_f32 v32, v32
    v_exp_f32 v33, v33
    s_waitcnt lgkmcnt(4)
    v_mfma_f32_32x32x16_bf16 v[106:121], v[98:101], v[82:85], v[106:121]
    v_exp_f32 v34, v34
    v_exp_f32 v35, v35
    v_exp_f32 v36, v36
    v_exp_f32 v37, v37
    v_exp_f32 v38, v38
    v_exp_f32 v39, v39
    v_exp_f32 v40, v40
    v_exp_f32 v41, v41
    s_waitcnt lgkmcnt(3)
    v_mfma_f32_32x32x16_bf16 v[106:121], v[102:105], v[86:89], v[106:121]
    v_cvt_pk_bf16_f32 v74, v26, v27
    v_cvt_pk_bf16_f32 v75, v28, v29
    v_cvt_pk_bf16_f32 v76, v30, v31
    v_cvt_pk_bf16_f32 v77, v32, v33
    v_cvt_pk_bf16_f32 v78, v34, v35
    v_cvt_pk_bf16_f32 v79, v36, v37
    v_cvt_pk_bf16_f32 v80, v38, v39
    v_cvt_pk_bf16_f32 v81, v40, v41
    ds_read_b128 v[14:17], v6 offset:7680
    s_waitcnt lgkmcnt(3)
    v_mfma_f32_32x32x16_bf16 v[26:41], v[22:25], v[10:13], v[58:73]
    s_mov_b64 exec, s[20:21]
    ds_read_b128 v[98:101], v7 offset:13312
    ds_read_b128 v[102:105], v7 offset:13824
    s_mov_b64 exec, -1
    v_exp_f32 v42, v42
    v_exp_f32 v43, v43
    v_exp_f32 v44, v44
    v_exp_f32 v45, v45
    v_exp_f32 v46, v46
    v_exp_f32 v47, v47
    v_exp_f32 v48, v48
    v_exp_f32 v49, v49
    s_waitcnt lgkmcnt(4)
    v_mfma_f32_32x32x16_bf16 v[106:121], v[90:93], v[74:77], v[106:121]
    v_exp_f32 v50, v50
    v_exp_f32 v51, v51
    v_exp_f32 v52, v52
    v_exp_f32 v53, v53
    v_exp_f32 v54, v54
    v_exp_f32 v55, v55
    v_exp_f32 v56, v56
    v_exp_f32 v57, v57
    s_waitcnt lgkmcnt(3)
    v_mfma_f32_32x32x16_bf16 v[106:121], v[94:97], v[78:81], v[106:121]
    v_cvt_pk_bf16_f32 v82, v42, v43
    v_cvt_pk_bf16_f32 v83, v44, v45
    v_cvt_pk_bf16_f32 v84, v46, v47
    v_cvt_pk_bf16_f32 v85, v48, v49
    v_cvt_pk_bf16_f32 v86, v50, v51
    v_cvt_pk_bf16_f32 v87, v52, v53
    v_cvt_pk_bf16_f32 v88, v54, v55
    v_cvt_pk_bf16_f32 v89, v56, v57
    ds_read_b128 v[18:21], v6 offset:8192
    s_waitcnt lgkmcnt(3)
    v_mfma_f32_32x32x16_bf16 v[42:57], v[14:17], v[10:13], v[58:73]
    s_mov_b64 exec, s[20:21]
    ds_read_b128 v[90:93], v7 offset:14336
    ds_read_b128 v[94:97], v7 offset:14848
    s_mov_b64 exec, -1
    v_exp_f32 v26, v26
    v_exp_f32 v27, v27
    v_exp_f32 v28, v28
    v_exp_f32 v29, v29
    v_exp_f32 v30, v30
    v_exp_f32 v31, v31
    v_exp_f32 v32, v32
    v_exp_f32 v33, v33
    s_waitcnt lgkmcnt(4)
    v_mfma_f32_32x32x16_bf16 v[106:121], v[98:101], v[82:85], v[106:121]
    v_exp_f32 v34, v34
    v_exp_f32 v35, v35
    v_exp_f32 v36, v36
    v_exp_f32 v37, v37
    v_exp_f32 v38, v38
    v_exp_f32 v39, v39
    v_exp_f32 v40, v40
    v_exp_f32 v41, v41
    s_waitcnt lgkmcnt(3)
    v_mfma_f32_32x32x16_bf16 v[106:121], v[102:105], v[86:89], v[106:121]
    v_cvt_pk_bf16_f32 v74, v26, v27
    v_cvt_pk_bf16_f32 v75, v28, v29
    v_cvt_pk_bf16_f32 v76, v30, v31
    v_cvt_pk_bf16_f32 v77, v32, v33
    v_cvt_pk_bf16_f32 v78, v34, v35
    v_cvt_pk_bf16_f32 v79, v36, v37
    v_cvt_pk_bf16_f32 v80, v38, v39
    v_cvt_pk_bf16_f32 v81, v40, v41
    ds_read_b128 v[22:25], v6 offset:8704
    s_waitcnt lgkmcnt(3)
    v_mfma_f32_32x32x16_bf16 v[26:41], v[18:21], v[10:13], v[58:73]
    s_mov_b64 exec, s[20:21]
    ds_read_b128 v[98:101], v7 offset:15360
    ds_read_b128 v[102:105], v7 offset:15872
    s_mov_b64 exec, -1
    v_exp_f32 v42, v42
    v_exp_f32 v43, v43
    v_exp_f32 v44, v44
    v_exp_f32 v45, v45
    v_exp_f32 v46, v46
    v_exp_f32 v47, v47
    v_exp_f32 v48, v48
    v_exp_f32 v49, v49
    s_waitcnt lgkmcnt(4)
    v_mfma_f32_32x32x16_bf16 v[106:121], v[90:93], v[74:77], v[106:121]
    v_exp_f32 v50, v50
    v_exp_f32 v51, v51
    v_exp_f32 v52, v52
    v_exp_f32 v53, v53
    v_exp_f32 v54, v54
    v_exp_f32 v55, v55
    v_exp_f32 v56, v56
    v_exp_f32 v57, v57
    s_waitcnt lgkmcnt(3)
    v_mfma_f32_32x32x16_bf16 v[106:121], v[94:97], v[78:81], v[106:121]
    v_cvt_pk_bf16_f32 v82, v42, v43
    v_cvt_pk_bf16_f32 v83, v44, v45
    v_cvt_pk_bf16_f32 v84, v46, v47
    v_cvt_pk_bf16_f32 v85, v48, v49
    v_cvt_pk_bf16_f32 v86, v50, v51
    v_cvt_pk_bf16_f32 v87, v52, v53
    v_cvt_pk_bf16_f32 v88, v54, v55
    v_cvt_pk_bf16_f32 v89, v56, v57
    ds_read_b128 v[14:17], v6 offset:9216
    s_waitcnt lgkmcnt(3)
    v_mfma_f32_32x32x16_bf16 v[42:57], v[22:25], v[10:13], v[58:73]
    s_mov_b64 exec, s[20:21]
    ds_read_b128 v[90:93], v7 offset:16384
    ds_read_b128 v[94:97], v7 offset:16896
    s_mov_b64 exec, -1
    v_exp_f32 v26, v26
    v_exp_f32 v27, v27
    v_exp_f32 v28, v28
    v_exp_f32 v29, v29
    v_exp_f32 v30, v30
    v_exp_f32 v31, v31
    v_exp_f32 v32, v32
    v_exp_f32 v33, v33
    s_waitcnt lgkmcnt(4)
    v_mfma_f32_32x32x16_bf16 v[106:121], v[98:101], v[82:85], v[106:121]
    v_exp_f32 v34, v34
    v_exp_f32 v35, v35
    v_exp_f32 v36, v36
    v_exp_f32 v37, v37
    v_exp_f32 v38, v38
    v_exp_f32 v39, v39
    v_exp_f32 v40, v40
    v_exp_f32 v41, v41
    s_waitcnt lgkmcnt(3)
    v_mfma_f32_32x32x16_bf16 v[106:121], v[102:105], v[86:89], v[106:121]
    v_cvt_pk_bf16_f32 v74, v26, v27
    v_cvt_pk_bf16_f32 v75, v28, v29
    v_cvt_pk_bf16_f32 v76, v30, v31
    v_cvt_pk_bf16_f32 v77, v32, v33
    v_cvt_pk_bf16_f32 v78, v34, v35
    v_cvt_pk_bf16_f32 v79, v36, v37
    v_cvt_pk_bf16_f32 v80, v38, v39
    v_cvt_pk_bf16_f32 v81, v40, v41
    ds_read_b128 v[18:21], v6 offset:9728
    s_waitcnt lgkmcnt(3)
    v_mfma_f32_32x32x16_bf16 v[26:41], v[14:17], v[10:13], v[58:73]
    s_mov_b64 exec, s[20:21]
    ds_read_b128 v[98:101], v7 offset:17408
    ds_read_b128 v[102:105], v7 offset:17920
    s_mov_b64 exec, -1
    v_exp_f32 v42, v42
    v_exp_f32 v43, v43
    v_exp_f32 v44, v44
    v_exp_f32 v45, v45
    v_exp_f32 v46, v46
    v_exp_f32 v47, v47
    v_exp_f32 v48, v48
    v_exp_f32 v49, v49
    s_waitcnt lgkmcnt(4)
    v_mfma_f32_32x32x16_bf16 v[106:121], v[90:93], v[74:77], v[106:121]
    v_exp_f32 v50, v50
    v_exp_f32 v51, v51
    v_exp_f32 v52, v52
    v_exp_f32 v53, v53
    v_exp_f32 v54, v54
    v_exp_f32 v55, v55
    v_exp_f32 v56, v56
    v_exp_f32 v57, v57
    s_waitcnt lgkmcnt(3)
    v_mfma_f32_32x32x16_bf16 v[106:121], v[94:97], v[78:81], v[106:121]
    v_cvt_pk_bf16_f32 v82, v42, v43
    v_cvt_pk_bf16_f32 v83, v44, v45
    v_cvt_pk_bf16_f32 v84, v46, v47
    v_cvt_pk_bf16_f32 v85, v48, v49
    v_cvt_pk_bf16_f32 v86, v50, v51
    v_cvt_pk_bf16_f32 v87, v52, v53
    v_cvt_pk_bf16_f32 v88, v54, v55
    v_cvt_pk_bf16_f32 v89, v56, v57
    ds_read_b128 v[22:25], v6 offset:10240
    s_waitcnt lgkmcnt(3)
    v_mfma_f32_32x32x16_bf16 v[42:57], v[18:21], v[10:13], v[58:73]
    s_mov_b64 exec, s[20:21]
    ds_read_b128 v[90:93], v7 offset:18432
    ds_read_b128 v[94:97], v7 offset:18944
    s_mov_b64 exec, -1
    v_exp_f32 v26, v26
    v_exp_f32 v27, v27
    v_exp_f32 v28, v28
    v_exp_f32 v29, v29
    v_exp_f32 v30, v30
    v_exp_f32 v31, v31
    v_exp_f32 v32, v32
    v_exp_f32 v33, v33
    s_waitcnt lgkmcnt(4)
    v_mfma_f32_32x32x16_bf16 v[106:121], v[98:101], v[82:85], v[106:121]
    v_exp_f32 v34, v34
    v_exp_f32 v35, v35
    v_exp_f32 v36, v36
    v_exp_f32 v37, v37
    v_exp_f32 v38, v38
    v_exp_f32 v39, v39
    v_exp_f32 v40, v40
    v_exp_f32 v41, v41
    s_waitcnt lgkmcnt(3)
    v_mfma_f32_32x32x16_bf16 v[106:121], v[102:105], v[86:89], v[106:121]
    v_cvt_pk_bf16_f32 v74, v26, v27
    v_cvt_pk_bf16_f32 v75, v28, v29
    v_cvt_pk_bf16_f32 v76, v30, v31
    v_cvt_pk_bf16_f32 v77, v32, v33
    v_cvt_pk_bf16_f32 v78, v34, v35
    v_cvt_pk_bf16_f32 v79, v36, v37
    v_cvt_pk_bf16_f32 v80, v38, v39
    v_cvt_pk_bf16_f32 v81, v40, v41
    ds_read_b128 v[14:17], v6 offset:10752
    s_waitcnt lgkmcnt(3)
    v_mfma_f32_32x32x16_bf16 v[26:41], v[22:25], v[10:13], v[58:73]
    s_mov_b64 exec, s[20:21]
    ds_read_b128 v[98:101], v7 offset:19456
    ds_read_b128 v[102:105], v7 offset:19968
    s_mov_b64 exec, -1
    v_exp_f32 v42, v42
    v_exp_f32 v43, v43
    v_exp_f32 v44, v44
    v_exp_f32 v45, v45
    v_exp_f32 v46, v46
    v_exp_f32 v47, v47
    v_exp_f32 v48, v48
    v_exp_f32 v49, v49
    s_waitcnt lgkmcnt(4)
    v_mfma_f32_32x32x16_bf16 v[106:121], v[90:93], v[74:77], v[106:121]
    v_exp_f32 v50, v50
    v_exp_f32 v51, v51
    v_exp_f32 v52, v52
    v_exp_f32 v53, v53
    v_exp_f32 v54, v54
    v_exp_f32 v55, v55
    v_exp_f32 v56, v56
    v_exp_f32 v57, v57
    s_waitcnt lgkmcnt(3)
    v_mfma_f32_32x32x16_bf16 v[106:121], v[94:97], v[78:81], v[106:121]
    v_cvt_pk_bf16_f32 v82, v42, v43
    v_cvt_pk_bf16_f32 v83, v44, v45
    v_cvt_pk_bf16_f32 v84, v46, v47
    v_cvt_pk_bf16_f32 v85, v48, v49
    v_cvt_pk_bf16_f32 v86, v50, v51
    v_cvt_pk_bf16_f32 v87, v52, v53
    v_cvt_pk_bf16_f32 v88, v54, v55
    v_cvt_pk_bf16_f32 v89, v56, v57
    ds_read_b128 v[18:21], v6 offset:11264
    s_waitcnt lgkmcnt(3)
    v_mfma_f32_32x32x16_bf16 v[42:57], v[14:17], v[10:13], v[58:73]
    s_mov_b64 exec, s[20:21]
    ds_read_b128 v[90:93], v7 offset:20480
    ds_read_b128 v[94:97], v7 offset:20992
    s_mov_b64 exec, -1
    v_exp_f32 v26, v26
    v_exp_f32 v27, v27
    v_exp_f32 v28, v28
    v_exp_f32 v29, v29
    v_exp_f32 v30, v30
    v_exp_f32 v31, v31
    v_exp_f32 v32, v32
    v_exp_f32 v33, v33
    s_waitcnt lgkmcnt(4)
    v_mfma_f32_32x32x16_bf16 v[106:121], v[98:101], v[82:85], v[106:121]
    v_exp_f32 v34, v34
    v_exp_f32 v35, v35
    v_exp_f32 v36, v36
    v_exp_f32 v37, v37
    v_exp_f32 v38, v38
    v_exp_f32 v39, v39
    v_exp_f32 v40, v40
    v_exp_f32 v41, v41
    s_waitcnt lgkmcnt(3)
    v_mfma_f32_32x32x16_bf16 v[106:121], v[102:105], v[86:89], v[106:121]
    v_cvt_pk_bf16_f32 v74, v26, v27
    v_cvt_pk_bf16_f32 v75, v28, v29
    v_cvt_pk_bf16_f32 v76, v30, v31
    v_cvt_pk_bf16_f32 v77, v32, v33
    v_cvt_pk_bf16_f32 v78, v34, v35
    v_cvt_pk_bf16_f32 v79, v36, v37
    v_cvt_pk_bf16_f32 v80, v38, v39
    v_cvt_pk_bf16_f32 v81, v40, v41
    ds_read_b128 v[22:25], v6 offset:11776
    s_waitcnt lgkmcnt(3)
    v_mfma_f32_32x32x16_bf16 v[26:41], v[18:21], v[10:13], v[58:73]
    s_mov_b64 exec, s[20:21]
    ds_read_b128 v[98:101], v7 offset:21504
    ds_read_b128 v[102:105], v7 offset:22016
    s_mov_b64 exec, -1
    v_exp_f32 v42, v42
    v_exp_f32 v43, v43
    v_exp_f32 v44, v44
    v_exp_f32 v45, v45
    v_exp_f32 v46, v46
    v_exp_f32 v47, v47
    v_exp_f32 v48, v48
    v_exp_f32 v49, v49
    s_waitcnt lgkmcnt(4)
    v_mfma_f32_32x32x16_bf16 v[106:121], v[90:93], v[74:77], v[106:121]
    v_exp_f32 v50, v50
    v_exp_f32 v51, v51
    v_exp_f32 v52, v52
    v_exp_f32 v53, v53
    v_exp_f32 v54, v54
    v_exp_f32 v55, v55
    v_exp_f32 v56, v56
    v_exp_f32 v57, v57
    s_waitcnt lgkmcnt(3)
    v_mfma_f32_32x32x16_bf16 v[106:121], v[94:97], v[78:81], v[106:121]
    v_cvt_pk_bf16_f32 v82, v42, v43
    v_cvt_pk_bf16_f32 v83, v44, v45
    v_cvt_pk_bf16_f32 v84, v46, v47
    v_cvt_pk_bf16_f32 v85, v48, v49
    v_cvt_pk_bf16_f32 v86, v50, v51
    v_cvt_pk_bf16_f32 v87, v52, v53
    v_cvt_pk_bf16_f32 v88, v54, v55
    v_cvt_pk_bf16_f32 v89, v56, v57
    ds_read_b128 v[14:17], v6 offset:12288
    s_waitcnt lgkmcnt(3)
    v_mfma_f32_32x32x16_bf16 v[42:57], v[22:25], v[10:13], v[58:73]
    s_mov_b64 exec, s[20:21]
    ds_read_b128 v[90:93], v7 offset:22528
    ds_read_b128 v[94:97], v7 offset:23040
    s_mov_b64 exec, -1
    v_exp_f32 v26, v26
    v_exp_f32 v27, v27
    v_exp_f32 v28, v28
    v_exp_f32 v29, v29
    v_exp_f32 v30, v30
    v_exp_f32 v31, v31
    v_exp_f32 v32, v32
    v_exp_f32 v33, v33
    s_waitcnt lgkmcnt(4)
    v_mfma_f32_32x32x16_bf16 v[106:121], v[98:101], v[82:85], v[106:121]
    v_exp_f32 v34, v34
    v_exp_f32 v35, v35
    v_exp_f32 v36, v36
    v_exp_f32 v37, v37
    v_exp_f32 v38, v38
    v_exp_f32 v39, v39
    v_exp_f32 v40, v40
    v_exp_f32 v41, v41
    s_waitcnt lgkmcnt(3)
    v_mfma_f32_32x32x16_bf16 v[106:121], v[102:105], v[86:89], v[106:121]
    v_cvt_pk_bf16_f32 v74, v26, v27
    v_cvt_pk_bf16_f32 v75, v28, v29
    v_cvt_pk_bf16_f32 v76, v30, v31
    v_cvt_pk_bf16_f32 v77, v32, v33
    v_cvt_pk_bf16_f32 v78, v34, v35
    v_cvt_pk_bf16_f32 v79, v36, v37
    v_cvt_pk_bf16_f32 v80, v38, v39
    v_cvt_pk_bf16_f32 v81, v40, v41
    ds_read_b128 v[18:21], v6 offset:12800
    s_waitcnt lgkmcnt(3)
    v_mfma_f32_32x32x16_bf16 v[26:41], v[14:17], v[10:13], v[58:73]
    s_mov_b64 exec, s[20:21]
    ds_read_b128 v[98:101], v7 offset:23552
    ds_read_b128 v[102:105], v7 offset:24064
    s_mov_b64 exec, -1
    v_exp_f32 v42, v42
    v_exp_f32 v43, v43
    v_exp_f32 v44, v44
    v_exp_f32 v45, v45
    v_exp_f32 v46, v46
    v_exp_f32 v47, v47
    v_exp_f32 v48, v48
    v_exp_f32 v49, v49
    s_waitcnt lgkmcnt(4)
    v_mfma_f32_32x32x16_bf16 v[106:121], v[90:93], v[74:77], v[106:121]
    v_exp_f32 v50, v50
    v_exp_f32 v51, v51
    v_exp_f32 v52, v52
    v_exp_f32 v53, v53
    v_exp_f32 v54, v54
    v_exp_f32 v55, v55
    v_exp_f32 v56, v56
    v_exp_f32 v57, v57
    s_waitcnt lgkmcnt(3)
    v_mfma_f32_32x32x16_bf16 v[106:121], v[94:97], v[78:81], v[106:121]
    v_cvt_pk_bf16_f32 v82, v42, v43
    v_cvt_pk_bf16_f32 v83, v44, v45
    v_cvt_pk_bf16_f32 v84, v46, v47
    v_cvt_pk_bf16_f32 v85, v48, v49
    v_cvt_pk_bf16_f32 v86, v50, v51
    v_cvt_pk_bf16_f32 v87, v52, v53
    v_cvt_pk_bf16_f32 v88, v54, v55
    v_cvt_pk_bf16_f32 v89, v56, v57
    ds_read_b128 v[22:25], v6 offset:13312
    s_waitcnt lgkmcnt(3)
    v_mfma_f32_32x32x16_bf16 v[42:57], v[18:21], v[10:13], v[58:73]
    s_mov_b64 exec, s[20:21]
    ds_read_b128 v[90:93], v7 offset:24576
    ds_read_b128 v[94:97], v7 offset:25088
    s_mov_b64 exec, -1
    v_exp_f32 v26, v26
    v_exp_f32 v27, v27
    v_exp_f32 v28, v28
    v_exp_f32 v29, v29
    v_exp_f32 v30, v30
    v_exp_f32 v31, v31
    v_exp_f32 v32, v32
    v_exp_f32 v33, v33
    s_waitcnt lgkmcnt(4)
    v_mfma_f32_32x32x16_bf16 v[106:121], v[98:101], v[82:85], v[106:121]
    v_exp_f32 v34, v34
    v_exp_f32 v35, v35
    v_exp_f32 v36, v36
    v_exp_f32 v37, v37
    v_exp_f32 v38, v38
    v_exp_f32 v39, v39
    v_exp_f32 v40, v40
    v_exp_f32 v41, v41
    s_waitcnt lgkmcnt(3)
    v_mfma_f32_32x32x16_bf16 v[106:121], v[102:105], v[86:89], v[106:121]
    v_cvt_pk_bf16_f32 v74, v26, v27
    v_cvt_pk_bf16_f32 v75, v28, v29
    v_cvt_pk_bf16_f32 v76, v30, v31
    v_cvt_pk_bf16_f32 v77, v32, v33
    v_cvt_pk_bf16_f32 v78, v34, v35
    v_cvt_pk_bf16_f32 v79, v36, v37
    v_cvt_pk_bf16_f32 v80, v38, v39
    v_cvt_pk_bf16_f32 v81, v40, v41
    ds_read_b128 v[14:17], v6 offset:13824
    s_waitcnt lgkmcnt(3)
    v_mfma_f32_32x32x16_bf16 v[26:41], v[22:25], v[10:13], v[58:73]
    s_mov_b64 exec, s[20:21]
    ds_read_b128 v[98:101], v7 offset:25600
    ds_read_b128 v[102:105], v7 offset:26112
    s_mov_b64 exec, -1
    v_exp_f32 v42, v42
    v_exp_f32 v43, v43
    v_exp_f32 v44, v44
    v_exp_f32 v45, v45
    v_exp_f32 v46, v46
    v_exp_f32 v47, v47
    v_exp_f32 v48, v48
    v_exp_f32 v49, v49
    s_waitcnt lgkmcnt(4)
    v_mfma_f32_32x32x16_bf16 v[106:121], v[90:93], v[74:77], v[106:121]
    v_exp_f32 v50, v50
    v_exp_f32 v51, v51
    v_exp_f32 v52, v52
    v_exp_f32 v53, v53
    v_exp_f32 v54, v54
    v_exp_f32 v55, v55
    v_exp_f32 v56, v56
    v_exp_f32 v57, v57
    s_waitcnt lgkmcnt(3)
    v_mfma_f32_32x32x16_bf16 v[106:121], v[94:97], v[78:81], v[106:121]
    v_cvt_pk_bf16_f32 v82, v42, v43
    v_cvt_pk_bf16_f32 v83, v44, v45
    v_cvt_pk_bf16_f32 v84, v46, v47
    v_cvt_pk_bf16_f32 v85, v48, v49
    v_cvt_pk_bf16_f32 v86, v50, v51
    v_cvt_pk_bf16_f32 v87, v52, v53
    v_cvt_pk_bf16_f32 v88, v54, v55
    v_cvt_pk_bf16_f32 v89, v56, v57
    ds_read_b128 v[18:21], v6 offset:14336
    s_waitcnt lgkmcnt(3)
    v_mfma_f32_32x32x16_bf16 v[42:57], v[14:17], v[10:13], v[58:73]
    s_mov_b64 exec, s[20:21]
    ds_read_b128 v[90:93], v7 offset:26624
    ds_read_b128 v[94:97], v7 offset:27136
    s_mov_b64 exec, -1
    v_exp_f32 v26, v26
    v_exp_f32 v27, v27
    v_exp_f32 v28, v28
    v_exp_f32 v29, v29
    v_exp_f32 v30, v30
    v_exp_f32 v31, v31
    v_exp_f32 v32, v32
    v_exp_f32 v33, v33
    s_waitcnt lgkmcnt(4)
    v_mfma_f32_32x32x16_bf16 v[106:121], v[98:101], v[82:85], v[106:121]
    v_exp_f32 v34, v34
    v_exp_f32 v35, v35
    v_exp_f32 v36, v36
    v_exp_f32 v37, v37
    v_exp_f32 v38, v38
    v_exp_f32 v39, v39
    v_exp_f32 v40, v40
    v_exp_f32 v41, v41
    s_waitcnt lgkmcnt(3)
    v_mfma_f32_32x32x16_bf16 v[106:121], v[102:105], v[86:89], v[106:121]
    v_cvt_pk_bf16_f32 v74, v26, v27
    v_cvt_pk_bf16_f32 v75, v28, v29
    v_cvt_pk_bf16_f32 v76, v30, v31
    v_cvt_pk_bf16_f32 v77, v32, v33
    v_cvt_pk_bf16_f32 v78, v34, v35
    v_cvt_pk_bf16_f32 v79, v36, v37
    v_cvt_pk_bf16_f32 v80, v38, v39
    v_cvt_pk_bf16_f32 v81, v40, v41
    ds_read_b128 v[22:25], v6 offset:14848
    s_waitcnt lgkmcnt(3)
    v_mfma_f32_32x32x16_bf16 v[26:41], v[18:21], v[10:13], v[58:73]
    s_mov_b64 exec, s[20:21]
    ds_read_b128 v[98:101], v7 offset:27648
    ds_read_b128 v[102:105], v7 offset:28160
    s_mov_b64 exec, -1
    v_exp_f32 v42, v42
    v_exp_f32 v43, v43
    v_exp_f32 v44, v44
    v_exp_f32 v45, v45
    v_exp_f32 v46, v46
    v_exp_f32 v47, v47
    v_exp_f32 v48, v48
    v_exp_f32 v49, v49
    s_waitcnt lgkmcnt(4)
    v_mfma_f32_32x32x16_bf16 v[106:121], v[90:93], v[74:77], v[106:121]
    v_exp_f32 v50, v50
    v_exp_f32 v51, v51
    v_exp_f32 v52, v52
    v_exp_f32 v53, v53
    v_exp_f32 v54, v54
    v_exp_f32 v55, v55
    v_exp_f32 v56, v56
    v_exp_f32 v57, v57
    s_waitcnt lgkmcnt(3)
    v_mfma_f32_32x32x16_bf16 v[106:121], v[94:97], v[78:81], v[106:121]
    v_cvt_pk_bf16_f32 v82, v42, v43
    v_cvt_pk_bf16_f32 v83, v44, v45
    v_cvt_pk_bf16_f32 v84, v46, v47
    v_cvt_pk_bf16_f32 v85, v48, v49
    v_cvt_pk_bf16_f32 v86, v50, v51
    v_cvt_pk_bf16_f32 v87, v52, v53
    v_cvt_pk_bf16_f32 v88, v54, v55
    v_cvt_pk_bf16_f32 v89, v56, v57
    ds_read_b128 v[14:17], v6 offset:15360
    s_waitcnt lgkmcnt(3)
    v_mfma_f32_32x32x16_bf16 v[42:57], v[22:25], v[10:13], v[58:73]
    s_mov_b64 exec, s[20:21]
    ds_read_b128 v[90:93], v7 offset:28672
    ds_read_b128 v[94:97], v7 offset:29184
    s_mov_b64 exec, -1
    v_exp_f32 v26, v26
    v_exp_f32 v27, v27
    v_exp_f32 v28, v28
    v_exp_f32 v29, v29
    v_exp_f32 v30, v30
    v_exp_f32 v31, v31
    v_exp_f32 v32, v32
    v_exp_f32 v33, v33
    s_waitcnt lgkmcnt(4)
    v_mfma_f32_32x32x16_bf16 v[106:121], v[98:101], v[82:85], v[106:121]
    v_exp_f32 v34, v34
    v_exp_f32 v35, v35
    v_exp_f32 v36, v36
    v_exp_f32 v37, v37
    v_exp_f32 v38, v38
    v_exp_f32 v39, v39
    v_exp_f32 v40, v40
    v_exp_f32 v41, v41
    s_waitcnt lgkmcnt(3)
    v_mfma_f32_32x32x16_bf16 v[106:121], v[102:105], v[86:89], v[106:121]
    v_cvt_pk_bf16_f32 v74, v26, v27
    v_cvt_pk_bf16_f32 v75, v28, v29
    v_cvt_pk_bf16_f32 v76, v30, v31
    v_cvt_pk_bf16_f32 v77, v32, v33
    v_cvt_pk_bf16_f32 v78, v34, v35
    v_cvt_pk_bf16_f32 v79, v36, v37
    v_cvt_pk_bf16_f32 v80, v38, v39
    v_cvt_pk_bf16_f32 v81, v40, v41
    ds_read_b128 v[18:21], v6 offset:15872
    s_waitcnt lgkmcnt(3)
    v_mfma_f32_32x32x16_bf16 v[26:41], v[14:17], v[10:13], v[58:73]
    s_mov_b64 exec, s[20:21]
    ds_read_b128 v[98:101], v7 offset:29696
    ds_read_b128 v[102:105], v7 offset:30208
    s_mov_b64 exec, -1
    v_exp_f32 v42, v42
    v_exp_f32 v43, v43
    v_exp_f32 v44, v44
    v_exp_f32 v45, v45
    v_exp_f32 v46, v46
    v_exp_f32 v47, v47
    v_exp_f32 v48, v48
    v_exp_f32 v49, v49
    s_waitcnt lgkmcnt(4)
    v_mfma_f32_32x32x16_bf16 v[106:121], v[90:93], v[74:77], v[106:121]
    v_exp_f32 v50, v50
    v_exp_f32 v51, v51
    v_exp_f32 v52, v52
    v_exp_f32 v53, v53
    v_exp_f32 v54, v54
    v_exp_f32 v55, v55
    v_exp_f32 v56, v56
    v_exp_f32 v57, v57
    s_waitcnt lgkmcnt(3)
    v_mfma_f32_32x32x16_bf16 v[106:121], v[94:97], v[78:81], v[106:121]
    v_cvt_pk_bf16_f32 v82, v42, v43
    v_cvt_pk_bf16_f32 v83, v44, v45
    v_cvt_pk_bf16_f32 v84, v46, v47
    v_cvt_pk_bf16_f32 v85, v48, v49
    v_cvt_pk_bf16_f32 v86, v50, v51
    v_cvt_pk_bf16_f32 v87, v52, v53
    v_cvt_pk_bf16_f32 v88, v54, v55
    v_cvt_pk_bf16_f32 v89, v56, v57
    s_waitcnt vmcnt(0)
    s_barrier
    ds_read_b128 v[22:25], v6 offset:16384
    s_waitcnt lgkmcnt(3)
    v_mfma_f32_32x32x16_bf16 v[42:57], v[18:21], v[10:13], v[58:73]
    s_mov_b64 exec, s[20:21]
    ds_read_b128 v[90:93], v7 offset:30720
    ds_read_b128 v[94:97], v7 offset:31232
    s_mov_b64 exec, -1
    v_exp_f32 v26, v26
    v_exp_f32 v27, v27
    v_exp_f32 v28, v28
    v_exp_f32 v29, v29
    v_exp_f32 v30, v30
    v_exp_f32 v31, v31
    v_exp_f32 v32, v32
    v_exp_f32 v33, v33
    s_waitcnt lgkmcnt(4)
    v_mfma_f32_32x32x16_bf16 v[106:121], v[98:101], v[82:85], v[106:121]
    v_exp_f32 v34, v34
    v_exp_f32 v35, v35
    v_exp_f32 v36, v36
    v_exp_f32 v37, v37
    v_exp_f32 v38, v38
    v_exp_f32 v39, v39
    v_exp_f32 v40, v40
    v_exp_f32 v41, v41
    s_waitcnt lgkmcnt(3)
    v_mfma_f32_32x32x16_bf16 v[106:121], v[102:105], v[86:89], v[106:121]
    v_cvt_pk_bf16_f32 v74, v26, v27
    v_cvt_pk_bf16_f32 v75, v28, v29
    v_cvt_pk_bf16_f32 v76, v30, v31
    v_cvt_pk_bf16_f32 v77, v32, v33
    v_cvt_pk_bf16_f32 v78, v34, v35
    v_cvt_pk_bf16_f32 v79, v36, v37
    v_cvt_pk_bf16_f32 v80, v38, v39
    v_cvt_pk_bf16_f32 v81, v40, v41
    ds_read_b128 v[14:17], v6 offset:16896
    s_waitcnt lgkmcnt(3)
    v_mfma_f32_32x32x16_bf16 v[26:41], v[22:25], v[10:13], v[58:73]
    s_mov_b64 exec, s[20:21]
    ds_read_b128 v[98:101], v7 offset:31744
    ds_read_b128 v[102:105], v7 offset:32256
    s_mov_b64 exec, -1
    v_exp_f32 v42, v42
    v_exp_f32 v43, v43
    v_exp_f32 v44, v44
    v_exp_f32 v45, v45
    v_exp_f32 v46, v46
    v_exp_f32 v47, v47
    v_exp_f32 v48, v48
    v_exp_f32 v49, v49
    s_waitcnt lgkmcnt(4)
    v_mfma_f32_32x32x16_bf16 v[106:121], v[90:93], v[74:77], v[106:121]
    v_exp_f32 v50, v50
    v_exp_f32 v51, v51
    v_exp_f32 v52, v52
    v_exp_f32 v53, v53
    v_exp_f32 v54, v54
    v_exp_f32 v55, v55
    v_exp_f32 v56, v56
    v_exp_f32 v57, v57
    s_waitcnt lgkmcnt(3)
    v_mfma_f32_32x32x16_bf16 v[106:121], v[94:97], v[78:81], v[106:121]
    v_cvt_pk_bf16_f32 v82, v42, v43
    v_cvt_pk_bf16_f32 v83, v44, v45
    v_cvt_pk_bf16_f32 v84, v46, v47
    v_cvt_pk_bf16_f32 v85, v48, v49
    v_cvt_pk_bf16_f32 v86, v50, v51
    v_cvt_pk_bf16_f32 v87, v52, v53
    v_cvt_pk_bf16_f32 v88, v54, v55
    v_cvt_pk_bf16_f32 v89, v56, v57
    ds_read_b128 v[18:21], v6 offset:17408
    s_waitcnt lgkmcnt(3)
    v_mfma_f32_32x32x16_bf16 v[42:57], v[14:17], v[10:13], v[58:73]
    s_mov_b64 exec, s[20:21]
    ds_read_b128 v[90:93], v7 offset:32768
    ds_read_b128 v[94:97], v7 offset:33280
    s_mov_b64 exec, -1
    v_exp_f32 v26, v26
    v_exp_f32 v27, v27
    v_exp_f32 v28, v28
    v_exp_f32 v29, v29
    v_exp_f32 v30, v30
    v_exp_f32 v31, v31
    v_exp_f32 v32, v32
    v_exp_f32 v33, v33
    s_waitcnt lgkmcnt(4)
    v_mfma_f32_32x32x16_bf16 v[106:121], v[98:101], v[82:85], v[106:121]
    v_exp_f32 v34, v34
    v_exp_f32 v35, v35
    v_exp_f32 v36, v36
    v_exp_f32 v37, v37
    v_exp_f32 v38, v38
    v_exp_f32 v39, v39
    v_exp_f32 v40, v40
    v_exp_f32 v41, v41
    s_waitcnt lgkmcnt(3)
    v_mfma_f32_32x32x16_bf16 v[106:121], v[102:105], v[86:89], v[106:121]
    v_cvt_pk_bf16_f32 v74, v26, v27
    v_cvt_pk_bf16_f32 v75, v28, v29
    v_cvt_pk_bf16_f32 v76, v30, v31
    v_cvt_pk_bf16_f32 v77, v32, v33
    v_cvt_pk_bf16_f32 v78, v34, v35
    v_cvt_pk_bf16_f32 v79, v36, v37
    v_cvt_pk_bf16_f32 v80, v38, v39
    v_cvt_pk_bf16_f32 v81, v40, v41
    ds_read_b128 v[22:25], v6 offset:17920
    s_waitcnt lgkmcnt(3)
    v_mfma_f32_32x32x16_bf16 v[26:41], v[18:21], v[10:13], v[58:73]
    s_mov_b64 exec, s[20:21]
    ds_read_b128 v[98:101], v7 offset:33792
    ds_read_b128 v[102:105], v7 offset:34304
    s_mov_b64 exec, -1
    v_exp_f32 v42, v42
    v_exp_f32 v43, v43
    v_exp_f32 v44, v44
    v_exp_f32 v45, v45
    v_exp_f32 v46, v46
    v_exp_f32 v47, v47
    v_exp_f32 v48, v48
    v_exp_f32 v49, v49
    s_waitcnt lgkmcnt(4)
    v_mfma_f32_32x32x16_bf16 v[106:121], v[90:93], v[74:77], v[106:121]
    v_exp_f32 v50, v50
    v_exp_f32 v51, v51
    v_exp_f32 v52, v52
    v_exp_f32 v53, v53
    v_exp_f32 v54, v54
    v_exp_f32 v55, v55
    v_exp_f32 v56, v56
    v_exp_f32 v57, v57
    s_waitcnt lgkmcnt(3)
    v_mfma_f32_32x32x16_bf16 v[106:121], v[94:97], v[78:81], v[106:121]
    v_cvt_pk_bf16_f32 v82, v42, v43
    v_cvt_pk_bf16_f32 v83, v44, v45
    v_cvt_pk_bf16_f32 v84, v46, v47
    v_cvt_pk_bf16_f32 v85, v48, v49
    v_cvt_pk_bf16_f32 v86, v50, v51
    v_cvt_pk_bf16_f32 v87, v52, v53
    v_cvt_pk_bf16_f32 v88, v54, v55
    v_cvt_pk_bf16_f32 v89, v56, v57
    ds_read_b128 v[14:17], v6 offset:18432
    s_waitcnt lgkmcnt(3)
    v_mfma_f32_32x32x16_bf16 v[42:57], v[22:25], v[10:13], v[58:73]
    s_mov_b64 exec, s[20:21]
    ds_read_b128 v[90:93], v7 offset:34816
    ds_read_b128 v[94:97], v7 offset:35328
    s_mov_b64 exec, -1
    v_exp_f32 v26, v26
    v_exp_f32 v27, v27
    v_exp_f32 v28, v28
    v_exp_f32 v29, v29
    v_exp_f32 v30, v30
    v_exp_f32 v31, v31
    v_exp_f32 v32, v32
    v_exp_f32 v33, v33
    s_waitcnt lgkmcnt(4)
    v_mfma_f32_32x32x16_bf16 v[106:121], v[98:101], v[82:85], v[106:121]
    v_exp_f32 v34, v34
    v_exp_f32 v35, v35
    v_exp_f32 v36, v36
    v_exp_f32 v37, v37
    v_exp_f32 v38, v38
    v_exp_f32 v39, v39
    v_exp_f32 v40, v40
    v_exp_f32 v41, v41
    s_waitcnt lgkmcnt(3)
    v_mfma_f32_32x32x16_bf16 v[106:121], v[102:105], v[86:89], v[106:121]
    v_cvt_pk_bf16_f32 v74, v26, v27
    v_cvt_pk_bf16_f32 v75, v28, v29
    v_cvt_pk_bf16_f32 v76, v30, v31
    v_cvt_pk_bf16_f32 v77, v32, v33
    v_cvt_pk_bf16_f32 v78, v34, v35
    v_cvt_pk_bf16_f32 v79, v36, v37
    v_cvt_pk_bf16_f32 v80, v38, v39
    v_cvt_pk_bf16_f32 v81, v40, v41
    ds_read_b128 v[18:21], v6 offset:18944
    s_waitcnt lgkmcnt(3)
    v_mfma_f32_32x32x16_bf16 v[26:41], v[14:17], v[10:13], v[58:73]
    s_mov_b64 exec, s[20:21]
    ds_read_b128 v[98:101], v7 offset:35840
    ds_read_b128 v[102:105], v7 offset:36352
    s_mov_b64 exec, -1
    v_exp_f32 v42, v42
    v_exp_f32 v43, v43
    v_exp_f32 v44, v44
    v_exp_f32 v45, v45
    v_exp_f32 v46, v46
    v_exp_f32 v47, v47
    v_exp_f32 v48, v48
    v_exp_f32 v49, v49
    s_waitcnt lgkmcnt(4)
    v_mfma_f32_32x32x16_bf16 v[106:121], v[90:93], v[74:77], v[106:121]
    v_exp_f32 v50, v50
    v_exp_f32 v51, v51
    v_exp_f32 v52, v52
    v_exp_f32 v53, v53
    v_exp_f32 v54, v54
    v_exp_f32 v55, v55
    v_exp_f32 v56, v56
    v_exp_f32 v57, v57
    s_waitcnt lgkmcnt(3)
    v_mfma_f32_32x32x16_bf16 v[106:121], v[94:97], v[78:81], v[106:121]
    v_cvt_pk_bf16_f32 v82, v42, v43
    v_cvt_pk_bf16_f32 v83, v44, v45
    v_cvt_pk_bf16_f32 v84, v46, v47
    v_cvt_pk_bf16_f32 v85, v48, v49
    v_cvt_pk_bf16_f32 v86, v50, v51
    v_cvt_pk_bf16_f32 v87, v52, v53
    v_cvt_pk_bf16_f32 v88, v54, v55
    v_cvt_pk_bf16_f32 v89, v56, v57
    ds_read_b128 v[22:25], v6 offset:19456
    s_waitcnt lgkmcnt(3)
    v_mfma_f32_32x32x16_bf16 v[42:57], v[18:21], v[10:13], v[58:73]
    s_mov_b64 exec, s[20:21]
    ds_read_b128 v[90:93], v7 offset:36864
    ds_read_b128 v[94:97], v7 offset:37376
    s_mov_b64 exec, -1
    v_exp_f32 v26, v26
    v_exp_f32 v27, v27
    v_exp_f32 v28, v28
    v_exp_f32 v29, v29
    v_exp_f32 v30, v30
    v_exp_f32 v31, v31
    v_exp_f32 v32, v32
    v_exp_f32 v33, v33
    s_waitcnt lgkmcnt(4)
    v_mfma_f32_32x32x16_bf16 v[106:121], v[98:101], v[82:85], v[106:121]
    v_exp_f32 v34, v34
    v_exp_f32 v35, v35
    v_exp_f32 v36, v36
    v_exp_f32 v37, v37
    v_exp_f32 v38, v38
    v_exp_f32 v39, v39
    v_exp_f32 v40, v40
    v_exp_f32 v41, v41
    s_waitcnt lgkmcnt(3)
    v_mfma_f32_32x32x16_bf16 v[106:121], v[102:105], v[86:89], v[106:121]
    v_cvt_pk_bf16_f32 v74, v26, v27
    v_cvt_pk_bf16_f32 v75, v28, v29
    v_cvt_pk_bf16_f32 v76, v30, v31
    v_cvt_pk_bf16_f32 v77, v32, v33
    v_cvt_pk_bf16_f32 v78, v34, v35
    v_cvt_pk_bf16_f32 v79, v36, v37
    v_cvt_pk_bf16_f32 v80, v38, v39
    v_cvt_pk_bf16_f32 v81, v40, v41
    ds_read_b128 v[14:17], v6 offset:19968
    s_waitcnt lgkmcnt(3)
    v_mfma_f32_32x32x16_bf16 v[26:41], v[22:25], v[10:13], v[58:73]
    s_mov_b64 exec, s[20:21]
    ds_read_b128 v[98:101], v7 offset:37888
    ds_read_b128 v[102:105], v7 offset:38400
    s_mov_b64 exec, -1
    v_exp_f32 v42, v42
    v_exp_f32 v43, v43
    v_exp_f32 v44, v44
    v_exp_f32 v45, v45
    v_exp_f32 v46, v46
    v_exp_f32 v47, v47
    v_exp_f32 v48, v48
    v_exp_f32 v49, v49
    s_waitcnt lgkmcnt(4)
    v_mfma_f32_32x32x16_bf16 v[106:121], v[90:93], v[74:77], v[106:121]
    v_exp_f32 v50, v50
    v_exp_f32 v51, v51
    v_exp_f32 v52, v52
    v_exp_f32 v53, v53
    v_exp_f32 v54, v54
    v_exp_f32 v55, v55
    v_exp_f32 v56, v56
    v_exp_f32 v57, v57
    s_waitcnt lgkmcnt(3)
    v_mfma_f32_32x32x16_bf16 v[106:121], v[94:97], v[78:81], v[106:121]
    v_cvt_pk_bf16_f32 v82, v42, v43
    v_cvt_pk_bf16_f32 v83, v44, v45
    v_cvt_pk_bf16_f32 v84, v46, v47
    v_cvt_pk_bf16_f32 v85, v48, v49
    v_cvt_pk_bf16_f32 v86, v50, v51
    v_cvt_pk_bf16_f32 v87, v52, v53
    v_cvt_pk_bf16_f32 v88, v54, v55
    v_cvt_pk_bf16_f32 v89, v56, v57
    ds_read_b128 v[18:21], v6 offset:20480
    s_waitcnt lgkmcnt(3)
    v_mfma_f32_32x32x16_bf16 v[42:57], v[14:17], v[10:13], v[58:73]
    s_mov_b64 exec, s[20:21]
    ds_read_b128 v[90:93], v7 offset:38912
    ds_read_b128 v[94:97], v7 offset:39424
    s_mov_b64 exec, -1
    v_exp_f32 v26, v26
    v_exp_f32 v27, v27
    v_exp_f32 v28, v28
    v_exp_f32 v29, v29
    v_exp_f32 v30, v30
    v_exp_f32 v31, v31
    v_exp_f32 v32, v32
    v_exp_f32 v33, v33
    s_waitcnt lgkmcnt(4)
    v_mfma_f32_32x32x16_bf16 v[106:121], v[98:101], v[82:85], v[106:121]
    v_exp_f32 v34, v34
    v_exp_f32 v35, v35
    v_exp_f32 v36, v36
    v_exp_f32 v37, v37
    v_exp_f32 v38, v38
    v_exp_f32 v39, v39
    v_exp_f32 v40, v40
    v_exp_f32 v41, v41
    s_waitcnt lgkmcnt(3)
    v_mfma_f32_32x32x16_bf16 v[106:121], v[102:105], v[86:89], v[106:121]
    v_cvt_pk_bf16_f32 v74, v26, v27
    v_cvt_pk_bf16_f32 v75, v28, v29
    v_cvt_pk_bf16_f32 v76, v30, v31
    v_cvt_pk_bf16_f32 v77, v32, v33
    v_cvt_pk_bf16_f32 v78, v34, v35
    v_cvt_pk_bf16_f32 v79, v36, v37
    v_cvt_pk_bf16_f32 v80, v38, v39
    v_cvt_pk_bf16_f32 v81, v40, v41
    ds_read_b128 v[22:25], v6 offset:20992
    s_waitcnt lgkmcnt(3)
    v_mfma_f32_32x32x16_bf16 v[26:41], v[18:21], v[10:13], v[58:73]
    s_mov_b64 exec, s[20:21]
    ds_read_b128 v[98:101], v7 offset:39936
    ds_read_b128 v[102:105], v7 offset:40448
    s_mov_b64 exec, -1
    v_exp_f32 v42, v42
    v_exp_f32 v43, v43
    v_exp_f32 v44, v44
    v_exp_f32 v45, v45
    v_exp_f32 v46, v46
    v_exp_f32 v47, v47
    v_exp_f32 v48, v48
    v_exp_f32 v49, v49
    s_waitcnt lgkmcnt(4)
    v_mfma_f32_32x32x16_bf16 v[106:121], v[90:93], v[74:77], v[106:121]
    v_exp_f32 v50, v50
    v_exp_f32 v51, v51
    v_exp_f32 v52, v52
    v_exp_f32 v53, v53
    v_exp_f32 v54, v54
    v_exp_f32 v55, v55
    v_exp_f32 v56, v56
    v_exp_f32 v57, v57
    s_waitcnt lgkmcnt(3)
    v_mfma_f32_32x32x16_bf16 v[106:121], v[94:97], v[78:81], v[106:121]
    v_cvt_pk_bf16_f32 v82, v42, v43
    v_cvt_pk_bf16_f32 v83, v44, v45
    v_cvt_pk_bf16_f32 v84, v46, v47
    v_cvt_pk_bf16_f32 v85, v48, v49
    v_cvt_pk_bf16_f32 v86, v50, v51
    v_cvt_pk_bf16_f32 v87, v52, v53
    v_cvt_pk_bf16_f32 v88, v54, v55
    v_cvt_pk_bf16_f32 v89, v56, v57
    ds_read_b128 v[14:17], v6 offset:21504
    s_waitcnt lgkmcnt(3)
    v_mfma_f32_32x32x16_bf16 v[42:57], v[22:25], v[10:13], v[58:73]
    s_mov_b64 exec, s[20:21]
    ds_read_b128 v[90:93], v7 offset:40960
    ds_read_b128 v[94:97], v7 offset:41472
    s_mov_b64 exec, -1
    v_exp_f32 v26, v26
    v_exp_f32 v27, v27
    v_exp_f32 v28, v28
    v_exp_f32 v29, v29
    v_exp_f32 v30, v30
    v_exp_f32 v31, v31
    v_exp_f32 v32, v32
    v_exp_f32 v33, v33
    s_waitcnt lgkmcnt(4)
    v_mfma_f32_32x32x16_bf16 v[106:121], v[98:101], v[82:85], v[106:121]
    v_exp_f32 v34, v34
    v_exp_f32 v35, v35
    v_exp_f32 v36, v36
    v_exp_f32 v37, v37
    v_exp_f32 v38, v38
    v_exp_f32 v39, v39
    v_exp_f32 v40, v40
    v_exp_f32 v41, v41
    s_waitcnt lgkmcnt(3)
    v_mfma_f32_32x32x16_bf16 v[106:121], v[102:105], v[86:89], v[106:121]
    v_cvt_pk_bf16_f32 v74, v26, v27
    v_cvt_pk_bf16_f32 v75, v28, v29
    v_cvt_pk_bf16_f32 v76, v30, v31
    v_cvt_pk_bf16_f32 v77, v32, v33
    v_cvt_pk_bf16_f32 v78, v34, v35
    v_cvt_pk_bf16_f32 v79, v36, v37
    v_cvt_pk_bf16_f32 v80, v38, v39
    v_cvt_pk_bf16_f32 v81, v40, v41
    ds_read_b128 v[18:21], v6 offset:22016
    s_waitcnt lgkmcnt(3)
    v_mfma_f32_32x32x16_bf16 v[26:41], v[14:17], v[10:13], v[58:73]
    s_mov_b64 exec, s[20:21]
    ds_read_b128 v[98:101], v7 offset:41984
    ds_read_b128 v[102:105], v7 offset:42496
    s_mov_b64 exec, -1
    v_exp_f32 v42, v42
    v_exp_f32 v43, v43
    v_exp_f32 v44, v44
    v_exp_f32 v45, v45
    v_exp_f32 v46, v46
    v_exp_f32 v47, v47
    v_exp_f32 v48, v48
    v_exp_f32 v49, v49
    s_waitcnt lgkmcnt(4)
    v_mfma_f32_32x32x16_bf16 v[106:121], v[90:93], v[74:77], v[106:121]
    v_exp_f32 v50, v50
    v_exp_f32 v51, v51
    v_exp_f32 v52, v52
    v_exp_f32 v53, v53
    v_exp_f32 v54, v54
    v_exp_f32 v55, v55
    v_exp_f32 v56, v56
    v_exp_f32 v57, v57
    s_waitcnt lgkmcnt(3)
    v_mfma_f32_32x32x16_bf16 v[106:121], v[94:97], v[78:81], v[106:121]
    v_cvt_pk_bf16_f32 v82, v42, v43
    v_cvt_pk_bf16_f32 v83, v44, v45
    v_cvt_pk_bf16_f32 v84, v46, v47
    v_cvt_pk_bf16_f32 v85, v48, v49
    v_cvt_pk_bf16_f32 v86, v50, v51
    v_cvt_pk_bf16_f32 v87, v52, v53
    v_cvt_pk_bf16_f32 v88, v54, v55
    v_cvt_pk_bf16_f32 v89, v56, v57
    ds_read_b128 v[22:25], v6 offset:22528
    s_waitcnt lgkmcnt(3)
    v_mfma_f32_32x32x16_bf16 v[42:57], v[18:21], v[10:13], v[58:73]
    s_mov_b64 exec, s[20:21]
    ds_read_b128 v[90:93], v7 offset:43008
    ds_read_b128 v[94:97], v7 offset:43520
    s_mov_b64 exec, -1
    v_exp_f32 v26, v26
    v_exp_f32 v27, v27
    v_exp_f32 v28, v28
    v_exp_f32 v29, v29
    v_exp_f32 v30, v30
    v_exp_f32 v31, v31
    v_exp_f32 v32, v32
    v_exp_f32 v33, v33
    s_waitcnt lgkmcnt(4)
    v_mfma_f32_32x32x16_bf16 v[106:121], v[98:101], v[82:85], v[106:121]
    v_exp_f32 v34, v34
    v_exp_f32 v35, v35
    v_exp_f32 v36, v36
    v_exp_f32 v37, v37
    v_exp_f32 v38, v38
    v_exp_f32 v39, v39
    v_exp_f32 v40, v40
    v_exp_f32 v41, v41
    s_waitcnt lgkmcnt(3)
    v_mfma_f32_32x32x16_bf16 v[106:121], v[102:105], v[86:89], v[106:121]
    v_cvt_pk_bf16_f32 v74, v26, v27
    v_cvt_pk_bf16_f32 v75, v28, v29
    v_cvt_pk_bf16_f32 v76, v30, v31
    v_cvt_pk_bf16_f32 v77, v32, v33
    v_cvt_pk_bf16_f32 v78, v34, v35
    v_cvt_pk_bf16_f32 v79, v36, v37
    v_cvt_pk_bf16_f32 v80, v38, v39
    v_cvt_pk_bf16_f32 v81, v40, v41
    ds_read_b128 v[14:17], v6 offset:23040
    s_waitcnt lgkmcnt(3)
    v_mfma_f32_32x32x16_bf16 v[26:41], v[22:25], v[10:13], v[58:73]
    s_mov_b64 exec, s[20:21]
    ds_read_b128 v[98:101], v7 offset:44032
    ds_read_b128 v[102:105], v7 offset:44544
    s_mov_b64 exec, -1
    v_exp_f32 v42, v42
    v_exp_f32 v43, v43
    v_exp_f32 v44, v44
    v_exp_f32 v45, v45
    v_exp_f32 v46, v46
    v_exp_f32 v47, v47
    v_exp_f32 v48, v48
    v_exp_f32 v49, v49
    s_waitcnt lgkmcnt(4)
    v_mfma_f32_32x32x16_bf16 v[106:121], v[90:93], v[74:77], v[106:121]
    v_exp_f32 v50, v50
    v_exp_f32 v51, v51
    v_exp_f32 v52, v52
    v_exp_f32 v53, v53
    v_exp_f32 v54, v54
    v_exp_f32 v55, v55
    v_exp_f32 v56, v56
    v_exp_f32 v57, v57
    s_waitcnt lgkmcnt(3)
    v_mfma_f32_32x32x16_bf16 v[106:121], v[94:97], v[78:81], v[106:121]
    v_cvt_pk_bf16_f32 v82, v42, v43
    v_cvt_pk_bf16_f32 v83, v44, v45
    v_cvt_pk_bf16_f32 v84, v46, v47
    v_cvt_pk_bf16_f32 v85, v48, v49
    v_cvt_pk_bf16_f32 v86, v50, v51
    v_cvt_pk_bf16_f32 v87, v52, v53
    v_cvt_pk_bf16_f32 v88, v54, v55
    v_cvt_pk_bf16_f32 v89, v56, v57
    ds_read_b128 v[18:21], v6 offset:23552
    s_waitcnt lgkmcnt(3)
    v_mfma_f32_32x32x16_bf16 v[42:57], v[14:17], v[10:13], v[58:73]
    s_mov_b64 exec, s[20:21]
    ds_read_b128 v[90:93], v7 offset:45056
    ds_read_b128 v[94:97], v7 offset:45568
    s_mov_b64 exec, -1
    v_exp_f32 v26, v26
    v_exp_f32 v27, v27
    v_exp_f32 v28, v28
    v_exp_f32 v29, v29
    v_exp_f32 v30, v30
    v_exp_f32 v31, v31
    v_exp_f32 v32, v32
    v_exp_f32 v33, v33
    s_waitcnt lgkmcnt(4)
    v_mfma_f32_32x32x16_bf16 v[106:121], v[98:101], v[82:85], v[106:121]
    v_exp_f32 v34, v34
    v_exp_f32 v35, v35
    v_exp_f32 v36, v36
    v_exp_f32 v37, v37
    v_exp_f32 v38, v38
    v_exp_f32 v39, v39
    v_exp_f32 v40, v40
    v_exp_f32 v41, v41
    s_waitcnt lgkmcnt(3)
    v_mfma_f32_32x32x16_bf16 v[106:121], v[102:105], v[86:89], v[106:121]
    v_cvt_pk_bf16_f32 v74, v26, v27
    v_cvt_pk_bf16_f32 v75, v28, v29
    v_cvt_pk_bf16_f32 v76, v30, v31
    v_cvt_pk_bf16_f32 v77, v32, v33
    v_cvt_pk_bf16_f32 v78, v34, v35
    v_cvt_pk_bf16_f32 v79, v36, v37
    v_cvt_pk_bf16_f32 v80, v38, v39
    v_cvt_pk_bf16_f32 v81, v40, v41
    ds_read_b128 v[22:25], v6 offset:24064
    s_waitcnt lgkmcnt(3)
    v_mfma_f32_32x32x16_bf16 v[26:41], v[18:21], v[10:13], v[58:73]
    s_mov_b64 exec, s[20:21]
    ds_read_b128 v[98:101], v7 offset:46080
    ds_read_b128 v[102:105], v7 offset:46592
    s_mov_b64 exec, -1
    v_exp_f32 v42, v42
    v_exp_f32 v43, v43
    v_exp_f32 v44, v44
    v_exp_f32 v45, v45
    v_exp_f32 v46, v46
    v_exp_f32 v47, v47
    v_exp_f32 v48, v48
    v_exp_f32 v49, v49
    s_waitcnt lgkmcnt(4)
    v_mfma_f32_32x32x16_bf16 v[106:121], v[90:93], v[74:77], v[106:121]
    v_exp_f32 v50, v50
    v_exp_f32 v51, v51
    v_exp_f32 v52, v52
    v_exp_f32 v53, v53
    v_exp_f32 v54, v54
    v_exp_f32 v55, v55
    v_exp_f32 v56, v56
    v_exp_f32 v57, v57
    s_waitcnt lgkmcnt(3)
    v_mfma_f32_32x32x16_bf16 v[106:121], v[94:97], v[78:81], v[106:121]
    v_cvt_pk_bf16_f32 v82, v42, v43
    v_cvt_pk_bf16_f32 v83, v44, v45
    v_cvt_pk_bf16_f32 v84, v46, v47
    v_cvt_pk_bf16_f32 v85, v48, v49
    v_cvt_pk_bf16_f32 v86, v50, v51
    v_cvt_pk_bf16_f32 v87, v52, v53
    v_cvt_pk_bf16_f32 v88, v54, v55
    v_cvt_pk_bf16_f32 v89, v56, v57
    ds_read_b128 v[14:17], v6 offset:24576
    s_waitcnt lgkmcnt(3)
    v_mfma_f32_32x32x16_bf16 v[42:57], v[22:25], v[10:13], v[58:73]
    s_mov_b64 exec, s[20:21]
    ds_read_b128 v[90:93], v7 offset:47104
    ds_read_b128 v[94:97], v7 offset:47616
    s_mov_b64 exec, -1
    v_exp_f32 v26, v26
    v_exp_f32 v27, v27
    v_exp_f32 v28, v28
    v_exp_f32 v29, v29
    v_exp_f32 v30, v30
    v_exp_f32 v31, v31
    v_exp_f32 v32, v32
    v_exp_f32 v33, v33
    s_waitcnt lgkmcnt(4)
    v_mfma_f32_32x32x16_bf16 v[106:121], v[98:101], v[82:85], v[106:121]
    v_exp_f32 v34, v34
    v_exp_f32 v35, v35
    v_exp_f32 v36, v36
    v_exp_f32 v37, v37
    v_exp_f32 v38, v38
    v_exp_f32 v39, v39
    v_exp_f32 v40, v40
    v_exp_f32 v41, v41
    s_waitcnt lgkmcnt(3)
    v_mfma_f32_32x32x16_bf16 v[106:121], v[102:105], v[86:89], v[106:121]
    v_cvt_pk_bf16_f32 v74, v26, v27
    v_cvt_pk_bf16_f32 v75, v28, v29
    v_cvt_pk_bf16_f32 v76, v30, v31
    v_cvt_pk_bf16_f32 v77, v32, v33
    v_cvt_pk_bf16_f32 v78, v34, v35
    v_cvt_pk_bf16_f32 v79, v36, v37
    v_cvt_pk_bf16_f32 v80, v38, v39
    v_cvt_pk_bf16_f32 v81, v40, v41
    ds_read_b128 v[18:21], v6 offset:25088
    s_waitcnt lgkmcnt(3)
    v_mfma_f32_32x32x16_bf16 v[26:41], v[14:17], v[10:13], v[58:73]
    s_mov_b64 exec, s[20:21]
    ds_read_b128 v[98:101], v7 offset:48128
    ds_read_b128 v[102:105], v7 offset:48640
    s_mov_b64 exec, -1
    v_exp_f32 v42, v42
    v_exp_f32 v43, v43
    v_exp_f32 v44, v44
    v_exp_f32 v45, v45
    v_exp_f32 v46, v46
    v_exp_f32 v47, v47
    v_exp_f32 v48, v48
    v_exp_f32 v49, v49
    s_waitcnt lgkmcnt(4)
    v_mfma_f32_32x32x16_bf16 v[106:121], v[90:93], v[74:77], v[106:121]
    v_exp_f32 v50, v50
    v_exp_f32 v51, v51
    v_exp_f32 v52, v52
    v_exp_f32 v53, v53
    v_exp_f32 v54, v54
    v_exp_f32 v55, v55
    v_exp_f32 v56, v56
    v_exp_f32 v57, v57
    s_waitcnt lgkmcnt(3)
    v_mfma_f32_32x32x16_bf16 v[106:121], v[94:97], v[78:81], v[106:121]
    v_cvt_pk_bf16_f32 v82, v42, v43
    v_cvt_pk_bf16_f32 v83, v44, v45
    v_cvt_pk_bf16_f32 v84, v46, v47
    v_cvt_pk_bf16_f32 v85, v48, v49
    v_cvt_pk_bf16_f32 v86, v50, v51
    v_cvt_pk_bf16_f32 v87, v52, v53
    v_cvt_pk_bf16_f32 v88, v54, v55
    v_cvt_pk_bf16_f32 v89, v56, v57
    ds_read_b128 v[22:25], v6 offset:25600
    s_waitcnt lgkmcnt(3)
    v_mfma_f32_32x32x16_bf16 v[42:57], v[18:21], v[10:13], v[58:73]
    s_mov_b64 exec, s[20:21]
    ds_read_b128 v[90:93], v7 offset:49152
    ds_read_b128 v[94:97], v7 offset:49664
    s_mov_b64 exec, -1
    v_exp_f32 v26, v26
    v_exp_f32 v27, v27
    v_exp_f32 v28, v28
    v_exp_f32 v29, v29
    v_exp_f32 v30, v30
    v_exp_f32 v31, v31
    v_exp_f32 v32, v32
    v_exp_f32 v33, v33
    s_waitcnt lgkmcnt(4)
    v_mfma_f32_32x32x16_bf16 v[106:121], v[98:101], v[82:85], v[106:121]
    v_exp_f32 v34, v34
    v_exp_f32 v35, v35
    v_exp_f32 v36, v36
    v_exp_f32 v37, v37
    v_exp_f32 v38, v38
    v_exp_f32 v39, v39
    v_exp_f32 v40, v40
    v_exp_f32 v41, v41
    s_waitcnt lgkmcnt(3)
    v_mfma_f32_32x32x16_bf16 v[106:121], v[102:105], v[86:89], v[106:121]
    v_cvt_pk_bf16_f32 v74, v26, v27
    v_cvt_pk_bf16_f32 v75, v28, v29
    v_cvt_pk_bf16_f32 v76, v30, v31
    v_cvt_pk_bf16_f32 v77, v32, v33
    v_cvt_pk_bf16_f32 v78, v34, v35
    v_cvt_pk_bf16_f32 v79, v36, v37
    v_cvt_pk_bf16_f32 v80, v38, v39
    v_cvt_pk_bf16_f32 v81, v40, v41
    ds_read_b128 v[14:17], v6 offset:26112
    s_waitcnt lgkmcnt(3)
    v_mfma_f32_32x32x16_bf16 v[26:41], v[22:25], v[10:13], v[58:73]
    s_mov_b64 exec, s[20:21]
    ds_read_b128 v[98:101], v7 offset:50176
    ds_read_b128 v[102:105], v7 offset:50688
    s_mov_b64 exec, -1
    v_exp_f32 v42, v42
    v_exp_f32 v43, v43
    v_exp_f32 v44, v44
    v_exp_f32 v45, v45
    v_exp_f32 v46, v46
    v_exp_f32 v47, v47
    v_exp_f32 v48, v48
    v_exp_f32 v49, v49
    s_waitcnt lgkmcnt(4)
    v_mfma_f32_32x32x16_bf16 v[106:121], v[90:93], v[74:77], v[106:121]
    v_exp_f32 v50, v50
    v_exp_f32 v51, v51
    v_exp_f32 v52, v52
    v_exp_f32 v53, v53
    v_exp_f32 v54, v54
    v_exp_f32 v55, v55
    v_exp_f32 v56, v56
    v_exp_f32 v57, v57
    s_waitcnt lgkmcnt(3)
    v_mfma_f32_32x32x16_bf16 v[106:121], v[94:97], v[78:81], v[106:121]
    v_cvt_pk_bf16_f32 v82, v42, v43
    v_cvt_pk_bf16_f32 v83, v44, v45
    v_cvt_pk_bf16_f32 v84, v46, v47
    v_cvt_pk_bf16_f32 v85, v48, v49
    v_cvt_pk_bf16_f32 v86, v50, v51
    v_cvt_pk_bf16_f32 v87, v52, v53
    v_cvt_pk_bf16_f32 v88, v54, v55
    v_cvt_pk_bf16_f32 v89, v56, v57
    ds_read_b128 v[18:21], v6 offset:26624
    s_waitcnt lgkmcnt(3)
    v_mfma_f32_32x32x16_bf16 v[42:57], v[14:17], v[10:13], v[58:73]
    s_mov_b64 exec, s[20:21]
    ds_read_b128 v[90:93], v7 offset:51200
    ds_read_b128 v[94:97], v7 offset:51712
    s_mov_b64 exec, -1
    v_exp_f32 v26, v26
    v_exp_f32 v27, v27
    v_exp_f32 v28, v28
    v_exp_f32 v29, v29
    v_exp_f32 v30, v30
    v_exp_f32 v31, v31
    v_exp_f32 v32, v32
    v_exp_f32 v33, v33
    s_waitcnt lgkmcnt(4)
    v_mfma_f32_32x32x16_bf16 v[106:121], v[98:101], v[82:85], v[106:121]
    v_exp_f32 v34, v34
    v_exp_f32 v35, v35
    v_exp_f32 v36, v36
    v_exp_f32 v37, v37
    v_exp_f32 v38, v38
    v_exp_f32 v39, v39
    v_exp_f32 v40, v40
    v_exp_f32 v41, v41
    s_waitcnt lgkmcnt(3)
    v_mfma_f32_32x32x16_bf16 v[106:121], v[102:105], v[86:89], v[106:121]
    v_cvt_pk_bf16_f32 v74, v26, v27
    v_cvt_pk_bf16_f32 v75, v28, v29
    v_cvt_pk_bf16_f32 v76, v30, v31
    v_cvt_pk_bf16_f32 v77, v32, v33
    v_cvt_pk_bf16_f32 v78, v34, v35
    v_cvt_pk_bf16_f32 v79, v36, v37
    v_cvt_pk_bf16_f32 v80, v38, v39
    v_cvt_pk_bf16_f32 v81, v40, v41
    ds_read_b128 v[22:25], v6 offset:27136
    s_waitcnt lgkmcnt(3)
    v_mfma_f32_32x32x16_bf16 v[26:41], v[18:21], v[10:13], v[58:73]
    s_mov_b64 exec, s[20:21]
    ds_read_b128 v[98:101], v7 offset:52224
    ds_read_b128 v[102:105], v7 offset:52736
    s_mov_b64 exec, -1
    v_exp_f32 v42, v42
    v_exp_f32 v43, v43
    v_exp_f32 v44, v44
    v_exp_f32 v45, v45
    v_exp_f32 v46, v46
    v_exp_f32 v47, v47
    v_exp_f32 v48, v48
    v_exp_f32 v49, v49
    s_waitcnt lgkmcnt(4)
    v_mfma_f32_32x32x16_bf16 v[106:121], v[90:93], v[74:77], v[106:121]
    v_exp_f32 v50, v50
    v_exp_f32 v51, v51
    v_exp_f32 v52, v52
    v_exp_f32 v53, v53
    v_exp_f32 v54, v54
    v_exp_f32 v55, v55
    v_exp_f32 v56, v56
    v_exp_f32 v57, v57
    s_waitcnt lgkmcnt(3)
    v_mfma_f32_32x32x16_bf16 v[106:121], v[94:97], v[78:81], v[106:121]
    v_cvt_pk_bf16_f32 v82, v42, v43
    v_cvt_pk_bf16_f32 v83, v44, v45
    v_cvt_pk_bf16_f32 v84, v46, v47
    v_cvt_pk_bf16_f32 v85, v48, v49
    v_cvt_pk_bf16_f32 v86, v50, v51
    v_cvt_pk_bf16_f32 v87, v52, v53
    v_cvt_pk_bf16_f32 v88, v54, v55
    v_cvt_pk_bf16_f32 v89, v56, v57
    ds_read_b128 v[14:17], v6 offset:27648
    s_waitcnt lgkmcnt(3)
    v_mfma_f32_32x32x16_bf16 v[42:57], v[22:25], v[10:13], v[58:73]
    s_mov_b64 exec, s[20:21]
    ds_read_b128 v[90:93], v7 offset:53248
    ds_read_b128 v[94:97], v7 offset:53760
    s_mov_b64 exec, -1
    v_exp_f32 v26, v26
    v_exp_f32 v27, v27
    v_exp_f32 v28, v28
    v_exp_f32 v29, v29
    v_exp_f32 v30, v30
    v_exp_f32 v31, v31
    v_exp_f32 v32, v32
    v_exp_f32 v33, v33
    s_waitcnt lgkmcnt(4)
    v_mfma_f32_32x32x16_bf16 v[106:121], v[98:101], v[82:85], v[106:121]
    v_exp_f32 v34, v34
    v_exp_f32 v35, v35
    v_exp_f32 v36, v36
    v_exp_f32 v37, v37
    v_exp_f32 v38, v38
    v_exp_f32 v39, v39
    v_exp_f32 v40, v40
    v_exp_f32 v41, v41
    s_waitcnt lgkmcnt(3)
    v_mfma_f32_32x32x16_bf16 v[106:121], v[102:105], v[86:89], v[106:121]
    v_cvt_pk_bf16_f32 v74, v26, v27
    v_cvt_pk_bf16_f32 v75, v28, v29
    v_cvt_pk_bf16_f32 v76, v30, v31
    v_cvt_pk_bf16_f32 v77, v32, v33
    v_cvt_pk_bf16_f32 v78, v34, v35
    v_cvt_pk_bf16_f32 v79, v36, v37
    v_cvt_pk_bf16_f32 v80, v38, v39
    v_cvt_pk_bf16_f32 v81, v40, v41
    ds_read_b128 v[18:21], v6 offset:28160
    s_waitcnt lgkmcnt(3)
    v_mfma_f32_32x32x16_bf16 v[26:41], v[14:17], v[10:13], v[58:73]
    s_mov_b64 exec, s[20:21]
    ds_read_b128 v[98:101], v7 offset:54272
    ds_read_b128 v[102:105], v7 offset:54784
    s_mov_b64 exec, -1
    v_exp_f32 v42, v42
    v_exp_f32 v43, v43
    v_exp_f32 v44, v44
    v_exp_f32 v45, v45
    v_exp_f32 v46, v46
    v_exp_f32 v47, v47
    v_exp_f32 v48, v48
    v_exp_f32 v49, v49
    s_waitcnt lgkmcnt(4)
    v_mfma_f32_32x32x16_bf16 v[106:121], v[90:93], v[74:77], v[106:121]
    v_exp_f32 v50, v50
    v_exp_f32 v51, v51
    v_exp_f32 v52, v52
    v_exp_f32 v53, v53
    v_exp_f32 v54, v54
    v_exp_f32 v55, v55
    v_exp_f32 v56, v56
    v_exp_f32 v57, v57
    s_waitcnt lgkmcnt(3)
    v_mfma_f32_32x32x16_bf16 v[106:121], v[94:97], v[78:81], v[106:121]
    v_cvt_pk_bf16_f32 v82, v42, v43
    v_cvt_pk_bf16_f32 v83, v44, v45
    v_cvt_pk_bf16_f32 v84, v46, v47
    v_cvt_pk_bf16_f32 v85, v48, v49
    v_cvt_pk_bf16_f32 v86, v50, v51
    v_cvt_pk_bf16_f32 v87, v52, v53
    v_cvt_pk_bf16_f32 v88, v54, v55
    v_cvt_pk_bf16_f32 v89, v56, v57
    ds_read_b128 v[22:25], v6 offset:28672
    s_waitcnt lgkmcnt(3)
    v_mfma_f32_32x32x16_bf16 v[42:57], v[18:21], v[10:13], v[58:73]
    s_mov_b64 exec, s[20:21]
    ds_read_b128 v[90:93], v7 offset:55296
    ds_read_b128 v[94:97], v7 offset:55808
    s_mov_b64 exec, -1
    v_exp_f32 v26, v26
    v_exp_f32 v27, v27
    v_exp_f32 v28, v28
    v_exp_f32 v29, v29
    v_exp_f32 v30, v30
    v_exp_f32 v31, v31
    v_exp_f32 v32, v32
    v_exp_f32 v33, v33
    s_waitcnt lgkmcnt(4)
    v_mfma_f32_32x32x16_bf16 v[106:121], v[98:101], v[82:85], v[106:121]
    v_exp_f32 v34, v34
    v_exp_f32 v35, v35
    v_exp_f32 v36, v36
    v_exp_f32 v37, v37
    v_exp_f32 v38, v38
    v_exp_f32 v39, v39
    v_exp_f32 v40, v40
    v_exp_f32 v41, v41
    s_waitcnt lgkmcnt(3)
    v_mfma_f32_32x32x16_bf16 v[106:121], v[102:105], v[86:89], v[106:121]
    v_cvt_pk_bf16_f32 v74, v26, v27
    v_cvt_pk_bf16_f32 v75, v28, v29
    v_cvt_pk_bf16_f32 v76, v30, v31
    v_cvt_pk_bf16_f32 v77, v32, v33
    v_cvt_pk_bf16_f32 v78, v34, v35
    v_cvt_pk_bf16_f32 v79, v36, v37
    v_cvt_pk_bf16_f32 v80, v38, v39
    v_cvt_pk_bf16_f32 v81, v40, v41
    ds_read_b128 v[14:17], v6 offset:29184
    s_waitcnt lgkmcnt(3)
    v_mfma_f32_32x32x16_bf16 v[26:41], v[22:25], v[10:13], v[58:73]
    s_mov_b64 exec, s[20:21]
    ds_read_b128 v[98:101], v7 offset:56320
    ds_read_b128 v[102:105], v7 offset:56832
    s_mov_b64 exec, -1
    v_exp_f32 v42, v42
    v_exp_f32 v43, v43
    v_exp_f32 v44, v44
    v_exp_f32 v45, v45
    v_exp_f32 v46, v46
    v_exp_f32 v47, v47
    v_exp_f32 v48, v48
    v_exp_f32 v49, v49
    s_waitcnt lgkmcnt(4)
    v_mfma_f32_32x32x16_bf16 v[106:121], v[90:93], v[74:77], v[106:121]
    v_exp_f32 v50, v50
    v_exp_f32 v51, v51
    v_exp_f32 v52, v52
    v_exp_f32 v53, v53
    v_exp_f32 v54, v54
    v_exp_f32 v55, v55
    v_exp_f32 v56, v56
    v_exp_f32 v57, v57
    s_waitcnt lgkmcnt(3)
    v_mfma_f32_32x32x16_bf16 v[106:121], v[94:97], v[78:81], v[106:121]
    v_cvt_pk_bf16_f32 v82, v42, v43
    v_cvt_pk_bf16_f32 v83, v44, v45
    v_cvt_pk_bf16_f32 v84, v46, v47
    v_cvt_pk_bf16_f32 v85, v48, v49
    v_cvt_pk_bf16_f32 v86, v50, v51
    v_cvt_pk_bf16_f32 v87, v52, v53
    v_cvt_pk_bf16_f32 v88, v54, v55
    v_cvt_pk_bf16_f32 v89, v56, v57
    ds_read_b128 v[18:21], v6 offset:29696
    s_waitcnt lgkmcnt(3)
    v_mfma_f32_32x32x16_bf16 v[42:57], v[14:17], v[10:13], v[58:73]
    s_mov_b64 exec, s[20:21]
    ds_read_b128 v[90:93], v7 offset:57344
    ds_read_b128 v[94:97], v7 offset:57856
    s_mov_b64 exec, -1
    v_exp_f32 v26, v26
    v_exp_f32 v27, v27
    v_exp_f32 v28, v28
    v_exp_f32 v29, v29
    v_exp_f32 v30, v30
    v_exp_f32 v31, v31
    v_exp_f32 v32, v32
    v_exp_f32 v33, v33
    s_waitcnt lgkmcnt(4)
    v_mfma_f32_32x32x16_bf16 v[106:121], v[98:101], v[82:85], v[106:121]
    v_exp_f32 v34, v34
    v_exp_f32 v35, v35
    v_exp_f32 v36, v36
    v_exp_f32 v37, v37
    v_exp_f32 v38, v38
    v_exp_f32 v39, v39
    v_exp_f32 v40, v40
    v_exp_f32 v41, v41
    s_waitcnt lgkmcnt(3)
    v_mfma_f32_32x32x16_bf16 v[106:121], v[102:105], v[86:89], v[106:121]
    v_cvt_pk_bf16_f32 v74, v26, v27
    v_cvt_pk_bf16_f32 v75, v28, v29
    v_cvt_pk_bf16_f32 v76, v30, v31
    v_cvt_pk_bf16_f32 v77, v32, v33
    v_cvt_pk_bf16_f32 v78, v34, v35
    v_cvt_pk_bf16_f32 v79, v36, v37
    v_cvt_pk_bf16_f32 v80, v38, v39
    v_cvt_pk_bf16_f32 v81, v40, v41
    ds_read_b128 v[22:25], v6 offset:30208
    s_waitcnt lgkmcnt(3)
    v_mfma_f32_32x32x16_bf16 v[26:41], v[18:21], v[10:13], v[58:73]
    s_mov_b64 exec, s[20:21]
    ds_read_b128 v[98:101], v7 offset:58368
    ds_read_b128 v[102:105], v7 offset:58880
    s_mov_b64 exec, -1
    v_exp_f32 v42, v42
    v_exp_f32 v43, v43
    v_exp_f32 v44, v44
    v_exp_f32 v45, v45
    v_exp_f32 v46, v46
    v_exp_f32 v47, v47
    v_exp_f32 v48, v48
    v_exp_f32 v49, v49
    s_waitcnt lgkmcnt(4)
    v_mfma_f32_32x32x16_bf16 v[106:121], v[90:93], v[74:77], v[106:121]
    v_exp_f32 v50, v50
    v_exp_f32 v51, v51
    v_exp_f32 v52, v52
    v_exp_f32 v53, v53
    v_exp_f32 v54, v54
    v_exp_f32 v55, v55
    v_exp_f32 v56, v56
    v_exp_f32 v57, v57
    s_waitcnt lgkmcnt(3)
    v_mfma_f32_32x32x16_bf16 v[106:121], v[94:97], v[78:81], v[106:121]
    v_cvt_pk_bf16_f32 v82, v42, v43
    v_cvt_pk_bf16_f32 v83, v44, v45
    v_cvt_pk_bf16_f32 v84, v46, v47
    v_cvt_pk_bf16_f32 v85, v48, v49
    v_cvt_pk_bf16_f32 v86, v50, v51
    v_cvt_pk_bf16_f32 v87, v52, v53
    v_cvt_pk_bf16_f32 v88, v54, v55
    v_cvt_pk_bf16_f32 v89, v56, v57
    ds_read_b128 v[14:17], v6 offset:30720
    s_waitcnt lgkmcnt(3)
    v_mfma_f32_32x32x16_bf16 v[42:57], v[22:25], v[10:13], v[58:73]
    s_mov_b64 exec, s[20:21]
    ds_read_b128 v[90:93], v7 offset:59392
    ds_read_b128 v[94:97], v7 offset:59904
    s_mov_b64 exec, -1
    v_exp_f32 v26, v26
    v_exp_f32 v27, v27
    v_exp_f32 v28, v28
    v_exp_f32 v29, v29
    v_exp_f32 v30, v30
    v_exp_f32 v31, v31
    v_exp_f32 v32, v32
    v_exp_f32 v33, v33
    s_waitcnt lgkmcnt(4)
    v_mfma_f32_32x32x16_bf16 v[106:121], v[98:101], v[82:85], v[106:121]
    v_exp_f32 v34, v34
    v_exp_f32 v35, v35
    v_exp_f32 v36, v36
    v_exp_f32 v37, v37
    v_exp_f32 v38, v38
    v_exp_f32 v39, v39
    v_exp_f32 v40, v40
    v_exp_f32 v41, v41
    s_waitcnt lgkmcnt(3)
    v_mfma_f32_32x32x16_bf16 v[106:121], v[102:105], v[86:89], v[106:121]
    v_cvt_pk_bf16_f32 v74, v26, v27
    v_cvt_pk_bf16_f32 v75, v28, v29
    v_cvt_pk_bf16_f32 v76, v30, v31
    v_cvt_pk_bf16_f32 v77, v32, v33
    v_cvt_pk_bf16_f32 v78, v34, v35
    v_cvt_pk_bf16_f32 v79, v36, v37
    v_cvt_pk_bf16_f32 v80, v38, v39
    v_cvt_pk_bf16_f32 v81, v40, v41
    ds_read_b128 v[18:21], v6 offset:31232
    s_waitcnt lgkmcnt(3)
    v_mfma_f32_32x32x16_bf16 v[26:41], v[14:17], v[10:13], v[58:73]
    s_mov_b64 exec, s[20:21]
    ds_read_b128 v[98:101], v7 offset:60416
    ds_read_b128 v[102:105], v7 offset:60928
    s_mov_b64 exec, -1
    v_exp_f32 v42, v42
    v_exp_f32 v43, v43
    v_exp_f32 v44, v44
    v_exp_f32 v45, v45
    v_exp_f32 v46, v46
    v_exp_f32 v47, v47
    v_exp_f32 v48, v48
    v_exp_f32 v49, v49
    s_waitcnt lgkmcnt(4)
    v_mfma_f32_32x32x16_bf16 v[106:121], v[90:93], v[74:77], v[106:121]
    v_exp_f32 v50, v50
    v_exp_f32 v51, v51
    v_exp_f32 v52, v52
    v_exp_f32 v53, v53
    v_exp_f32 v54, v54
    v_exp_f32 v55, v55
    v_exp_f32 v56, v56
    v_exp_f32 v57, v57
    s_waitcnt lgkmcnt(3)
    v_mfma_f32_32x32x16_bf16 v[106:121], v[94:97], v[78:81], v[106:121]
    v_cvt_pk_bf16_f32 v82, v42, v43
    v_cvt_pk_bf16_f32 v83, v44, v45
    v_cvt_pk_bf16_f32 v84, v46, v47
    v_cvt_pk_bf16_f32 v85, v48, v49
    v_cvt_pk_bf16_f32 v86, v50, v51
    v_cvt_pk_bf16_f32 v87, v52, v53
    v_cvt_pk_bf16_f32 v88, v54, v55
    v_cvt_pk_bf16_f32 v89, v56, v57
    ds_read_b128 v[22:25], v6 offset:31744
    s_waitcnt lgkmcnt(3)
    v_mfma_f32_32x32x16_bf16 v[42:57], v[18:21], v[10:13], v[58:73]
    s_mov_b64 exec, s[20:21]
    ds_read_b128 v[90:93], v7 offset:61440
    ds_read_b128 v[94:97], v7 offset:61952
    s_mov_b64 exec, -1
    v_exp_f32 v26, v26
    v_exp_f32 v27, v27
    v_exp_f32 v28, v28
    v_exp_f32 v29, v29
    v_exp_f32 v30, v30
    v_exp_f32 v31, v31
    v_exp_f32 v32, v32
    v_exp_f32 v33, v33
    s_waitcnt lgkmcnt(4)
    v_mfma_f32_32x32x16_bf16 v[106:121], v[98:101], v[82:85], v[106:121]
    v_exp_f32 v34, v34
    v_exp_f32 v35, v35
    v_exp_f32 v36, v36
    v_exp_f32 v37, v37
    v_exp_f32 v38, v38
    v_exp_f32 v39, v39
    v_exp_f32 v40, v40
    v_exp_f32 v41, v41
    s_waitcnt lgkmcnt(3)
    v_mfma_f32_32x32x16_bf16 v[106:121], v[102:105], v[86:89], v[106:121]
    v_cvt_pk_bf16_f32 v74, v26, v27
    v_cvt_pk_bf16_f32 v75, v28, v29
    v_cvt_pk_bf16_f32 v76, v30, v31
    v_cvt_pk_bf16_f32 v77, v32, v33
    v_cvt_pk_bf16_f32 v78, v34, v35
    v_cvt_pk_bf16_f32 v79, v36, v37
    v_cvt_pk_bf16_f32 v80, v38, v39
    v_cvt_pk_bf16_f32 v81, v40, v41
    ds_read_b128 v[14:17], v6 offset:32256
    s_waitcnt lgkmcnt(3)
    v_mfma_f32_32x32x16_bf16 v[26:41], v[22:25], v[10:13], v[58:73]
    s_mov_b64 exec, s[20:21]
    ds_read_b128 v[98:101], v7 offset:62464
    ds_read_b128 v[102:105], v7 offset:62976
    s_mov_b64 exec, -1
    v_exp_f32 v42, v42
    v_exp_f32 v43, v43
    v_exp_f32 v44, v44
    v_exp_f32 v45, v45
    v_exp_f32 v46, v46
    v_exp_f32 v47, v47
    v_exp_f32 v48, v48
    v_exp_f32 v49, v49
    s_waitcnt lgkmcnt(4)
    v_mfma_f32_32x32x16_bf16 v[106:121], v[90:93], v[74:77], v[106:121]
    v_exp_f32 v50, v50
    v_exp_f32 v51, v51
    v_exp_f32 v52, v52
    v_exp_f32 v53, v53
    v_exp_f32 v54, v54
    v_exp_f32 v55, v55
    v_exp_f32 v56, v56
    v_exp_f32 v57, v57
    s_waitcnt lgkmcnt(3)
    v_mfma_f32_32x32x16_bf16 v[106:121], v[94:97], v[78:81], v[106:121]
    v_cvt_pk_bf16_f32 v82, v42, v43
    v_cvt_pk_bf16_f32 v83, v44, v45
    v_cvt_pk_bf16_f32 v84, v46, v47
    v_cvt_pk_bf16_f32 v85, v48, v49
    v_cvt_pk_bf16_f32 v86, v50, v51
    v_cvt_pk_bf16_f32 v87, v52, v53
    v_cvt_pk_bf16_f32 v88, v54, v55
    v_cvt_pk_bf16_f32 v89, v56, v57
    s_waitcnt lgkmcnt(2)
    v_mfma_f32_32x32x16_bf16 v[42:57], v[14:17], v[10:13], v[58:73]
    s_mov_b64 exec, s[20:21]
    ds_read_b128 v[90:93], v7 offset:63488
    ds_read_b128 v[94:97], v7 offset:64000
    s_mov_b64 exec, -1
    v_exp_f32 v26, v26
    v_exp_f32 v27, v27
    v_exp_f32 v28, v28
    v_exp_f32 v29, v29
    v_exp_f32 v30, v30
    v_exp_f32 v31, v31
    v_exp_f32 v32, v32
    v_exp_f32 v33, v33
    s_waitcnt lgkmcnt(3)
    v_mfma_f32_32x32x16_bf16 v[106:121], v[98:101], v[82:85], v[106:121]
    v_exp_f32 v34, v34
    v_exp_f32 v35, v35
    v_exp_f32 v36, v36
    v_exp_f32 v37, v37
    v_exp_f32 v38, v38
    v_exp_f32 v39, v39
    v_exp_f32 v40, v40
    v_exp_f32 v41, v41
    s_waitcnt lgkmcnt(2)
    v_mfma_f32_32x32x16_bf16 v[106:121], v[102:105], v[86:89], v[106:121]
    v_cvt_pk_bf16_f32 v74, v26, v27
    v_cvt_pk_bf16_f32 v75, v28, v29
    v_cvt_pk_bf16_f32 v76, v30, v31
    v_cvt_pk_bf16_f32 v77, v32, v33
    v_cvt_pk_bf16_f32 v78, v34, v35
    v_cvt_pk_bf16_f32 v79, v36, v37
    v_cvt_pk_bf16_f32 v80, v38, v39
    v_cvt_pk_bf16_f32 v81, v40, v41
    s_mov_b64 exec, s[20:21]
    ds_read_b128 v[98:101], v7 offset:64512
    ds_read_b128 v[102:105], v7 offset:65024
    s_mov_b64 exec, -1
    v_exp_f32 v42, v42
    v_exp_f32 v43, v43
    v_exp_f32 v44, v44
    v_exp_f32 v45, v45
    v_exp_f32 v46, v46
    v_exp_f32 v47, v47
    v_exp_f32 v48, v48
    v_exp_f32 v49, v49
    s_waitcnt lgkmcnt(3)
    v_mfma_f32_32x32x16_bf16 v[106:121], v[90:93], v[74:77], v[106:121]
    v_exp_f32 v50, v50
    v_exp_f32 v51, v51
    v_exp_f32 v52, v52
    v_exp_f32 v53, v53
    v_exp_f32 v54, v54
    v_exp_f32 v55, v55
    v_exp_f32 v56, v56
    v_exp_f32 v57, v57
    s_waitcnt lgkmcnt(2)
    v_mfma_f32_32x32x16_bf16 v[106:121], v[94:97], v[78:81], v[106:121]
    v_cvt_pk_bf16_f32 v82, v42, v43
    v_cvt_pk_bf16_f32 v83, v44, v45
    v_cvt_pk_bf16_f32 v84, v46, v47
    v_cvt_pk_bf16_f32 v85, v48, v49
    v_cvt_pk_bf16_f32 v86, v50, v51
    v_cvt_pk_bf16_f32 v87, v52, v53
    v_cvt_pk_bf16_f32 v88, v54, v55
    v_cvt_pk_bf16_f32 v89, v56, v57
    s_waitcnt lgkmcnt(1)
    v_mfma_f32_32x32x16_bf16 v[106:121], v[98:101], v[82:85], v[106:121]
    s_waitcnt lgkmcnt(0)
    v_mfma_f32_32x32x16_bf16 v[106:121], v[102:105], v[86:89], v[106:121]
    s_nop 11
    v_cmp_gt_f32 vcc, 0x21800000, v114
    s_nop 1
    s_cmp_lg_u64 vcc, 0
    s_cbranch_scc0 L_a_done
    v_mov_b32 v8, 0xff800000
    ds_read_b128 v[14:17], v6 offset:0
    ds_read_b128 v[18:21], v6 offset:512
    ds_read_b128 v[22:25], v6 offset:1024
    s_waitcnt lgkmcnt(2)
    v_mfma_f32_32x32x16_bf16 v[26:41], v[14:17], v[10:13], 0
    ds_read_b128 v[14:17], v6 offset:1536
    s_waitcnt lgkmcnt(2)
    v_mfma_f32_32x32x16_bf16 v[42:57], v[18:21], v[10:13], 0
    s_nop 8
    v_max3_f32 v8, v8, v26, v27
    v_max3_f32 v8, v8, v28, v29
    v_max3_f32 v8, v8, v30, v31
    v_max3_f32 v8, v8, v32, v33
    v_max3_f32 v8, v8, v34, v35
    v_max3_f32 v8, v8, v36, v37
    v_max3_f32 v8, v8, v38, v39
    v_max3_f32 v8, v8, v40, v41
    ds_read_b128 v[18:21], v6 offset:2048
    s_waitcnt lgkmcnt(2)
    v_mfma_f32_32x32x16_bf16 v[26:41], v[22:25], v[10:13], 0
    v_max3_f32 v8, v8, v42, v43
    v_max3_f32 v8, v8, v44, v45
    v_max3_f32 v8, v8, v46, v47
    v_max3_f32 v8, v8, v48, v49
    v_max3_f32 v8, v8, v50, v51
    v_max3_f32 v8, v8, v52, v53
    v_max3_f32 v8, v8, v54, v55
    v_max3_f32 v8, v8, v56, v57
    ds_read_b128 v[22:25], v6 offset:2560
    s_waitcnt lgkmcnt(2)
    v_mfma_f32_32x32x16_bf16 v[42:57], v[14:17], v[10:13], 0
    s_nop 0
    v_max3_f32 v8, v8, v26, v27
    v_max3_f32 v8, v8, v28, v29
    v_max3_f32 v8, v8, v30, v31
    v_max3_f32 v8, v8, v32, v33
    v_max3_f32 v8, v8, v34, v35
    v_max3_f32 v8, v8, v36, v37
    v_max3_f32 v8, v8, v38, v39
    v_max3_f32 v8, v8, v40, v41
    ds_read_b128 v[14:17], v6 offset:3072
    s_waitcnt lgkmcnt(2)
    v_mfma_f32_32x32x16_bf16 v[26:41], v[18:21], v[10:13], 0
    v_max3_f32 v8, v8, v42, v43
    v_max3_f32 v8, v8, v44, v45
    v_max3_f32 v8, v8, v46, v47
    v_max3_f32 v8, v8, v48, v49
    v_max3_f32 v8, v8, v50, v51
    v_max3_f32 v8, v8, v52, v53
    v_max3_f32 v8, v8, v54, v55
    v_max3_f32 v8, v8, v56, v57
    ds_read_b128 v[18:21], v6 offset:3584
    s_waitcnt lgkmcnt(2)
    v_mfma_f32_32x32x16_bf16 v[42:57], v[22:25], v[10:13], 0
    s_nop 0
    v_max3_f32 v8, v8, v26, v27
    v_max3_f32 v8, v8, v28, v29
    v_max3_f32 v8, v8, v30, v31
    v_max3_f32 v8, v8, v32, v33
    v_max3_f32 v8, v8, v34, v35
    v_max3_f32 v8, v8, v36, v37
    v_max3_f32 v8, v8, v38, v39
    v_max3_f32 v8, v8, v40, v41
    ds_read_b128 v[22:25], v6 offset:4096
    s_waitcnt lgkmcnt(2)
    v_mfma_f32_32x32x16_bf16 v[26:41], v[14:17], v[10:13], 0
    v_max3_f32 v8, v8, v42, v43
    v_max3_f32 v8, v8, v44, v45
    v_max3_f32 v8, v8, v46, v47
    v_max3_f32 v8, v8, v48, v49
    v_max3_f32 v8, v8, v50, v51
    v_max3_f32 v8, v8, v52, v53
    v_max3_f32 v8, v8, v54, v55
    v_max3_f32 v8, v8, v56, v57
    ds_read_b128 v[14:17], v6 offset:4608
    s_waitcnt lgkmcnt(2)
    v_mfma_f32_32x32x16_bf16 v[42:57], v[18:21], v[10:13], 0
    s_nop 0
    v_max3_f32 v8, v8, v26, v27
    v_max3_f32 v8, v8, v28, v29
    v_max3_f32 v8, v8, v30, v31
    v_max3_f32 v8, v8, v32, v33
    v_max3_f32 v8, v8, v34, v35
    v_max3_f32 v8, v8, v36, v37
    v_max3_f32 v8, v8, v38, v39
    v_max3_f32 v8, v8, v40, v41
    ds_read_b128 v[18:21], v6 offset:5120
    s_waitcnt lgkmcnt(2)
    v_mfma_f32_32x32x16_bf16 v[26:41], v[22:25], v[10:13], 0
    v_max3_f32 v8, v8, v42, v43
    v_max3_f32 v8, v8, v44, v45
    v_max3_f32 v8, v8, v46, v47
    v_max3_f32 v8, v8, v48, v49
    v_max3_f32 v8, v8, v50, v51
    v_max3_f32 v8, v8, v52, v53
    v_max3_f32 v8, v8, v54, v55
    v_max3_f32 v8, v8, v56, v57
    ds_read_b128 v[22:25], v6 offset:5632
    s_waitcnt lgkmcnt(2)
    v_mfma_f32_32x32x16_bf16 v[42:57], v[14:17], v[10:13], 0
    s_nop 0
    v_max3_f32 v8, v8, v26, v27
    v_max3_f32 v8, v8, v28, v29
    v_max3_f32 v8, v8, v30, v31
    v_max3_f32 v8, v8, v32, v33
    v_max3_f32 v8, v8, v34, v35
    v_max3_f32 v8, v8, v36, v37
    v_max3_f32 v8, v8, v38, v39
    v_max3_f32 v8, v8, v40, v41
    ds_read_b128 v[14:17], v6 offset:6144
    s_waitcnt lgkmcnt(2)
    v_mfma_f32_32x32x16_bf16 v[26:41], v[18:21], v[10:13], 0
    v_max3_f32 v8, v8, v42, v43
    v_max3_f32 v8, v8, v44, v45
    v_max3_f32 v8, v8, v46, v47
    v_max3_f32 v8, v8, v48, v49
    v_max3_f32 v8, v8, v50, v51
    v_max3_f32 v8, v8, v52, v53
    v_max3_f32 v8, v8, v54, v55
    v_max3_f32 v8, v8, v56, v57
    ds_read_b128 v[18:21], v6 offset:6656
    s_waitcnt lgkmcnt(2)
    v_mfma_f32_32x32x16_bf16 v[42:57], v[22:25], v[10:13], 0
    s_nop 0
    v_max3_f32 v8, v8, v26, v27
    v_max3_f32 v8, v8, v28, v29
    v_max3_f32 v8, v8, v30, v31
    v_max3_f32 v8, v8, v32, v33
    v_max3_f32 v8, v8, v34, v35
    v_max3_f32 v8, v8, v36, v37
    v_max3_f32 v8, v8, v38, v39
    v_max3_f32 v8, v8, v40, v41
    ds_read_b128 v[22:25], v6 offset:7168
    s_waitcnt lgkmcnt(2)
    v_mfma_f32_32x32x16_bf16 v[26:41], v[14:17], v[10:13], 0
    v_max3_f32 v8, v8, v42, v43
    v_max3_f32 v8, v8, v44, v45
    v_max3_f32 v8, v8, v46, v47
    v_max3_f32 v8, v8, v48, v49
    v_max3_f32 v8, v8, v50, v51
    v_max3_f32 v8, v8, v52, v53
    v_max3_f32 v8, v8, v54, v55
    v_max3_f32 v8, v8, v56, v57
    ds_read_b128 v[14:17], v6 offset:7680
    s_waitcnt lgkmcnt(2)
    v_mfma_f32_32x32x16_bf16 v[42:57], v[18:21], v[10:13], 0
    s_nop 0
    v_max3_f32 v8, v8, v26, v27
    v_max3_f32 v8, v8, v28, v29
    v_max3_f32 v8, v8, v30, v31
    v_max3_f32 v8, v8, v32, v33
    v_max3_f32 v8, v8, v34, v35
    v_max3_f32 v8, v8, v36, v37
    v_max3_f32 v8, v8, v38, v39
    v_max3_f32 v8, v8, v40, v41
    ds_read_b128 v[18:21], v6 offset:8192
    s_waitcnt lgkmcnt(2)
    v_mfma_f32_32x32x16_bf16 v[26:41], v[22:25], v[10:13], 0
    v_max3_f32 v8, v8, v42, v43
    v_max3_f32 v8, v8, v44, v45
    v_max3_f32 v8, v8, v46, v47
    v_max3_f32 v8, v8, v48, v49
    v_max3_f32 v8, v8, v50, v51
    v_max3_f32 v8, v8, v52, v53
    v_max3_f32 v8, v8, v54, v55
    v_max3_f32 v8, v8, v56, v57
    ds_read_b128 v[22:25], v6 offset:8704
    s_waitcnt lgkmcnt(2)
    v_mfma_f32_32x32x16_bf16 v[42:57], v[14:17], v[10:13], 0
    s_nop 0
    v_max3_f32 v8, v8, v26, v27
    v_max3_f32 v8, v8, v28, v29
    v_max3_f32 v8, v8, v30, v31
    v_max3_f32 v8, v8, v32, v33
    v_max3_f32 v8, v8, v34, v35
    v_max3_f32 v8, v8, v36, v37
    v_max3_f32 v8, v8, v38, v39
    v_max3_f32 v8, v8, v40, v41
    ds_read_b128 v[14:17], v6 offset:9216
    s_waitcnt lgkmcnt(2)
    v_mfma_f32_32x32x16_bf16 v[26:41], v[18:21], v[10:13], 0
    v_max3_f32 v8, v8, v42, v43
    v_max3_f32 v8, v8, v44, v45
    v_max3_f32 v8, v8, v46, v47
    v_max3_f32 v8, v8, v48, v49
    v_max3_f32 v8, v8, v50, v51
    v_max3_f32 v8, v8, v52, v53
    v_max3_f32 v8, v8, v54, v55
    v_max3_f32 v8, v8, v56, v57
    ds_read_b128 v[18:21], v6 offset:9728
    s_waitcnt lgkmcnt(2)
    v_mfma_f32_32x32x16_bf16 v[42:57], v[22:25], v[10:13], 0
    s_nop 0
    v_max3_f32 v8, v8, v26, v27
    v_max3_f32 v8, v8, v28, v29
    v_max3_f32 v8, v8, v30, v31
    v_max3_f32 v8, v8, v32, v33
    v_max3_f32 v8, v8, v34, v35
    v_max3_f32 v8, v8, v36, v37
    v_max3_f32 v8, v8, v38, v39
    v_max3_f32 v8, v8, v40, v41
    ds_read_b128 v[22:25], v6 offset:10240
    s_waitcnt lgkmcnt(2)
    v_mfma_f32_32x32x16_bf16 v[26:41], v[14:17], v[10:13], 0
    v_max3_f32 v8, v8, v42, v43
    v_max3_f32 v8, v8, v44, v45
    v_max3_f32 v8, v8, v46, v47
    v_max3_f32 v8, v8, v48, v49
    v_max3_f32 v8, v8, v50, v51
    v_max3_f32 v8, v8, v52, v53
    v_max3_f32 v8, v8, v54, v55
    v_max3_f32 v8, v8, v56, v57
    ds_read_b128 v[14:17], v6 offset:10752
    s_waitcnt lgkmcnt(2)
    v_mfma_f32_32x32x16_bf16 v[42:57], v[18:21], v[10:13], 0
    s_nop 0
    v_max3_f32 v8, v8, v26, v27
    v_max3_f32 v8, v8, v28, v29
    v_max3_f32 v8, v8, v30, v31
    v_max3_f32 v8, v8, v32, v33
    v_max3_f32 v8, v8, v34, v35
    v_max3_f32 v8, v8, v36, v37
    v_max3_f32 v8, v8, v38, v39
    v_max3_f32 v8, v8, v40, v41
    ds_read_b128 v[18:21], v6 offset:11264
    s_waitcnt lgkmcnt(2)
    v_mfma_f32_32x32x16_bf16 v[26:41], v[22:25], v[10:13], 0
    v_max3_f32 v8, v8, v42, v43
    v_max3_f32 v8, v8, v44, v45
    v_max3_f32 v8, v8, v46, v47
    v_max3_f32 v8, v8, v48, v49
    v_max3_f32 v8, v8, v50, v51
    v_max3_f32 v8, v8, v52, v53
    v_max3_f32 v8, v8, v54, v55
    v_max3_f32 v8, v8, v56, v57
    ds_read_b128 v[22:25], v6 offset:11776
    s_waitcnt lgkmcnt(2)
    v_mfma_f32_32x32x16_bf16 v[42:57], v[14:17], v[10:13], 0
    s_nop 0
    v_max3_f32 v8, v8, v26, v27
    v_max3_f32 v8, v8, v28, v29
    v_max3_f32 v8, v8, v30, v31
    v_max3_f32 v8, v8, v32, v33
    v_max3_f32 v8, v8, v34, v35
    v_max3_f32 v8, v8, v36, v37
    v_max3_f32 v8, v8, v38, v39
    v_max3_f32 v8, v8, v40, v41
    ds_read_b128 v[14:17], v6 offset:12288
    s_waitcnt lgkmcnt(2)
    v_mfma_f32_32x32x16_bf16 v[26:41], v[18:21], v[10:13], 0
    v_max3_f32 v8, v8, v42, v43
    v_max3_f32 v8, v8, v44, v45
    v_max3_f32 v8, v8, v46, v47
    v_max3_f32 v8, v8, v48, v49
    v_max3_f32 v8, v8, v50, v51
    v_max3_f32 v8, v8, v52, v53
    v_max3_f32 v8, v8, v54, v55
    v_max3_f32 v8, v8, v56, v57
    ds_read_b128 v[18:21], v6 offset:12800
    s_waitcnt lgkmcnt(2)
    v_mfma_f32_32x32x16_bf16 v[42:57], v[22:25], v[10:13], 0
    s_nop 0
    v_max3_f32 v8, v8, v26, v27
    v_max3_f32 v8, v8, v28, v29
    v_max3_f32 v8, v8, v30, v31
    v_max3_f32 v8, v8, v32, v33
    v_max3_f32 v8, v8, v34, v35
    v_max3_f32 v8, v8, v36, v37
    v_max3_f32 v8, v8, v38, v39
    v_max3_f32 v8, v8, v40, v41
    ds_read_b128 v[22:25], v6 offset:13312
    s_waitcnt lgkmcnt(2)
    v_mfma_f32_32x32x16_bf16 v[26:41], v[14:17], v[10:13], 0
    v_max3_f32 v8, v8, v42, v43
    v_max3_f32 v8, v8, v44, v45
    v_max3_f32 v8, v8, v46, v47
    v_max3_f32 v8, v8, v48, v49
    v_max3_f32 v8, v8, v50, v51
    v_max3_f32 v8, v8, v52, v53
    v_max3_f32 v8, v8, v54, v55
    v_max3_f32 v8, v8, v56, v57
    ds_read_b128 v[14:17], v6 offset:13824
    s_waitcnt lgkmcnt(2)
    v_mfma_f32_32x32x16_bf16 v[42:57], v[18:21], v[10:13], 0
    s_nop 0
    v_max3_f32 v8, v8, v26, v27
    v_max3_f32 v8, v8, v28, v29
    v_max3_f32 v8, v8, v30, v31
    v_max3_f32 v8, v8, v32, v33
    v_max3_f32 v8, v8, v34, v35
    v_max3_f32 v8, v8, v36, v37
    v_max3_f32 v8, v8, v38, v39
    v_max3_f32 v8, v8, v40, v41
    ds_read_b128 v[18:21], v6 offset:14336
    s_waitcnt lgkmcnt(2)
    v_mfma_f32_32x32x16_bf16 v[26:41], v[22:25], v[10:13], 0
    v_max3_f32 v8, v8, v42, v43
    v_max3_f32 v8, v8, v44, v45
    v_max3_f32 v8, v8, v46, v47
    v_max3_f32 v8, v8, v48, v49
    v_max3_f32 v8, v8, v50, v51
    v_max3_f32 v8, v8, v52, v53
    v_max3_f32 v8, v8, v54, v55
    v_max3_f32 v8, v8, v56, v57
    ds_read_b128 v[22:25], v6 offset:14848
    s_waitcnt lgkmcnt(2)
    v_mfma_f32_32x32x16_bf16 v[42:57], v[14:17], v[10:13], 0
    s_nop 0
    v_max3_f32 v8, v8, v26, v27
    v_max3_f32 v8, v8, v28, v29
    v_max3_f32 v8, v8, v30, v31
    v_max3_f32 v8, v8, v32, v33
    v_max3_f32 v8, v8, v34, v35
    v_max3_f32 v8, v8, v36, v37
    v_max3_f32 v8, v8, v38, v39
    v_max3_f32 v8, v8, v40, v41
    ds_read_b128 v[14:17], v6 offset:15360
    s_waitcnt lgkmcnt(2)
    v_mfma_f32_32x32x16_bf16 v[26:41], v[18:21], v[10:13], 0
    v_max3_f32 v8, v8, v42, v43
    v_max3_f32 v8, v8, v44, v45
    v_max3_f32 v8, v8, v46, v47
    v_max3_f32 v8, v8, v48, v49
    v_max3_f32 v8, v8, v50, v51
    v_max3_f32 v8, v8, v52, v53
    v_max3_f32 v8, v8, v54, v55
    v_max3_f32 v8, v8, v56, v57
    ds_read_b128 v[18:21], v6 offset:15872
    s_waitcnt lgkmcnt(2)
    v_mfma_f32_32x32x16_bf16 v[42:57], v[22:25], v[10:13], 0
    s_nop 0
    v_max3_f32 v8, v8, v26, v27
    v_max3_f32 v8, v8, v28, v29
    v_max3_f32 v8, v8, v30, v31
    v_max3_f32 v8, v8, v32, v33
    v_max3_f32 v8, v8, v34, v35
    v_max3_f32 v8, v8, v36, v37
    v_max3_f32 v8, v8, v38, v39
    v_max3_f32 v8, v8, v40, v41
    ds_read_b128 v[22:25], v6 offset:16384
    s_waitcnt lgkmcnt(2)
    v_mfma_f32_32x32x16_bf16 v[26:41], v[14:17], v[10:13], 0
    v_max3_f32 v8, v8, v42, v43
    v_max3_f32 v8, v8, v44, v45
    v_max3_f32 v8, v8, v46, v47
    v_max3_f32 v8, v8, v48, v49
    v_max3_f32 v8, v8, v50, v51
    v_max3_f32 v8, v8, v52, v53
    v_max3_f32 v8, v8, v54, v55
    v_max3_f32 v8, v8, v56, v57
    ds_read_b128 v[14:17], v6 offset:16896
    s_waitcnt lgkmcnt(2)
    v_mfma_f32_32x32x16_bf16 v[42:57], v[18:21], v[10:13], 0
    s_nop 0
    v_max3_f32 v8, v8, v26, v27
    v_max3_f32 v8, v8, v28, v29
    v_max3_f32 v8, v8, v30, v31
    v_max3_f32 v8, v8, v32, v33
    v_max3_f32 v8, v8, v34, v35
    v_max3_f32 v8, v8, v36, v37
    v_max3_f32 v8, v8, v38, v39
    v_max3_f32 v8, v8, v40, v41
    ds_read_b128 v[18:21], v6 offset:17408
    s_waitcnt lgkmcnt(2)
    v_mfma_f32_32x32x16_bf16 v[26:41], v[22:25], v[10:13], 0
    v_max3_f32 v8, v8, v42, v43
    v_max3_f32 v8, v8, v44, v45
    v_max3_f32 v8, v8, v46, v47
    v_max3_f32 v8, v8, v48, v49
    v_max3_f32 v8, v8, v50, v51
    v_max3_f32 v8, v8, v52, v53
    v_max3_f32 v8, v8, v54, v55
    v_max3_f32 v8, v8, v56, v57
    ds_read_b128 v[22:25], v6 offset:17920
    s_waitcnt lgkmcnt(2)
    v_mfma_f32_32x32x16_bf16 v[42:57], v[14:17], v[10:13], 0
    s_nop 0
    v_max3_f32 v8, v8, v26, v27
    v_max3_f32 v8, v8, v28, v29
    v_max3_f32 v8, v8, v30, v31
    v_max3_f32 v8, v8, v32, v33
    v_max3_f32 v8, v8, v34, v35
    v_max3_f32 v8, v8, v36, v37
    v_max3_f32 v8, v8, v38, v39
    v_max3_f32 v8, v8, v40, v41
    ds_read_b128 v[14:17], v6 offset:18432
    s_waitcnt lgkmcnt(2)
    v_mfma_f32_32x32x16_bf16 v[26:41], v[18:21], v[10:13], 0
    v_max3_f32 v8, v8, v42, v43
    v_max3_f32 v8, v8, v44, v45
    v_max3_f32 v8, v8, v46, v47
    v_max3_f32 v8, v8, v48, v49
    v_max3_f32 v8, v8, v50, v51
    v_max3_f32 v8, v8, v52, v53
    v_max3_f32 v8, v8, v54, v55
    v_max3_f32 v8, v8, v56, v57
    ds_read_b128 v[18:21], v6 offset:18944
    s_waitcnt lgkmcnt(2)
    v_mfma_f32_32x32x16_bf16 v[42:57], v[22:25], v[10:13], 0
    s_nop 0
    v_max3_f32 v8, v8, v26, v27
    v_max3_f32 v8, v8, v28, v29
    v_max3_f32 v8, v8, v30, v31
    v_max3_f32 v8, v8, v32, v33
    v_max3_f32 v8, v8, v34, v35
    v_max3_f32 v8, v8, v36, v37
    v_max3_f32 v8, v8, v38, v39
    v_max3_f32 v8, v8, v40, v41
    ds_read_b128 v[22:25], v6 offset:19456
    s_waitcnt lgkmcnt(2)
    v_mfma_f32_32x32x16_bf16 v[26:41], v[14:17], v[10:13], 0
    v_max3_f32 v8, v8, v42, v43
    v_max3_f32 v8, v8, v44, v45
    v_max3_f32 v8, v8, v46, v47
    v_max3_f32 v8, v8, v48, v49
    v_max3_f32 v8, v8, v50, v51
    v_max3_f32 v8, v8, v52, v53
    v_max3_f32 v8, v8, v54, v55
    v_max3_f32 v8, v8, v56, v57
    ds_read_b128 v[14:17], v6 offset:19968
    s_waitcnt lgkmcnt(2)
    v_mfma_f32_32x32x16_bf16 v[42:57], v[18:21], v[10:13], 0
    s_nop 0
    v_max3_f32 v8, v8, v26, v27
    v_max3_f32 v8, v8, v28, v29
    v_max3_f32 v8, v8, v30, v31
    v_max3_f32 v8, v8, v32, v33
    v_max3_f32 v8, v8, v34, v35
    v_max3_f32 v8, v8, v36, v37
    v_max3_f32 v8, v8, v38, v39
    v_max3_f32 v8, v8, v40, v41
    ds_read_b128 v[18:21], v6 offset:20480
    s_waitcnt lgkmcnt(2)
    v_mfma_f32_32x32x16_bf16 v[26:41], v[22:25], v[10:13], 0
    v_max3_f32 v8, v8, v42, v43
    v_max3_f32 v8, v8, v44, v45
    v_max3_f32 v8, v8, v46, v47
    v_max3_f32 v8, v8, v48, v49
    v_max3_f32 v8, v8, v50, v51
    v_max3_f32 v8, v8, v52, v53
    v_max3_f32 v8, v8, v54, v55
    v_max3_f32 v8, v8, v56, v57
    ds_read_b128 v[22:25], v6 offset:20992
    s_waitcnt lgkmcnt(2)
    v_mfma_f32_32x32x16_bf16 v[42:57], v[14:17], v[10:13], 0
    s_nop 0
    v_max3_f32 v8, v8, v26, v27
    v_max3_f32 v8, v8, v28, v29
    v_max3_f32 v8, v8, v30, v31
    v_max3_f32 v8, v8, v32, v33
    v_max3_f32 v8, v8, v34, v35
    v_max3_f32 v8, v8, v36, v37
    v_max3_f32 v8, v8, v38, v39
    v_max3_f32 v8, v8, v40, v41
    ds_read_b128 v[14:17], v6 offset:21504
    s_waitcnt lgkmcnt(2)
    v_mfma_f32_32x32x16_bf16 v[26:41], v[18:21], v[10:13], 0
    v_max3_f32 v8, v8, v42, v43
    v_max3_f32 v8, v8, v44, v45
    v_max3_f32 v8, v8, v46, v47
    v_max3_f32 v8, v8, v48, v49
    v_max3_f32 v8, v8, v50, v51
    v_max3_f32 v8, v8, v52, v53
    v_max3_f32 v8, v8, v54, v55
    v_max3_f32 v8, v8, v56, v57
    ds_read_b128 v[18:21], v6 offset:22016
    s_waitcnt lgkmcnt(2)
    v_mfma_f32_32x32x16_bf16 v[42:57], v[22:25], v[10:13], 0
    s_nop 0
    v_max3_f32 v8, v8, v26, v27
    v_max3_f32 v8, v8, v28, v29
    v_max3_f32 v8, v8, v30, v31
    v_max3_f32 v8, v8, v32, v33
    v_max3_f32 v8, v8, v34, v35
    v_max3_f32 v8, v8, v36, v37
    v_max3_f32 v8, v8, v38, v39
    v_max3_f32 v8, v8, v40, v41
    ds_read_b128 v[22:25], v6 offset:22528
    s_waitcnt lgkmcnt(2)
    v_mfma_f32_32x32x16_bf16 v[26:41], v[14:17], v[10:13], 0
    v_max3_f32 v8, v8, v42, v43
    v_max3_f32 v8, v8, v44, v45
    v_max3_f32 v8, v8, v46, v47
    v_max3_f32 v8, v8, v48, v49
    v_max3_f32 v8, v8, v50, v51
    v_max3_f32 v8, v8, v52, v53
    v_max3_f32 v8, v8, v54, v55
    v_max3_f32 v8, v8, v56, v57
    ds_read_b128 v[14:17], v6 offset:23040
    s_waitcnt lgkmcnt(2)
    v_mfma_f32_32x32x16_bf16 v[42:57], v[18:21], v[10:13], 0
    s_nop 0
    v_max3_f32 v8, v8, v26, v27
    v_max3_f32 v8, v8, v28, v29
    v_max3_f32 v8, v8, v30, v31
    v_max3_f32 v8, v8, v32, v33
    v_max3_f32 v8, v8, v34, v35
    v_max3_f32 v8, v8, v36, v37
    v_max3_f32 v8, v8, v38, v39
    v_max3_f32 v8, v8, v40, v41
    ds_read_b128 v[18:21], v6 offset:23552
    s_waitcnt lgkmcnt(2)
    v_mfma_f32_32x32x16_bf16 v[26:41], v[22:25], v[10:13], 0
    v_max3_f32 v8, v8, v42, v43
    v_max3_f32 v8, v8, v44, v45
    v_max3_f32 v8, v8, v46, v47
    v_max3_f32 v8, v8, v48, v49
    v_max3_f32 v8, v8, v50, v51
    v_max3_f32 v8, v8, v52, v53
    v_max3_f32 v8, v8, v54, v55
    v_max3_f32 v8, v8, v56, v57
    ds_read_b128 v[22:25], v6 offset:24064
    s_waitcnt lgkmcnt(2)
    v_mfma_f32_32x32x16_bf16 v[42:57], v[14:17], v[10:13], 0
    s_nop 0
    v_max3_f32 v8, v8, v26, v27
    v_max3_f32 v8, v8, v28, v29
    v_max3_f32 v8, v8, v30, v31
    v_max3_f32 v8, v8, v32, v33
    v_max3_f32 v8, v8, v34, v35
    v_max3_f32 v8, v8, v36, v37
    v_max3_f32 v8, v8, v38, v39
    v_max3_f32 v8, v8, v40, v41
    ds_read_b128 v[14:17], v6 offset:24576
    s_waitcnt lgkmcnt(2)
    v_mfma_f32_32x32x16_bf16 v[26:41], v[18:21], v[10:13], 0
    v_max3_f32 v8, v8, v42, v43
    v_max3_f32 v8, v8, v44, v45
    v_max3_f32 v8, v8, v46, v47
    v_max3_f32 v8, v8, v48, v49
    v_max3_f32 v8, v8, v50, v51
    v_max3_f32 v8, v8, v52, v53
    v_max3_f32 v8, v8, v54, v55
    v_max3_f32 v8, v8, v56, v57
    ds_read_b128 v[18:21], v6 offset:25088
    s_waitcnt lgkmcnt(2)
    v_mfma_f32_32x32x16_bf16 v[42:57], v[22:25], v[10:13], 0
    s_nop 0
    v_max3_f32 v8, v8, v26, v27
    v_max3_f32 v8, v8, v28, v29
    v_max3_f32 v8, v8, v30, v31
    v_max3_f32 v8, v8, v32, v33
    v_max3_f32 v8, v8, v34, v35
    v_max3_f32 v8, v8, v36, v37
    v_max3_f32 v8, v8, v38, v39
    v_max3_f32 v8, v8, v40, v41
    ds_read_b128 v[22:25], v6 offset:25600
    s_waitcnt lgkmcnt(2)
    v_mfma_f32_32x32x16_bf16 v[26:41], v[14:17], v[10:13], 0
    v_max3_f32 v8, v8, v42, v43
    v_max3_f32 v8, v8, v44, v45
    v_max3_f32 v8, v8, v46, v47
    v_max3_f32 v8, v8, v48, v49
    v_max3_f32 v8, v8, v50, v51
    v_max3_f32 v8, v8, v52, v53
    v_max3_f32 v8, v8, v54, v55
    v_max3_f32 v8, v8, v56, v57
    ds_read_b128 v[14:17], v6 offset:26112
    s_waitcnt lgkmcnt(2)
    v_mfma_f32_32x32x16_bf16 v[42:57], v[18:21], v[10:13], 0
    s_nop 0
    v_max3_f32 v8, v8, v26, v27
    v_max3_f32 v8, v8, v28, v29
    v_max3_f32 v8, v8, v30, v31
    v_max3_f32 v8, v8, v32, v33
    v_max3_f32 v8, v8, v34, v35
    v_max3_f32 v8, v8, v36, v37
    v_max3_f32 v8, v8, v38, v39
    v_max3_f32 v8, v8, v40, v41
    ds_read_b128 v[18:21], v6 offset:26624
    s_waitcnt lgkmcnt(2)
    v_mfma_f32_32x32x16_bf16 v[26:41], v[22:25], v[10:13], 0
    v_max3_f32 v8, v8, v42, v43
    v_max3_f32 v8, v8, v44, v45
    v_max3_f32 v8, v8, v46, v47
    v_max3_f32 v8, v8, v48, v49
    v_max3_f32 v8, v8, v50, v51
    v_max3_f32 v8, v8, v52, v53
    v_max3_f32 v8, v8, v54, v55
    v_max3_f32 v8, v8, v56, v57
    ds_read_b128 v[22:25], v6 offset:27136
    s_waitcnt lgkmcnt(2)
    v_mfma_f32_32x32x16_bf16 v[42:57], v[14:17], v[10:13], 0
    s_nop 0
    v_max3_f32 v8, v8, v26, v27
    v_max3_f32 v8, v8, v28, v29
    v_max3_f32 v8, v8, v30, v31
    v_max3_f32 v8, v8, v32, v33
    v_max3_f32 v8, v8, v34, v35
    v_max3_f32 v8, v8, v36, v37
    v_max3_f32 v8, v8, v38, v39
    v_max3_f32 v8, v8, v40, v41
    ds_read_b128 v[14:17], v6 offset:27648
    s_waitcnt lgkmcnt(2)
    v_mfma_f32_32x32x16_bf16 v[26:41], v[18:21], v[10:13], 0
    v_max3_f32 v8, v8, v42, v43
    v_max3_f32 v8, v8, v44, v45
    v_max3_f32 v8, v8, v46, v47
    v_max3_f32 v8, v8, v48, v49
    v_max3_f32 v8, v8, v50, v51
    v_max3_f32 v8, v8, v52, v53
    v_max3_f32 v8, v8, v54, v55
    v_max3_f32 v8, v8, v56, v57
    ds_read_b128 v[18:21], v6 offset:28160
    s_waitcnt lgkmcnt(2)
    v_mfma_f32_32x32x16_bf16 v[42:57], v[22:25], v[10:13], 0
    s_nop 0
    v_max3_f32 v8, v8, v26, v27
    v_max3_f32 v8, v8, v28, v29
    v_max3_f32 v8, v8, v30, v31
    v_max3_f32 v8, v8, v32, v33
    v_max3_f32 v8, v8, v34, v35
    v_max3_f32 v8, v8, v36, v37
    v_max3_f32 v8, v8, v38, v39
    v_max3_f32 v8, v8, v40, v41
    ds_read_b128 v[22:25], v6 offset:28672
    s_waitcnt lgkmcnt(2)
    v_mfma_f32_32x32x16_bf16 v[26:41], v[14:17], v[10:13], 0
    v_max3_f32 v8, v8, v42, v43
    v_max3_f32 v8, v8, v44, v45
    v_max3_f32 v8, v8, v46, v47
    v_max3_f32 v8, v8, v48, v49
    v_max3_f32 v8, v8, v50, v51
    v_max3_f32 v8, v8, v52, v53
    v_max3_f32 v8, v8, v54, v55
    v_max3_f32 v8, v8, v56, v57
    ds_read_b128 v[14:17], v6 offset:29184
    s_waitcnt lgkmcnt(2)
    v_mfma_f32_32x32x16_bf16 v[42:57], v[18:21], v[10:13], 0
    s_nop 0
    v_max3_f32 v8, v8, v26, v27
    v_max3_f32 v8, v8, v28, v29
    v_max3_f32 v8, v8, v30, v31
    v_max3_f32 v8, v8, v32, v33
    v_max3_f32 v8, v8, v34, v35
    v_max3_f32 v8, v8, v36, v37
    v_max3_f32 v8, v8, v38, v39
    v_max3_f32 v8, v8, v40, v41
    ds_read_b128 v[18:21], v6 offset:29696
    s_waitcnt lgkmcnt(2)
    v_mfma_f32_32x32x16_bf16 v[26:41], v[22:25], v[10:13], 0
    v_max3_f32 v8, v8, v42, v43
    v_max3_f32 v8, v8, v44, v45
    v_max3_f32 v8, v8, v46, v47
    v_max3_f32 v8, v8, v48, v49
    v_max3_f32 v8, v8, v50, v51
    v_max3_f32 v8, v8, v52, v53
    v_max3_f32 v8, v8, v54, v55
    v_max3_f32 v8, v8, v56, v57
    ds_read_b128 v[22:25], v6 offset:30208
    s_waitcnt lgkmcnt(2)
    v_mfma_f32_32x32x16_bf16 v[42:57], v[14:17], v[10:13], 0
    s_nop 0
    v_max3_f32 v8, v8, v26, v27
    v_max3_f32 v8, v8, v28, v29
    v_max3_f32 v8, v8, v30, v31
    v_max3_f32 v8, v8, v32, v33
    v_max3_f32 v8, v8, v34, v35
    v_max3_f32 v8, v8, v36, v37
    v_max3_f32 v8, v8, v38, v39
    v_max3_f32 v8, v8, v40, v41
    ds_read_b128 v[14:17], v6 offset:30720
    s_waitcnt lgkmcnt(2)
    v_mfma_f32_32x32x16_bf16 v[26:41], v[18:21], v[10:13], 0
    v_max3_f32 v8, v8, v42, v43
    v_max3_f32 v8, v8, v44, v45
    v_max3_f32 v8, v8, v46, v47
    v_max3_f32 v8, v8, v48, v49
    v_max3_f32 v8, v8, v50, v51
    v_max3_f32 v8, v8, v52, v53
    v_max3_f32 v8, v8, v54, v55
    v_max3_f32 v8, v8, v56, v57
    ds_read_b128 v[18:21], v6 offset:31232
    s_waitcnt lgkmcnt(2)
    v_mfma_f32_32x32x16_bf16 v[42:57], v[22:25], v[10:13], 0
    s_nop 0
    v_max3_f32 v8, v8, v26, v27
    v_max3_f32 v8, v8, v28, v29
    v_max3_f32 v8, v8, v30, v31
    v_max3_f32 v8, v8, v32, v33
    v_max3_f32 v8, v8, v34, v35
    v_max3_f32 v8, v8, v36, v37
    v_max3_f32 v8, v8, v38, v39
    v_max3_f32 v8, v8, v40, v41
    ds_read_b128 v[22:25], v6 offset:31744
    s_waitcnt lgkmcnt(2)
    v_mfma_f32_32x32x16_bf16 v[26:41], v[14:17], v[10:13], 0
    v_max3_f32 v8, v8, v42, v43
    v_max3_f32 v8, v8, v44, v45
    v_max3_f32 v8, v8, v46, v47
    v_max3_f32 v8, v8, v48, v49
    v_max3_f32 v8, v8, v50, v51
    v_max3_f32 v8, v8, v52, v53
    v_max3_f32 v8, v8, v54, v55
    v_max3_f32 v8, v8, v56, v57
    ds_read_b128 v[14:17], v6 offset:32256
    s_waitcnt lgkmcnt(2)
    v_mfma_f32_32x32x16_bf16 v[42:57], v[18:21], v[10:13], 0
    s_nop 0
    v_max3_f32 v8, v8, v26, v27
    v_max3_f32 v8, v8, v28, v29
    v_max3_f32 v8, v8, v30, v31
    v_max3_f32 v8, v8, v32, v33
    v_max3_f32 v8, v8, v34, v35
    v_max3_f32 v8, v8, v36, v37
    v_max3_f32 v8, v8, v38, v39
    v_max3_f32 v8, v8, v40, v41
    s_waitcnt lgkmcnt(1)
    v_mfma_f32_32x32x16_bf16 v[26:41], v[22:25], v[10:13], 0
    s_nop 0
    v_max3_f32 v8, v8, v42, v43
    v_max3_f32 v8, v8, v44, v45
    v_max3_f32 v8, v8, v46, v47
    v_max3_f32 v8, v8, v48, v49
    v_max3_f32 v8, v8, v50, v51
    v_max3_f32 v8, v8, v52, v53
    v_max3_f32 v8, v8, v54, v55
    v_max3_f32 v8, v8, v56, v57
    s_waitcnt lgkmcnt(0)
    v_mfma_f32_32x32x16_bf16 v[42:57], v[14:17], v[10:13], 0
    s_nop 0
    v_max3_f32 v8, v8, v26, v27
    v_max3_f32 v8, v8, v28, v29
    v_max3_f32 v8, v8, v30, v31
    v_max3_f32 v8, v8, v32, v33
    v_max3_f32 v8, v8, v34, v35
    v_max3_f32 v8, v8, v36, v37
    v_max3_f32 v8, v8, v38, v39
    v_max3_f32 v8, v8, v40, v41
    s_nop 2
    v_max3_f32 v8, v8, v42, v43
    v_max3_f32 v8, v8, v44, v45
    v_max3_f32 v8, v8, v46, v47
    v_max3_f32 v8, v8, v48, v49
    v_max3_f32 v8, v8, v50, v51
    v_max3_f32 v8, v8, v52, v53
    v_max3_f32 v8, v8, v54, v55
    v_max3_f32 v8, v8, v56, v57
    v_mov_b32 v2, v8
    s_nop 1
    v_permlane32_swap_b32 v8, v2
    v_max_f32 v8, v8, v2
    v_sub_f32 v58, 0, v8
    v_sub_f32 v59, 0, v8
    v_sub_f32 v60, 0, v8
    v_sub_f32 v61, 0, v8
    v_sub_f32 v62, 0, v8
    v_sub_f32 v63, 0, v8
    v_sub_f32 v64, 0, v8
    v_sub_f32 v65, 0, v8
    v_sub_f32 v66, 0, v8
    v_sub_f32 v67, 0, v8
    v_sub_f32 v68, 0, v8
    v_sub_f32 v69, 0, v8
    v_sub_f32 v70, 0, v8
    v_sub_f32 v71, 0, v8
    v_sub_f32 v72, 0, v8
    v_sub_f32 v73, 0, v8
    ds_read_b128 v[14:17], v6 offset:0
    ds_read_b128 v[18:21], v6 offset:512
    s_waitcnt lgkmcnt(1)
    v_mfma_f32_32x32x16_bf16 v[26:41], v[14:17], v[10:13], v[58:73]
    ds_read_b128 v[22:25], v6 offset:1024
    s_waitcnt lgkmcnt(1)
    v_mfma_f32_32x32x16_bf16 v[42:57], v[18:21], v[10:13], v[58:73]
    s_mov_b64 exec, s[20:21]
    ds_read_b128 v[90:93], v7 offset:0
    ds_read_b128 v[94:97], v7 offset:512
    s_mov_b64 exec, -1
    s_nop 4
    v_exp_f32 v26, v26
    v_exp_f32 v27, v27
    v_exp_f32 v28, v28
    v_exp_f32 v29, v29
    v_exp_f32 v30, v30
    v_exp_f32 v31, v31
    v_exp_f32 v32, v32
    v_exp_f32 v33, v33
    v_exp_f32 v34, v34
    v_exp_f32 v35, v35
    v_exp_f32 v36, v36
    v_exp_f32 v37, v37
    v_exp_f32 v38, v38
    v_exp_f32 v39, v39
    v_exp_f32 v40, v40
    v_exp_f32 v41, v41
    v_cvt_pk_bf16_f32 v74, v26, v27
    v_cvt_pk_bf16_f32 v75, v28, v29
    v_cvt_pk_bf16_f32 v76, v30, v31
    v_cvt_pk_bf16_f32 v77, v32, v33
    v_cvt_pk_bf16_f32 v78, v34, v35
    v_cvt_pk_bf16_f32 v79, v36, v37
    v_cvt_pk_bf16_f32 v80, v38, v39
    v_cvt_pk_bf16_f32 v81, v40, v41
    ds_read_b128 v[14:17], v6 offset:1536
    s_waitcnt lgkmcnt(3)
    v_mfma_f32_32x32x16_bf16 v[26:41], v[22:25], v[10:13], v[58:73]
    s_mov_b64 exec, s[20:21]
    ds_read_b128 v[98:101], v7 offset:1024
    ds_read_b128 v[102:105], v7 offset:1536
    s_mov_b64 exec, -1
    v_exp_f32 v42, v42
    v_exp_f32 v43, v43
    v_exp_f32 v44, v44
    v_exp_f32 v45, v45
    v_exp_f32 v46, v46
    v_exp_f32 v47, v47
    v_exp_f32 v48, v48
    v_exp_f32 v49, v49
    s_waitcnt lgkmcnt(4)
    v_mfma_f32_32x32x16_bf16 v[106:121], v[90:93], v[74:77], 0
    v_exp_f32 v50, v50
    v_exp_f32 v51, v51
    v_exp_f32 v52, v52
    v_exp_f32 v53, v53
    v_exp_f32 v54, v54
    v_exp_f32 v55, v55
    v_exp_f32 v56, v56
    v_exp_f32 v57, v57
    s_waitcnt lgkmcnt(3)
    v_mfma_f32_32x32x16_bf16 v[106:121], v[94:97], v[78:81], v[106:121]
    v_cvt_pk_bf16_f32 v82, v42, v43
    v_cvt_pk_bf16_f32 v83, v44, v45
    v_cvt_pk_bf16_f32 v84, v46, v47
    v_cvt_pk_bf16_f32 v85, v48, v49
    v_cvt_pk_bf16_f32 v86, v50, v51
    v_cvt_pk_bf16_f32 v87, v52, v53
    v_cvt_pk_bf16_f32 v88, v54, v55
    v_cvt_pk_bf16_f32 v89, v56, v57
    ds_read_b128 v[18:21], v6 offset:2048
    s_waitcnt lgkmcnt(3)
    v_mfma_f32_32x32x16_bf16 v[42:57], v[14:17], v[10:13], v[58:73]
    s_mov_b64 exec, s[20:21]
    ds_read_b128 v[90:93], v7 offset:2048
    ds_read_b128 v[94:97], v7 offset:2560
    s_mov_b64 exec, -1
    v_exp_f32 v26, v26
    v_exp_f32 v27, v27
    v_exp_f32 v28, v28
    v_exp_f32 v29, v29
    v_exp_f32 v30, v30
    v_exp_f32 v31, v31
    v_exp_f32 v32, v32
    v_exp_f32 v33, v33
    s_waitcnt lgkmcnt(4)
    v_mfma_f32_32x32x16_bf16 v[106:121], v[98:101], v[82:85], v[106:121]
    v_exp_f32 v34, v34
    v_exp_f32 v35, v35
    v_exp_f32 v36, v36
    v_exp_f32 v37, v37
    v_exp_f32 v38, v38
    v_exp_f32 v39, v39
    v_exp_f32 v40, v40
    v_exp_f32 v41, v41
    s_waitcnt lgkmcnt(3)
    v_mfma_f32_32x32x16_bf16 v[106:121], v[102:105], v[86:89], v[106:121]
    v_cvt_pk_bf16_f32 v74, v26, v27
    v_cvt_pk_bf16_f32 v75, v28, v29
    v_cvt_pk_bf16_f32 v76, v30, v31
    v_cvt_pk_bf16_f32 v77, v32, v33
    v_cvt_pk_bf16_f32 v78, v34, v35
    v_cvt_pk_bf16_f32 v79, v36, v37
    v_cvt_pk_bf16_f32 v80, v38, v39
    v_cvt_pk_bf16_f32 v81, v40, v41
    ds_read_b128 v[22:25], v6 offset:2560
    s_waitcnt lgkmcnt(3)
    v_mfma_f32_32x32x16_bf16 v[26:41], v[18:21], v[10:13], v[58:73]
    s_mov_b64 exec, s[20:21]
    ds_read_b128 v[98:101], v7 offset:3072
    ds_read_b128 v[102:105], v7 offset:3584
    s_mov_b64 exec, -1
    v_exp_f32 v42, v42
    v_exp_f32 v43, v43
    v_exp_f32 v44, v44
    v_exp_f32 v45, v45
    v_exp_f32 v46, v46
    v_exp_f32 v47, v47
    v_exp_f32 v48, v48
    v_exp_f32 v49, v49
    s_waitcnt lgkmcnt(4)
    v_mfma_f32_32x32x16_bf16 v[106:121], v[90:93], v[74:77], v[106:121]
    v_exp_f32 v50, v50
    v_exp_f32 v51, v51
    v_exp_f32 v52, v52
    v_exp_f32 v53, v53
    v_exp_f32 v54, v54
    v_exp_f32 v55, v55
    v_exp_f32 v56, v56
    v_exp_f32 v57, v57
    s_waitcnt lgkmcnt(3)
    v_mfma_f32_32x32x16_bf16 v[106:121], v[94:97], v[78:81], v[106:121]
    v_cvt_pk_bf16_f32 v82, v42, v43
    v_cvt_pk_bf16_f32 v83, v44, v45
    v_cvt_pk_bf16_f32 v84, v46, v47
    v_cvt_pk_bf16_f32 v85, v48, v49
    v_cvt_pk_bf16_f32 v86, v50, v51
    v_cvt_pk_bf16_f32 v87, v52, v53
    v_cvt_pk_bf16_f32 v88, v54, v55
    v_cvt_pk_bf16_f32 v89, v56, v57
    ds_read_b128 v[14:17], v6 offset:3072
    s_waitcnt lgkmcnt(3)
    v_mfma_f32_32x32x16_bf16 v[42:57], v[22:25], v[10:13], v[58:73]
    s_mov_b64 exec, s[20:21]
    ds_read_b128 v[90:93], v7 offset:4096
    ds_read_b128 v[94:97], v7 offset:4608
    s_mov_b64 exec, -1
    v_exp_f32 v26, v26
    v_exp_f32 v27, v27
    v_exp_f32 v28, v28
    v_exp_f32 v29, v29
    v_exp_f32 v30, v30
    v_exp_f32 v31, v31
    v_exp_f32 v32, v32
    v_exp_f32 v33, v33
    s_waitcnt lgkmcnt(4)
    v_mfma_f32_32x32x16_bf16 v[106:121], v[98:101], v[82:85], v[106:121]
    v_exp_f32 v34, v34
    v_exp_f32 v35, v35
    v_exp_f32 v36, v36
    v_exp_f32 v37, v37
    v_exp_f32 v38, v38
    v_exp_f32 v39, v39
    v_exp_f32 v40, v40
    v_exp_f32 v41, v41
    s_waitcnt lgkmcnt(3)
    v_mfma_f32_32x32x16_bf16 v[106:121], v[102:105], v[86:89], v[106:121]
    v_cvt_pk_bf16_f32 v74, v26, v27
    v_cvt_pk_bf16_f32 v75, v28, v29
    v_cvt_pk_bf16_f32 v76, v30, v31
    v_cvt_pk_bf16_f32 v77, v32, v33
    v_cvt_pk_bf16_f32 v78, v34, v35
    v_cvt_pk_bf16_f32 v79, v36, v37
    v_cvt_pk_bf16_f32 v80, v38, v39
    v_cvt_pk_bf16_f32 v81, v40, v41
    ds_read_b128 v[18:21], v6 offset:3584
    s_waitcnt lgkmcnt(3)
    v_mfma_f32_32x32x16_bf16 v[26:41], v[14:17], v[10:13], v[58:73]
    s_mov_b64 exec, s[20:21]
    ds_read_b128 v[98:101], v7 offset:5120
    ds_read_b128 v[102:105], v7 offset:5632
    s_mov_b64 exec, -1
    v_exp_f32 v42, v42
    v_exp_f32 v43, v43
    v_exp_f32 v44, v44
    v_exp_f32 v45, v45
    v_exp_f32 v46, v46
    v_exp_f32 v47, v47
    v_exp_f32 v48, v48
    v_exp_f32 v49, v49
    s_waitcnt lgkmcnt(4)
    v_mfma_f32_32x32x16_bf16 v[106:121], v[90:93], v[74:77], v[106:121]
    v_exp_f32 v50, v50
    v_exp_f32 v51, v51
    v_exp_f32 v52, v52
    v_exp_f32 v53, v53
    v_exp_f32 v54, v54
    v_exp_f32 v55, v55
    v_exp_f32 v56, v56
    v_exp_f32 v57, v57
    s_waitcnt lgkmcnt(3)
    v_mfma_f32_32x32x16_bf16 v[106:121], v[94:97], v[78:81], v[106:121]
    v_cvt_pk_bf16_f32 v82, v42, v43
    v_cvt_pk_bf16_f32 v83, v44, v45
    v_cvt_pk_bf16_f32 v84, v46, v47
    v_cvt_pk_bf16_f32 v85, v48, v49
    v_cvt_pk_bf16_f32 v86, v50, v51
    v_cvt_pk_bf16_f32 v87, v52, v53
    v_cvt_pk_bf16_f32 v88, v54, v55
    v_cvt_pk_bf16_f32 v89, v56, v57
    ds_read_b128 v[22:25], v6 offset:4096
    s_waitcnt lgkmcnt(3)
    v_mfma_f32_32x32x16_bf16 v[42:57], v[18:21], v[10:13], v[58:73]
    s_mov_b64 exec, s[20:21]
    ds_read_b128 v[90:93], v7 offset:6144
    ds_read_b128 v[94:97], v7 offset:6656
    s_mov_b64 exec, -1
    v_exp_f32 v26, v26
    v_exp_f32 v27, v27
    v_exp_f32 v28, v28
    v_exp_f32 v29, v29
    v_exp_f32 v30, v30
    v_exp_f32 v31, v31
    v_exp_f32 v32, v32
    v_exp_f32 v33, v33
    s_waitcnt lgkmcnt(4)
    v_mfma_f32_32x32x16_bf16 v[106:121], v[98:101], v[82:85], v[106:121]
    v_exp_f32 v34, v34
    v_exp_f32 v35, v35
    v_exp_f32 v36, v36
    v_exp_f32 v37, v37
    v_exp_f32 v38, v38
    v_exp_f32 v39, v39
    v_exp_f32 v40, v40
    v_exp_f32 v41, v41
    s_waitcnt lgkmcnt(3)
    v_mfma_f32_32x32x16_bf16 v[106:121], v[102:105], v[86:89], v[106:121]
    v_cvt_pk_bf16_f32 v74, v26, v27
    v_cvt_pk_bf16_f32 v75, v28, v29
    v_cvt_pk_bf16_f32 v76, v30, v31
    v_cvt_pk_bf16_f32 v77, v32, v33
    v_cvt_pk_bf16_f32 v78, v34, v35
    v_cvt_pk_bf16_f32 v79, v36, v37
    v_cvt_pk_bf16_f32 v80, v38, v39
    v_cvt_pk_bf16_f32 v81, v40, v41
    ds_read_b128 v[14:17], v6 offset:4608
    s_waitcnt lgkmcnt(3)
    v_mfma_f32_32x32x16_bf16 v[26:41], v[22:25], v[10:13], v[58:73]
    s_mov_b64 exec, s[20:21]
    ds_read_b128 v[98:101], v7 offset:7168
    ds_read_b128 v[102:105], v7 offset:7680
    s_mov_b64 exec, -1
    v_exp_f32 v42, v42
    v_exp_f32 v43, v43
    v_exp_f32 v44, v44
    v_exp_f32 v45, v45
    v_exp_f32 v46, v46
    v_exp_f32 v47, v47
    v_exp_f32 v48, v48
    v_exp_f32 v49, v49
    s_waitcnt lgkmcnt(4)
    v_mfma_f32_32x32x16_bf16 v[106:121], v[90:93], v[74:77], v[106:121]
    v_exp_f32 v50, v50
    v_exp_f32 v51, v51
    v_exp_f32 v52, v52
    v_exp_f32 v53, v53
    v_exp_f32 v54, v54
    v_exp_f32 v55, v55
    v_exp_f32 v56, v56
    v_exp_f32 v57, v57
    s_waitcnt lgkmcnt(3)
    v_mfma_f32_32x32x16_bf16 v[106:121], v[94:97], v[78:81], v[106:121]
    v_cvt_pk_bf16_f32 v82, v42, v43
    v_cvt_pk_bf16_f32 v83, v44, v45
    v_cvt_pk_bf16_f32 v84, v46, v47
    v_cvt_pk_bf16_f32 v85, v48, v49
    v_cvt_pk_bf16_f32 v86, v50, v51
    v_cvt_pk_bf16_f32 v87, v52, v53
    v_cvt_pk_bf16_f32 v88, v54, v55
    v_cvt_pk_bf16_f32 v89, v56, v57
    ds_read_b128 v[18:21], v6 offset:5120
    s_waitcnt lgkmcnt(3)
    v_mfma_f32_32x32x16_bf16 v[42:57], v[14:17], v[10:13], v[58:73]
    s_mov_b64 exec, s[20:21]
    ds_read_b128 v[90:93], v7 offset:8192
    ds_read_b128 v[94:97], v7 offset:8704
    s_mov_b64 exec, -1
    v_exp_f32 v26, v26
    v_exp_f32 v27, v27
    v_exp_f32 v28, v28
    v_exp_f32 v29, v29
    v_exp_f32 v30, v30
    v_exp_f32 v31, v31
    v_exp_f32 v32, v32
    v_exp_f32 v33, v33
    s_waitcnt lgkmcnt(4)
    v_mfma_f32_32x32x16_bf16 v[106:121], v[98:101], v[82:85], v[106:121]
    v_exp_f32 v34, v34
    v_exp_f32 v35, v35
    v_exp_f32 v36, v36
    v_exp_f32 v37, v37
    v_exp_f32 v38, v38
    v_exp_f32 v39, v39
    v_exp_f32 v40, v40
    v_exp_f32 v41, v41
    s_waitcnt lgkmcnt(3)
    v_mfma_f32_32x32x16_bf16 v[106:121], v[102:105], v[86:89], v[106:121]
    v_cvt_pk_bf16_f32 v74, v26, v27
    v_cvt_pk_bf16_f32 v75, v28, v29
    v_cvt_pk_bf16_f32 v76, v30, v31
    v_cvt_pk_bf16_f32 v77, v32, v33
    v_cvt_pk_bf16_f32 v78, v34, v35
    v_cvt_pk_bf16_f32 v79, v36, v37
    v_cvt_pk_bf16_f32 v80, v38, v39
    v_cvt_pk_bf16_f32 v81, v40, v41
    ds_read_b128 v[22:25], v6 offset:5632
    s_waitcnt lgkmcnt(3)
    v_mfma_f32_32x32x16_bf16 v[26:41], v[18:21], v[10:13], v[58:73]
    s_mov_b64 exec, s[20:21]
    ds_read_b128 v[98:101], v7 offset:9216
    ds_read_b128 v[102:105], v7 offset:9728
    s_mov_b64 exec, -1
    v_exp_f32 v42, v42
    v_exp_f32 v43, v43
    v_exp_f32 v44, v44
    v_exp_f32 v45, v45
    v_exp_f32 v46, v46
    v_exp_f32 v47, v47
    v_exp_f32 v48, v48
    v_exp_f32 v49, v49
    s_waitcnt lgkmcnt(4)
    v_mfma_f32_32x32x16_bf16 v[106:121], v[90:93], v[74:77], v[106:121]
    v_exp_f32 v50, v50
    v_exp_f32 v51, v51
    v_exp_f32 v52, v52
    v_exp_f32 v53, v53
    v_exp_f32 v54, v54
    v_exp_f32 v55, v55
    v_exp_f32 v56, v56
    v_exp_f32 v57, v57
    s_waitcnt lgkmcnt(3)
    v_mfma_f32_32x32x16_bf16 v[106:121], v[94:97], v[78:81], v[106:121]
    v_cvt_pk_bf16_f32 v82, v42, v43
    v_cvt_pk_bf16_f32 v83, v44, v45
    v_cvt_pk_bf16_f32 v84, v46, v47
    v_cvt_pk_bf16_f32 v85, v48, v49
    v_cvt_pk_bf16_f32 v86, v50, v51
    v_cvt_pk_bf16_f32 v87, v52, v53
    v_cvt_pk_bf16_f32 v88, v54, v55
    v_cvt_pk_bf16_f32 v89, v56, v57
    ds_read_b128 v[14:17], v6 offset:6144
    s_waitcnt lgkmcnt(3)
    v_mfma_f32_32x32x16_bf16 v[42:57], v[22:25], v[10:13], v[58:73]
    s_mov_b64 exec, s[20:21]
    ds_read_b128 v[90:93], v7 offset:10240
    ds_read_b128 v[94:97], v7 offset:10752
    s_mov_b64 exec, -1
    v_exp_f32 v26, v26
    v_exp_f32 v27, v27
    v_exp_f32 v28, v28
    v_exp_f32 v29, v29
    v_exp_f32 v30, v30
    v_exp_f32 v31, v31
    v_exp_f32 v32, v32
    v_exp_f32 v33, v33
    s_waitcnt lgkmcnt(4)
    v_mfma_f32_32x32x16_bf16 v[106:121], v[98:101], v[82:85], v[106:121]
    v_exp_f32 v34, v34
    v_exp_f32 v35, v35
    v_exp_f32 v36, v36
    v_exp_f32 v37, v37
    v_exp_f32 v38, v38
    v_exp_f32 v39, v39
    v_exp_f32 v40, v40
    v_exp_f32 v41, v41
    s_waitcnt lgkmcnt(3)
    v_mfma_f32_32x32x16_bf16 v[106:121], v[102:105], v[86:89], v[106:121]
    v_cvt_pk_bf16_f32 v74, v26, v27
    v_cvt_pk_bf16_f32 v75, v28, v29
    v_cvt_pk_bf16_f32 v76, v30, v31
    v_cvt_pk_bf16_f32 v77, v32, v33
    v_cvt_pk_bf16_f32 v78, v34, v35
    v_cvt_pk_bf16_f32 v79, v36, v37
    v_cvt_pk_bf16_f32 v80, v38, v39
    v_cvt_pk_bf16_f32 v81, v40, v41
    ds_read_b128 v[18:21], v6 offset:6656
    s_waitcnt lgkmcnt(3)
    v_mfma_f32_32x32x16_bf16 v[26:41], v[14:17], v[10:13], v[58:73]
    s_mov_b64 exec, s[20:21]
    ds_read_b128 v[98:101], v7 offset:11264
    ds_read_b128 v[102:105], v7 offset:11776
    s_mov_b64 exec, -1
    v_exp_f32 v42, v42
    v_exp_f32 v43, v43
    v_exp_f32 v44, v44
    v_exp_f32 v45, v45
    v_exp_f32 v46, v46
    v_exp_f32 v47, v47
    v_exp_f32 v48, v48
    v_exp_f32 v49, v49
    s_waitcnt lgkmcnt(4)
    v_mfma_f32_32x32x16_bf16 v[106:121], v[90:93], v[74:77], v[106:121]
    v_exp_f32 v50, v50
    v_exp_f32 v51, v51
    v_exp_f32 v52, v52
    v_exp_f32 v53, v53
    v_exp_f32 v54, v54
    v_exp_f32 v55, v55
    v_exp_f32 v56, v56
    v_exp_f32 v57, v57
    s_waitcnt lgkmcnt(3)
    v_mfma_f32_32x32x16_bf16 v[106:121], v[94:97], v[78:81], v[106:121]
    v_cvt_pk_bf16_f32 v82, v42, v43
    v_cvt_pk_bf16_f32 v83, v44, v45
    v_cvt_pk_bf16_f32 v84, v46, v47
    v_cvt_pk_bf16_f32 v85, v48, v49
    v_cvt_pk_bf16_f32 v86, v50, v51
    v_cvt_pk_bf16_f32 v87, v52, v53
    v_cvt_pk_bf16_f32 v88, v54, v55
    v_cvt_pk_bf16_f32 v89, v56, v57
    ds_read_b128 v[22:25], v6 offset:7168
    s_waitcnt lgkmcnt(3)
    v_mfma_f32_32x32x16_bf16 v[42:57], v[18:21], v[10:13], v[58:73]
    s_mov_b64 exec, s[20:21]
    ds_read_b128 v[90:93], v7 offset:12288
    ds_read_b128 v[94:97], v7 offset:12800
    s_mov_b64 exec, -1
    v_exp_f32 v26, v26
    v_exp_f32 v27, v27
    v_exp_f32 v28, v28
    v_exp_f32 v29, v29
    v_exp_f32 v30, v30
    v_exp_f32 v31, v31
    v_exp_f32 v32, v32
    v_exp_f32 v33, v33
    s_waitcnt lgkmcnt(4)
    v_mfma_f32_32x32x16_bf16 v[106:121], v[98:101], v[82:85], v[106:121]
    v_exp_f32 v34, v34
    v_exp_f32 v35, v35
    v_exp_f32 v36, v36
    v_exp_f32 v37, v37
    v_exp_f32 v38, v38
    v_exp_f32 v39, v39
    v_exp_f32 v40, v40
    v_exp_f32 v41, v41
    s_waitcnt lgkmcnt(3)
    v_mfma_f32_32x32x16_bf16 v[106:121], v[102:105], v[86:89], v[106:121]
    v_cvt_pk_bf16_f32 v74, v26, v27
    v_cvt_pk_bf16_f32 v75, v28, v29
    v_cvt_pk_bf16_f32 v76, v30, v31
    v_cvt_pk_bf16_f32 v77, v32, v33
    v_cvt_pk_bf16_f32 v78, v34, v35
    v_cvt_pk_bf16_f32 v79, v36, v37
    v_cvt_pk_bf16_f32 v80, v38, v39
    v_cvt_pk_bf16_f32 v81, v40, v41
    ds_read_b128 v[14:17], v6 offset:7680
    s_waitcnt lgkmcnt(3)
    v_mfma_f32_32x32x16_bf16 v[26:41], v[22:25], v[10:13], v[58:73]
    s_mov_b64 exec, s[20:21]
    ds_read_b128 v[98:101], v7 offset:13312
    ds_read_b128 v[102:105], v7 offset:13824
    s_mov_b64 exec, -1
    v_exp_f32 v42, v42
    v_exp_f32 v43, v43
    v_exp_f32 v44, v44
    v_exp_f32 v45, v45
    v_exp_f32 v46, v46
    v_exp_f32 v47, v47
    v_exp_f32 v48, v48
    v_exp_f32 v49, v49
    s_waitcnt lgkmcnt(4)
    v_mfma_f32_32x32x16_bf16 v[106:121], v[90:93], v[74:77], v[106:121]
    v_exp_f32 v50, v50
    v_exp_f32 v51, v51
    v_exp_f32 v52, v52
    v_exp_f32 v53, v53
    v_exp_f32 v54, v54
    v_exp_f32 v55, v55
    v_exp_f32 v56, v56
    v_exp_f32 v57, v57
    s_waitcnt lgkmcnt(3)
    v_mfma_f32_32x32x16_bf16 v[106:121], v[94:97], v[78:81], v[106:121]
    v_cvt_pk_bf16_f32 v82, v42, v43
    v_cvt_pk_bf16_f32 v83, v44, v45
    v_cvt_pk_bf16_f32 v84, v46, v47
    v_cvt_pk_bf16_f32 v85, v48, v49
    v_cvt_pk_bf16_f32 v86, v50, v51
    v_cvt_pk_bf16_f32 v87, v52, v53
    v_cvt_pk_bf16_f32 v88, v54, v55
    v_cvt_pk_bf16_f32 v89, v56, v57
    ds_read_b128 v[18:21], v6 offset:8192
    s_waitcnt lgkmcnt(3)
    v_mfma_f32_32x32x16_bf16 v[42:57], v[14:17], v[10:13], v[58:73]
    s_mov_b64 exec, s[20:21]
    ds_read_b128 v[90:93], v7 offset:14336
    ds_read_b128 v[94:97], v7 offset:14848
    s_mov_b64 exec, -1
    v_exp_f32 v26, v26
    v_exp_f32 v27, v27
    v_exp_f32 v28, v28
    v_exp_f32 v29, v29
    v_exp_f32 v30, v30
    v_exp_f32 v31, v31
    v_exp_f32 v32, v32
    v_exp_f32 v33, v33
    s_waitcnt lgkmcnt(4)
    v_mfma_f32_32x32x16_bf16 v[106:121], v[98:101], v[82:85], v[106:121]
    v_exp_f32 v34, v34
    v_exp_f32 v35, v35
    v_exp_f32 v36, v36
    v_exp_f32 v37, v37
    v_exp_f32 v38, v38
    v_exp_f32 v39, v39
    v_exp_f32 v40, v40
    v_exp_f32 v41, v41
    s_waitcnt lgkmcnt(3)
    v_mfma_f32_32x32x16_bf16 v[106:121], v[102:105], v[86:89], v[106:121]
    v_cvt_pk_bf16_f32 v74, v26, v27
    v_cvt_pk_bf16_f32 v75, v28, v29
    v_cvt_pk_bf16_f32 v76, v30, v31
    v_cvt_pk_bf16_f32 v77, v32, v33
    v_cvt_pk_bf16_f32 v78, v34, v35
    v_cvt_pk_bf16_f32 v79, v36, v37
    v_cvt_pk_bf16_f32 v80, v38, v39
    v_cvt_pk_bf16_f32 v81, v40, v41
    ds_read_b128 v[22:25], v6 offset:8704
    s_waitcnt lgkmcnt(3)
    v_mfma_f32_32x32x16_bf16 v[26:41], v[18:21], v[10:13], v[58:73]
    s_mov_b64 exec, s[20:21]
    ds_read_b128 v[98:101], v7 offset:15360
    ds_read_b128 v[102:105], v7 offset:15872
    s_mov_b64 exec, -1
    v_exp_f32 v42, v42
    v_exp_f32 v43, v43
    v_exp_f32 v44, v44
    v_exp_f32 v45, v45
    v_exp_f32 v46, v46
    v_exp_f32 v47, v47
    v_exp_f32 v48, v48
    v_exp_f32 v49, v49
    s_waitcnt lgkmcnt(4)
    v_mfma_f32_32x32x16_bf16 v[106:121], v[90:93], v[74:77], v[106:121]
    v_exp_f32 v50, v50
    v_exp_f32 v51, v51
    v_exp_f32 v52, v52
    v_exp_f32 v53, v53
    v_exp_f32 v54, v54
    v_exp_f32 v55, v55
    v_exp_f32 v56, v56
    v_exp_f32 v57, v57
    s_waitcnt lgkmcnt(3)
    v_mfma_f32_32x32x16_bf16 v[106:121], v[94:97], v[78:81], v[106:121]
    v_cvt_pk_bf16_f32 v82, v42, v43
    v_cvt_pk_bf16_f32 v83, v44, v45
    v_cvt_pk_bf16_f32 v84, v46, v47
    v_cvt_pk_bf16_f32 v85, v48, v49
    v_cvt_pk_bf16_f32 v86, v50, v51
    v_cvt_pk_bf16_f32 v87, v52, v53
    v_cvt_pk_bf16_f32 v88, v54, v55
    v_cvt_pk_bf16_f32 v89, v56, v57
    ds_read_b128 v[14:17], v6 offset:9216
    s_waitcnt lgkmcnt(3)
    v_mfma_f32_32x32x16_bf16 v[42:57], v[22:25], v[10:13], v[58:73]
    s_mov_b64 exec, s[20:21]
    ds_read_b128 v[90:93], v7 offset:16384
    ds_read_b128 v[94:97], v7 offset:16896
    s_mov_b64 exec, -1
    v_exp_f32 v26, v26
    v_exp_f32 v27, v27
    v_exp_f32 v28, v28
    v_exp_f32 v29, v29
    v_exp_f32 v30, v30
    v_exp_f32 v31, v31
    v_exp_f32 v32, v32
    v_exp_f32 v33, v33
    s_waitcnt lgkmcnt(4)
    v_mfma_f32_32x32x16_bf16 v[106:121], v[98:101], v[82:85], v[106:121]
    v_exp_f32 v34, v34
    v_exp_f32 v35, v35
    v_exp_f32 v36, v36
    v_exp_f32 v37, v37
    v_exp_f32 v38, v38
    v_exp_f32 v39, v39
    v_exp_f32 v40, v40
    v_exp_f32 v41, v41
    s_waitcnt lgkmcnt(3)
    v_mfma_f32_32x32x16_bf16 v[106:121], v[102:105], v[86:89], v[106:121]
    v_cvt_pk_bf16_f32 v74, v26, v27
    v_cvt_pk_bf16_f32 v75, v28, v29
    v_cvt_pk_bf16_f32 v76, v30, v31
    v_cvt_pk_bf16_f32 v77, v32, v33
    v_cvt_pk_bf16_f32 v78, v34, v35
    v_cvt_pk_bf16_f32 v79, v36, v37
    v_cvt_pk_bf16_f32 v80, v38, v39
    v_cvt_pk_bf16_f32 v81, v40, v41
    ds_read_b128 v[18:21], v6 offset:9728
    s_waitcnt lgkmcnt(3)
    v_mfma_f32_32x32x16_bf16 v[26:41], v[14:17], v[10:13], v[58:73]
    s_mov_b64 exec, s[20:21]
    ds_read_b128 v[98:101], v7 offset:17408
    ds_read_b128 v[102:105], v7 offset:17920
    s_mov_b64 exec, -1
    v_exp_f32 v42, v42
    v_exp_f32 v43, v43
    v_exp_f32 v44, v44
    v_exp_f32 v45, v45
    v_exp_f32 v46, v46
    v_exp_f32 v47, v47
    v_exp_f32 v48, v48
    v_exp_f32 v49, v49
    s_waitcnt lgkmcnt(4)
    v_mfma_f32_32x32x16_bf16 v[106:121], v[90:93], v[74:77], v[106:121]
    v_exp_f32 v50, v50
    v_exp_f32 v51, v51
    v_exp_f32 v52, v52
    v_exp_f32 v53, v53
    v_exp_f32 v54, v54
    v_exp_f32 v55, v55
    v_exp_f32 v56, v56
    v_exp_f32 v57, v57
    s_waitcnt lgkmcnt(3)
    v_mfma_f32_32x32x16_bf16 v[106:121], v[94:97], v[78:81], v[106:121]
    v_cvt_pk_bf16_f32 v82, v42, v43
    v_cvt_pk_bf16_f32 v83, v44, v45
    v_cvt_pk_bf16_f32 v84, v46, v47
    v_cvt_pk_bf16_f32 v85, v48, v49
    v_cvt_pk_bf16_f32 v86, v50, v51
    v_cvt_pk_bf16_f32 v87, v52, v53
    v_cvt_pk_bf16_f32 v88, v54, v55
    v_cvt_pk_bf16_f32 v89, v56, v57
    ds_read_b128 v[22:25], v6 offset:10240
    s_waitcnt lgkmcnt(3)
    v_mfma_f32_32x32x16_bf16 v[42:57], v[18:21], v[10:13], v[58:73]
    s_mov_b64 exec, s[20:21]
    ds_read_b128 v[90:93], v7 offset:18432
    ds_read_b128 v[94:97], v7 offset:18944
    s_mov_b64 exec, -1
    v_exp_f32 v26, v26
    v_exp_f32 v27, v27
    v_exp_f32 v28, v28
    v_exp_f32 v29, v29
    v_exp_f32 v30, v30
    v_exp_f32 v31, v31
    v_exp_f32 v32, v32
    v_exp_f32 v33, v33
    s_waitcnt lgkmcnt(4)
    v_mfma_f32_32x32x16_bf16 v[106:121], v[98:101], v[82:85], v[106:121]
    v_exp_f32 v34, v34
    v_exp_f32 v35, v35
    v_exp_f32 v36, v36
    v_exp_f32 v37, v37
    v_exp_f32 v38, v38
    v_exp_f32 v39, v39
    v_exp_f32 v40, v40
    v_exp_f32 v41, v41
    s_waitcnt lgkmcnt(3)
    v_mfma_f32_32x32x16_bf16 v[106:121], v[102:105], v[86:89], v[106:121]
    v_cvt_pk_bf16_f32 v74, v26, v27
    v_cvt_pk_bf16_f32 v75, v28, v29
    v_cvt_pk_bf16_f32 v76, v30, v31
    v_cvt_pk_bf16_f32 v77, v32, v33
    v_cvt_pk_bf16_f32 v78, v34, v35
    v_cvt_pk_bf16_f32 v79, v36, v37
    v_cvt_pk_bf16_f32 v80, v38, v39
    v_cvt_pk_bf16_f32 v81, v40, v41
    ds_read_b128 v[14:17], v6 offset:10752
    s_waitcnt lgkmcnt(3)
    v_mfma_f32_32x32x16_bf16 v[26:41], v[22:25], v[10:13], v[58:73]
    s_mov_b64 exec, s[20:21]
    ds_read_b128 v[98:101], v7 offset:19456
    ds_read_b128 v[102:105], v7 offset:19968
    s_mov_b64 exec, -1
    v_exp_f32 v42, v42
    v_exp_f32 v43, v43
    v_exp_f32 v44, v44
    v_exp_f32 v45, v45
    v_exp_f32 v46, v46
    v_exp_f32 v47, v47
    v_exp_f32 v48, v48
    v_exp_f32 v49, v49
    s_waitcnt lgkmcnt(4)
    v_mfma_f32_32x32x16_bf16 v[106:121], v[90:93], v[74:77], v[106:121]
    v_exp_f32 v50, v50
    v_exp_f32 v51, v51
    v_exp_f32 v52, v52
    v_exp_f32 v53, v53
    v_exp_f32 v54, v54
    v_exp_f32 v55, v55
    v_exp_f32 v56, v56
    v_exp_f32 v57, v57
    s_waitcnt lgkmcnt(3)
    v_mfma_f32_32x32x16_bf16 v[106:121], v[94:97], v[78:81], v[106:121]
    v_cvt_pk_bf16_f32 v82, v42, v43
    v_cvt_pk_bf16_f32 v83, v44, v45
    v_cvt_pk_bf16_f32 v84, v46, v47
    v_cvt_pk_bf16_f32 v85, v48, v49
    v_cvt_pk_bf16_f32 v86, v50, v51
    v_cvt_pk_bf16_f32 v87, v52, v53
    v_cvt_pk_bf16_f32 v88, v54, v55
    v_cvt_pk_bf16_f32 v89, v56, v57
    ds_read_b128 v[18:21], v6 offset:11264
    s_waitcnt lgkmcnt(3)
    v_mfma_f32_32x32x16_bf16 v[42:57], v[14:17], v[10:13], v[58:73]
    s_mov_b64 exec, s[20:21]
    ds_read_b128 v[90:93], v7 offset:20480
    ds_read_b128 v[94:97], v7 offset:20992
    s_mov_b64 exec, -1
    v_exp_f32 v26, v26
    v_exp_f32 v27, v27
    v_exp_f32 v28, v28
    v_exp_f32 v29, v29
    v_exp_f32 v30, v30
    v_exp_f32 v31, v31
    v_exp_f32 v32, v32
    v_exp_f32 v33, v33
    s_waitcnt lgkmcnt(4)
    v_mfma_f32_32x32x16_bf16 v[106:121], v[98:101], v[82:85], v[106:121]
    v_exp_f32 v34, v34
    v_exp_f32 v35, v35
    v_exp_f32 v36, v36
    v_exp_f32 v37, v37
    v_exp_f32 v38, v38
    v_exp_f32 v39, v39
    v_exp_f32 v40, v40
    v_exp_f32 v41, v41
    s_waitcnt lgkmcnt(3)
    v_mfma_f32_32x32x16_bf16 v[106:121], v[102:105], v[86:89], v[106:121]
    v_cvt_pk_bf16_f32 v74, v26, v27
    v_cvt_pk_bf16_f32 v75, v28, v29
    v_cvt_pk_bf16_f32 v76, v30, v31
    v_cvt_pk_bf16_f32 v77, v32, v33
    v_cvt_pk_bf16_f32 v78, v34, v35
    v_cvt_pk_bf16_f32 v79, v36, v37
    v_cvt_pk_bf16_f32 v80, v38, v39
    v_cvt_pk_bf16_f32 v81, v40, v41
    ds_read_b128 v[22:25], v6 offset:11776
    s_waitcnt lgkmcnt(3)
    v_mfma_f32_32x32x16_bf16 v[26:41], v[18:21], v[10:13], v[58:73]
    s_mov_b64 exec, s[20:21]
    ds_read_b128 v[98:101], v7 offset:21504
    ds_read_b128 v[102:105], v7 offset:22016
    s_mov_b64 exec, -1
    v_exp_f32 v42, v42
    v_exp_f32 v43, v43
    v_exp_f32 v44, v44
    v_exp_f32 v45, v45
    v_exp_f32 v46, v46
    v_exp_f32 v47, v47
    v_exp_f32 v48, v48
    v_exp_f32 v49, v49
    s_waitcnt lgkmcnt(4)
    v_mfma_f32_32x32x16_bf16 v[106:121], v[90:93], v[74:77], v[106:121]
    v_exp_f32 v50, v50
    v_exp_f32 v51, v51
    v_exp_f32 v52, v52
    v_exp_f32 v53, v53
    v_exp_f32 v54, v54
    v_exp_f32 v55, v55
    v_exp_f32 v56, v56
    v_exp_f32 v57, v57
    s_waitcnt lgkmcnt(3)
    v_mfma_f32_32x32x16_bf16 v[106:121], v[94:97], v[78:81], v[106:121]
    v_cvt_pk_bf16_f32 v82, v42, v43
    v_cvt_pk_bf16_f32 v83, v44, v45
    v_cvt_pk_bf16_f32 v84, v46, v47
    v_cvt_pk_bf16_f32 v85, v48, v49
    v_cvt_pk_bf16_f32 v86, v50, v51
    v_cvt_pk_bf16_f32 v87, v52, v53
    v_cvt_pk_bf16_f32 v88, v54, v55
    v_cvt_pk_bf16_f32 v89, v56, v57
    ds_read_b128 v[14:17], v6 offset:12288
    s_waitcnt lgkmcnt(3)
    v_mfma_f32_32x32x16_bf16 v[42:57], v[22:25], v[10:13], v[58:73]
    s_mov_b64 exec, s[20:21]
    ds_read_b128 v[90:93], v7 offset:22528
    ds_read_b128 v[94:97], v7 offset:23040
    s_mov_b64 exec, -1
    v_exp_f32 v26, v26
    v_exp_f32 v27, v27
    v_exp_f32 v28, v28
    v_exp_f32 v29, v29
    v_exp_f32 v30, v30
    v_exp_f32 v31, v31
    v_exp_f32 v32, v32
    v_exp_f32 v33, v33
    s_waitcnt lgkmcnt(4)
    v_mfma_f32_32x32x16_bf16 v[106:121], v[98:101], v[82:85], v[106:121]
    v_exp_f32 v34, v34
    v_exp_f32 v35, v35
    v_exp_f32 v36, v36
    v_exp_f32 v37, v37
    v_exp_f32 v38, v38
    v_exp_f32 v39, v39
    v_exp_f32 v40, v40
    v_exp_f32 v41, v41
    s_waitcnt lgkmcnt(3)
    v_mfma_f32_32x32x16_bf16 v[106:121], v[102:105], v[86:89], v[106:121]
    v_cvt_pk_bf16_f32 v74, v26, v27
    v_cvt_pk_bf16_f32 v75, v28, v29
    v_cvt_pk_bf16_f32 v76, v30, v31
    v_cvt_pk_bf16_f32 v77, v32, v33
    v_cvt_pk_bf16_f32 v78, v34, v35
    v_cvt_pk_bf16_f32 v79, v36, v37
    v_cvt_pk_bf16_f32 v80, v38, v39
    v_cvt_pk_bf16_f32 v81, v40, v41
    ds_read_b128 v[18:21], v6 offset:12800
    s_waitcnt lgkmcnt(3)
    v_mfma_f32_32x32x16_bf16 v[26:41], v[14:17], v[10:13], v[58:73]
    s_mov_b64 exec, s[20:21]
    ds_read_b128 v[98:101], v7 offset:23552
    ds_read_b128 v[102:105], v7 offset:24064
    s_mov_b64 exec, -1
    v_exp_f32 v42, v42
    v_exp_f32 v43, v43
    v_exp_f32 v44, v44
    v_exp_f32 v45, v45
    v_exp_f32 v46, v46
    v_exp_f32 v47, v47
    v_exp_f32 v48, v48
    v_exp_f32 v49, v49
    s_waitcnt lgkmcnt(4)
    v_mfma_f32_32x32x16_bf16 v[106:121], v[90:93], v[74:77], v[106:121]
    v_exp_f32 v50, v50
    v_exp_f32 v51, v51
    v_exp_f32 v52, v52
    v_exp_f32 v53, v53
    v_exp_f32 v54, v54
    v_exp_f32 v55, v55
    v_exp_f32 v56, v56
    v_exp_f32 v57, v57
    s_waitcnt lgkmcnt(3)
    v_mfma_f32_32x32x16_bf16 v[106:121], v[94:97], v[78:81], v[106:121]
    v_cvt_pk_bf16_f32 v82, v42, v43
    v_cvt_pk_bf16_f32 v83, v44, v45
    v_cvt_pk_bf16_f32 v84, v46, v47
    v_cvt_pk_bf16_f32 v85, v48, v49
    v_cvt_pk_bf16_f32 v86, v50, v51
    v_cvt_pk_bf16_f32 v87, v52, v53
    v_cvt_pk_bf16_f32 v88, v54, v55
    v_cvt_pk_bf16_f32 v89, v56, v57
    ds_read_b128 v[22:25], v6 offset:13312
    s_waitcnt lgkmcnt(3)
    v_mfma_f32_32x32x16_bf16 v[42:57], v[18:21], v[10:13], v[58:73]
    s_mov_b64 exec, s[20:21]
    ds_read_b128 v[90:93], v7 offset:24576
    ds_read_b128 v[94:97], v7 offset:25088
    s_mov_b64 exec, -1
    v_exp_f32 v26, v26
    v_exp_f32 v27, v27
    v_exp_f32 v28, v28
    v_exp_f32 v29, v29
    v_exp_f32 v30, v30
    v_exp_f32 v31, v31
    v_exp_f32 v32, v32
    v_exp_f32 v33, v33
    s_waitcnt lgkmcnt(4)
    v_mfma_f32_32x32x16_bf16 v[106:121], v[98:101], v[82:85], v[106:121]
    v_exp_f32 v34, v34
    v_exp_f32 v35, v35
    v_exp_f32 v36, v36
    v_exp_f32 v37, v37
    v_exp_f32 v38, v38
    v_exp_f32 v39, v39
    v_exp_f32 v40, v40
    v_exp_f32 v41, v41
    s_waitcnt lgkmcnt(3)
    v_mfma_f32_32x32x16_bf16 v[106:121], v[102:105], v[86:89], v[106:121]
    v_cvt_pk_bf16_f32 v74, v26, v27
    v_cvt_pk_bf16_f32 v75, v28, v29
    v_cvt_pk_bf16_f32 v76, v30, v31
    v_cvt_pk_bf16_f32 v77, v32, v33
    v_cvt_pk_bf16_f32 v78, v34, v35
    v_cvt_pk_bf16_f32 v79, v36, v37
    v_cvt_pk_bf16_f32 v80, v38, v39
    v_cvt_pk_bf16_f32 v81, v40, v41
    ds_read_b128 v[14:17], v6 offset:13824
    s_waitcnt lgkmcnt(3)
    v_mfma_f32_32x32x16_bf16 v[26:41], v[22:25], v[10:13], v[58:73]
    s_mov_b64 exec, s[20:21]
    ds_read_b128 v[98:101], v7 offset:25600
    ds_read_b128 v[102:105], v7 offset:26112
    s_mov_b64 exec, -1
    v_exp_f32 v42, v42
    v_exp_f32 v43, v43
    v_exp_f32 v44, v44
    v_exp_f32 v45, v45
    v_exp_f32 v46, v46
    v_exp_f32 v47, v47
    v_exp_f32 v48, v48
    v_exp_f32 v49, v49
    s_waitcnt lgkmcnt(4)
    v_mfma_f32_32x32x16_bf16 v[106:121], v[90:93], v[74:77], v[106:121]
    v_exp_f32 v50, v50
    v_exp_f32 v51, v51
    v_exp_f32 v52, v52
    v_exp_f32 v53, v53
    v_exp_f32 v54, v54
    v_exp_f32 v55, v55
    v_exp_f32 v56, v56
    v_exp_f32 v57, v57
    s_waitcnt lgkmcnt(3)
    v_mfma_f32_32x32x16_bf16 v[106:121], v[94:97], v[78:81], v[106:121]
    v_cvt_pk_bf16_f32 v82, v42, v43
    v_cvt_pk_bf16_f32 v83, v44, v45
    v_cvt_pk_bf16_f32 v84, v46, v47
    v_cvt_pk_bf16_f32 v85, v48, v49
    v_cvt_pk_bf16_f32 v86, v50, v51
    v_cvt_pk_bf16_f32 v87, v52, v53
    v_cvt_pk_bf16_f32 v88, v54, v55
    v_cvt_pk_bf16_f32 v89, v56, v57
    ds_read_b128 v[18:21], v6 offset:14336
    s_waitcnt lgkmcnt(3)
    v_mfma_f32_32x32x16_bf16 v[42:57], v[14:17], v[10:13], v[58:73]
    s_mov_b64 exec, s[20:21]
    ds_read_b128 v[90:93], v7 offset:26624
    ds_read_b128 v[94:97], v7 offset:27136
    s_mov_b64 exec, -1
    v_exp_f32 v26, v26
    v_exp_f32 v27, v27
    v_exp_f32 v28, v28
    v_exp_f32 v29, v29
    v_exp_f32 v30, v30
    v_exp_f32 v31, v31
    v_exp_f32 v32, v32
    v_exp_f32 v33, v33
    s_waitcnt lgkmcnt(4)
    v_mfma_f32_32x32x16_bf16 v[106:121], v[98:101], v[82:85], v[106:121]
    v_exp_f32 v34, v34
    v_exp_f32 v35, v35
    v_exp_f32 v36, v36
    v_exp_f32 v37, v37
    v_exp_f32 v38, v38
    v_exp_f32 v39, v39
    v_exp_f32 v40, v40
    v_exp_f32 v41, v41
    s_waitcnt lgkmcnt(3)
    v_mfma_f32_32x32x16_bf16 v[106:121], v[102:105], v[86:89], v[106:121]
    v_cvt_pk_bf16_f32 v74, v26, v27
    v_cvt_pk_bf16_f32 v75, v28, v29
    v_cvt_pk_bf16_f32 v76, v30, v31
    v_cvt_pk_bf16_f32 v77, v32, v33
    v_cvt_pk_bf16_f32 v78, v34, v35
    v_cvt_pk_bf16_f32 v79, v36, v37
    v_cvt_pk_bf16_f32 v80, v38, v39
    v_cvt_pk_bf16_f32 v81, v40, v41
    ds_read_b128 v[22:25], v6 offset:14848
    s_waitcnt lgkmcnt(3)
    v_mfma_f32_32x32x16_bf16 v[26:41], v[18:21], v[10:13], v[58:73]
    s_mov_b64 exec, s[20:21]
    ds_read_b128 v[98:101], v7 offset:27648
    ds_read_b128 v[102:105], v7 offset:28160
    s_mov_b64 exec, -1
    v_exp_f32 v42, v42
    v_exp_f32 v43, v43
    v_exp_f32 v44, v44
    v_exp_f32 v45, v45
    v_exp_f32 v46, v46
    v_exp_f32 v47, v47
    v_exp_f32 v48, v48
    v_exp_f32 v49, v49
    s_waitcnt lgkmcnt(4)
    v_mfma_f32_32x32x16_bf16 v[106:121], v[90:93], v[74:77], v[106:121]
    v_exp_f32 v50, v50
    v_exp_f32 v51, v51
    v_exp_f32 v52, v52
    v_exp_f32 v53, v53
    v_exp_f32 v54, v54
    v_exp_f32 v55, v55
    v_exp_f32 v56, v56
    v_exp_f32 v57, v57
    s_waitcnt lgkmcnt(3)
    v_mfma_f32_32x32x16_bf16 v[106:121], v[94:97], v[78:81], v[106:121]
    v_cvt_pk_bf16_f32 v82, v42, v43
    v_cvt_pk_bf16_f32 v83, v44, v45
    v_cvt_pk_bf16_f32 v84, v46, v47
    v_cvt_pk_bf16_f32 v85, v48, v49
    v_cvt_pk_bf16_f32 v86, v50, v51
    v_cvt_pk_bf16_f32 v87, v52, v53
    v_cvt_pk_bf16_f32 v88, v54, v55
    v_cvt_pk_bf16_f32 v89, v56, v57
    ds_read_b128 v[14:17], v6 offset:15360
    s_waitcnt lgkmcnt(3)
    v_mfma_f32_32x32x16_bf16 v[42:57], v[22:25], v[10:13], v[58:73]
    s_mov_b64 exec, s[20:21]
    ds_read_b128 v[90:93], v7 offset:28672
    ds_read_b128 v[94:97], v7 offset:29184
    s_mov_b64 exec, -1
    v_exp_f32 v26, v26
    v_exp_f32 v27, v27
    v_exp_f32 v28, v28
    v_exp_f32 v29, v29
    v_exp_f32 v30, v30
    v_exp_f32 v31, v31
    v_exp_f32 v32, v32
    v_exp_f32 v33, v33
    s_waitcnt lgkmcnt(4)
    v_mfma_f32_32x32x16_bf16 v[106:121], v[98:101], v[82:85], v[106:121]
    v_exp_f32 v34, v34
    v_exp_f32 v35, v35
    v_exp_f32 v36, v36
    v_exp_f32 v37, v37
    v_exp_f32 v38, v38
    v_exp_f32 v39, v39
    v_exp_f32 v40, v40
    v_exp_f32 v41, v41
    s_waitcnt lgkmcnt(3)
    v_mfma_f32_32x32x16_bf16 v[106:121], v[102:105], v[86:89], v[106:121]
    v_cvt_pk_bf16_f32 v74, v26, v27
    v_cvt_pk_bf16_f32 v75, v28, v29
    v_cvt_pk_bf16_f32 v76, v30, v31
    v_cvt_pk_bf16_f32 v77, v32, v33
    v_cvt_pk_bf16_f32 v78, v34, v35
    v_cvt_pk_bf16_f32 v79, v36, v37
    v_cvt_pk_bf16_f32 v80, v38, v39
    v_cvt_pk_bf16_f32 v81, v40, v41
    ds_read_b128 v[18:21], v6 offset:15872
    s_waitcnt lgkmcnt(3)
    v_mfma_f32_32x32x16_bf16 v[26:41], v[14:17], v[10:13], v[58:73]
    s_mov_b64 exec, s[20:21]
    ds_read_b128 v[98:101], v7 offset:29696
    ds_read_b128 v[102:105], v7 offset:30208
    s_mov_b64 exec, -1
    v_exp_f32 v42, v42
    v_exp_f32 v43, v43
    v_exp_f32 v44, v44
    v_exp_f32 v45, v45
    v_exp_f32 v46, v46
    v_exp_f32 v47, v47
    v_exp_f32 v48, v48
    v_exp_f32 v49, v49
    s_waitcnt lgkmcnt(4)
    v_mfma_f32_32x32x16_bf16 v[106:121], v[90:93], v[74:77], v[106:121]
    v_exp_f32 v50, v50
    v_exp_f32 v51, v51
    v_exp_f32 v52, v52
    v_exp_f32 v53, v53
    v_exp_f32 v54, v54
    v_exp_f32 v55, v55
    v_exp_f32 v56, v56
    v_exp_f32 v57, v57
    s_waitcnt lgkmcnt(3)
    v_mfma_f32_32x32x16_bf16 v[106:121], v[94:97], v[78:81], v[106:121]
    v_cvt_pk_bf16_f32 v82, v42, v43
    v_cvt_pk_bf16_f32 v83, v44, v45
    v_cvt_pk_bf16_f32 v84, v46, v47
    v_cvt_pk_bf16_f32 v85, v48, v49
    v_cvt_pk_bf16_f32 v86, v50, v51
    v_cvt_pk_bf16_f32 v87, v52, v53
    v_cvt_pk_bf16_f32 v88, v54, v55
    v_cvt_pk_bf16_f32 v89, v56, v57
    ds_read_b128 v[22:25], v6 offset:16384
    s_waitcnt lgkmcnt(3)
    v_mfma_f32_32x32x16_bf16 v[42:57], v[18:21], v[10:13], v[58:73]
    s_mov_b64 exec, s[20:21]
    ds_read_b128 v[90:93], v7 offset:30720
    ds_read_b128 v[94:97], v7 offset:31232
    s_mov_b64 exec, -1
    v_exp_f32 v26, v26
    v_exp_f32 v27, v27
    v_exp_f32 v28, v28
    v_exp_f32 v29, v29
    v_exp_f32 v30, v30
    v_exp_f32 v31, v31
    v_exp_f32 v32, v32
    v_exp_f32 v33, v33
    s_waitcnt lgkmcnt(4)
    v_mfma_f32_32x32x16_bf16 v[106:121], v[98:101], v[82:85], v[106:121]
    v_exp_f32 v34, v34
    v_exp_f32 v35, v35
    v_exp_f32 v36, v36
    v_exp_f32 v37, v37
    v_exp_f32 v38, v38
    v_exp_f32 v39, v39
    v_exp_f32 v40, v40
    v_exp_f32 v41, v41
    s_waitcnt lgkmcnt(3)
    v_mfma_f32_32x32x16_bf16 v[106:121], v[102:105], v[86:89], v[106:121]
    v_cvt_pk_bf16_f32 v74, v26, v27
    v_cvt_pk_bf16_f32 v75, v28, v29
    v_cvt_pk_bf16_f32 v76, v30, v31
    v_cvt_pk_bf16_f32 v77, v32, v33
    v_cvt_pk_bf16_f32 v78, v34, v35
    v_cvt_pk_bf16_f32 v79, v36, v37
    v_cvt_pk_bf16_f32 v80, v38, v39
    v_cvt_pk_bf16_f32 v81, v40, v41
    ds_read_b128 v[14:17], v6 offset:16896
    s_waitcnt lgkmcnt(3)
    v_mfma_f32_32x32x16_bf16 v[26:41], v[22:25], v[10:13], v[58:73]
    s_mov_b64 exec, s[20:21]
    ds_read_b128 v[98:101], v7 offset:31744
    ds_read_b128 v[102:105], v7 offset:32256
    s_mov_b64 exec, -1
    v_exp_f32 v42, v42
    v_exp_f32 v43, v43
    v_exp_f32 v44, v44
    v_exp_f32 v45, v45
    v_exp_f32 v46, v46
    v_exp_f32 v47, v47
    v_exp_f32 v48, v48
    v_exp_f32 v49, v49
    s_waitcnt lgkmcnt(4)
    v_mfma_f32_32x32x16_bf16 v[106:121], v[90:93], v[74:77], v[106:121]
    v_exp_f32 v50, v50
    v_exp_f32 v51, v51
    v_exp_f32 v52, v52
    v_exp_f32 v53, v53
    v_exp_f32 v54, v54
    v_exp_f32 v55, v55
    v_exp_f32 v56, v56
    v_exp_f32 v57, v57
    s_waitcnt lgkmcnt(3)
    v_mfma_f32_32x32x16_bf16 v[106:121], v[94:97], v[78:81], v[106:121]
    v_cvt_pk_bf16_f32 v82, v42, v43
    v_cvt_pk_bf16_f32 v83, v44, v45
    v_cvt_pk_bf16_f32 v84, v46, v47
    v_cvt_pk_bf16_f32 v85, v48, v49
    v_cvt_pk_bf16_f32 v86, v50, v51
    v_cvt_pk_bf16_f32 v87, v52, v53
    v_cvt_pk_bf16_f32 v88, v54, v55
    v_cvt_pk_bf16_f32 v89, v56, v57
    ds_read_b128 v[18:21], v6 offset:17408
    s_waitcnt lgkmcnt(3)
    v_mfma_f32_32x32x16_bf16 v[42:57], v[14:17], v[10:13], v[58:73]
    s_mov_b64 exec, s[20:21]
    ds_read_b128 v[90:93], v7 offset:32768
    ds_read_b128 v[94:97], v7 offset:33280
    s_mov_b64 exec, -1
    v_exp_f32 v26, v26
    v_exp_f32 v27, v27
    v_exp_f32 v28, v28
    v_exp_f32 v29, v29
    v_exp_f32 v30, v30
    v_exp_f32 v31, v31
    v_exp_f32 v32, v32
    v_exp_f32 v33, v33
    s_waitcnt lgkmcnt(4)
    v_mfma_f32_32x32x16_bf16 v[106:121], v[98:101], v[82:85], v[106:121]
    v_exp_f32 v34, v34
    v_exp_f32 v35, v35
    v_exp_f32 v36, v36
    v_exp_f32 v37, v37
    v_exp_f32 v38, v38
    v_exp_f32 v39, v39
    v_exp_f32 v40, v40
    v_exp_f32 v41, v41
    s_waitcnt lgkmcnt(3)
    v_mfma_f32_32x32x16_bf16 v[106:121], v[102:105], v[86:89], v[106:121]
    v_cvt_pk_bf16_f32 v74, v26, v27
    v_cvt_pk_bf16_f32 v75, v28, v29
    v_cvt_pk_bf16_f32 v76, v30, v31
    v_cvt_pk_bf16_f32 v77, v32, v33
    v_cvt_pk_bf16_f32 v78, v34, v35
    v_cvt_pk_bf16_f32 v79, v36, v37
    v_cvt_pk_bf16_f32 v80, v38, v39
    v_cvt_pk_bf16_f32 v81, v40, v41
    ds_read_b128 v[22:25], v6 offset:17920
    s_waitcnt lgkmcnt(3)
    v_mfma_f32_32x32x16_bf16 v[26:41], v[18:21], v[10:13], v[58:73]
    s_mov_b64 exec, s[20:21]
    ds_read_b128 v[98:101], v7 offset:33792
    ds_read_b128 v[102:105], v7 offset:34304
    s_mov_b64 exec, -1
    v_exp_f32 v42, v42
    v_exp_f32 v43, v43
    v_exp_f32 v44, v44
    v_exp_f32 v45, v45
    v_exp_f32 v46, v46
    v_exp_f32 v47, v47
    v_exp_f32 v48, v48
    v_exp_f32 v49, v49
    s_waitcnt lgkmcnt(4)
    v_mfma_f32_32x32x16_bf16 v[106:121], v[90:93], v[74:77], v[106:121]
    v_exp_f32 v50, v50
    v_exp_f32 v51, v51
    v_exp_f32 v52, v52
    v_exp_f32 v53, v53
    v_exp_f32 v54, v54
    v_exp_f32 v55, v55
    v_exp_f32 v56, v56
    v_exp_f32 v57, v57
    s_waitcnt lgkmcnt(3)
    v_mfma_f32_32x32x16_bf16 v[106:121], v[94:97], v[78:81], v[106:121]
    v_cvt_pk_bf16_f32 v82, v42, v43
    v_cvt_pk_bf16_f32 v83, v44, v45
    v_cvt_pk_bf16_f32 v84, v46, v47
    v_cvt_pk_bf16_f32 v85, v48, v49
    v_cvt_pk_bf16_f32 v86, v50, v51
    v_cvt_pk_bf16_f32 v87, v52, v53
    v_cvt_pk_bf16_f32 v88, v54, v55
    v_cvt_pk_bf16_f32 v89, v56, v57
    ds_read_b128 v[14:17], v6 offset:18432
    s_waitcnt lgkmcnt(3)
    v_mfma_f32_32x32x16_bf16 v[42:57], v[22:25], v[10:13], v[58:73]
    s_mov_b64 exec, s[20:21]
    ds_read_b128 v[90:93], v7 offset:34816
    ds_read_b128 v[94:97], v7 offset:35328
    s_mov_b64 exec, -1
    v_exp_f32 v26, v26
    v_exp_f32 v27, v27
    v_exp_f32 v28, v28
    v_exp_f32 v29, v29
    v_exp_f32 v30, v30
    v_exp_f32 v31, v31
    v_exp_f32 v32, v32
    v_exp_f32 v33, v33
    s_waitcnt lgkmcnt(4)
    v_mfma_f32_32x32x16_bf16 v[106:121], v[98:101], v[82:85], v[106:121]
    v_exp_f32 v34, v34
    v_exp_f32 v35, v35
    v_exp_f32 v36, v36
    v_exp_f32 v37, v37
    v_exp_f32 v38, v38
    v_exp_f32 v39, v39
    v_exp_f32 v40, v40
    v_exp_f32 v41, v41
    s_waitcnt lgkmcnt(3)
    v_mfma_f32_32x32x16_bf16 v[106:121], v[102:105], v[86:89], v[106:121]
    v_cvt_pk_bf16_f32 v74, v26, v27
    v_cvt_pk_bf16_f32 v75, v28, v29
    v_cvt_pk_bf16_f32 v76, v30, v31
    v_cvt_pk_bf16_f32 v77, v32, v33
    v_cvt_pk_bf16_f32 v78, v34, v35
    v_cvt_pk_bf16_f32 v79, v36, v37
    v_cvt_pk_bf16_f32 v80, v38, v39
    v_cvt_pk_bf16_f32 v81, v40, v41
    ds_read_b128 v[18:21], v6 offset:18944
    s_waitcnt lgkmcnt(3)
    v_mfma_f32_32x32x16_bf16 v[26:41], v[14:17], v[10:13], v[58:73]
    s_mov_b64 exec, s[20:21]
    ds_read_b128 v[98:101], v7 offset:35840
    ds_read_b128 v[102:105], v7 offset:36352
    s_mov_b64 exec, -1
    v_exp_f32 v42, v42
    v_exp_f32 v43, v43
    v_exp_f32 v44, v44
    v_exp_f32 v45, v45
    v_exp_f32 v46, v46
    v_exp_f32 v47, v47
    v_exp_f32 v48, v48
    v_exp_f32 v49, v49
    s_waitcnt lgkmcnt(4)
    v_mfma_f32_32x32x16_bf16 v[106:121], v[90:93], v[74:77], v[106:121]
    v_exp_f32 v50, v50
    v_exp_f32 v51, v51
    v_exp_f32 v52, v52
    v_exp_f32 v53, v53
    v_exp_f32 v54, v54
    v_exp_f32 v55, v55
    v_exp_f32 v56, v56
    v_exp_f32 v57, v57
    s_waitcnt lgkmcnt(3)
    v_mfma_f32_32x32x16_bf16 v[106:121], v[94:97], v[78:81], v[106:121]
    v_cvt_pk_bf16_f32 v82, v42, v43
    v_cvt_pk_bf16_f32 v83, v44, v45
    v_cvt_pk_bf16_f32 v84, v46, v47
    v_cvt_pk_bf16_f32 v85, v48, v49
    v_cvt_pk_bf16_f32 v86, v50, v51
    v_cvt_pk_bf16_f32 v87, v52, v53
    v_cvt_pk_bf16_f32 v88, v54, v55
    v_cvt_pk_bf16_f32 v89, v56, v57
    ds_read_b128 v[22:25], v6 offset:19456
    s_waitcnt lgkmcnt(3)
    v_mfma_f32_32x32x16_bf16 v[42:57], v[18:21], v[10:13], v[58:73]
    s_mov_b64 exec, s[20:21]
    ds_read_b128 v[90:93], v7 offset:36864
    ds_read_b128 v[94:97], v7 offset:37376
    s_mov_b64 exec, -1
    v_exp_f32 v26, v26
    v_exp_f32 v27, v27
    v_exp_f32 v28, v28
    v_exp_f32 v29, v29
    v_exp_f32 v30, v30
    v_exp_f32 v31, v31
    v_exp_f32 v32, v32
    v_exp_f32 v33, v33
    s_waitcnt lgkmcnt(4)
    v_mfma_f32_32x32x16_bf16 v[106:121], v[98:101], v[82:85], v[106:121]
    v_exp_f32 v34, v34
    v_exp_f32 v35, v35
    v_exp_f32 v36, v36
    v_exp_f32 v37, v37
    v_exp_f32 v38, v38
    v_exp_f32 v39, v39
    v_exp_f32 v40, v40
    v_exp_f32 v41, v41
    s_waitcnt lgkmcnt(3)
    v_mfma_f32_32x32x16_bf16 v[106:121], v[102:105], v[86:89], v[106:121]
    v_cvt_pk_bf16_f32 v74, v26, v27
    v_cvt_pk_bf16_f32 v75, v28, v29
    v_cvt_pk_bf16_f32 v76, v30, v31
    v_cvt_pk_bf16_f32 v77, v32, v33
    v_cvt_pk_bf16_f32 v78, v34, v35
    v_cvt_pk_bf16_f32 v79, v36, v37
    v_cvt_pk_bf16_f32 v80, v38, v39
    v_cvt_pk_bf16_f32 v81, v40, v41
    ds_read_b128 v[14:17], v6 offset:19968
    s_waitcnt lgkmcnt(3)
    v_mfma_f32_32x32x16_bf16 v[26:41], v[22:25], v[10:13], v[58:73]
    s_mov_b64 exec, s[20:21]
    ds_read_b128 v[98:101], v7 offset:37888
    ds_read_b128 v[102:105], v7 offset:38400
    s_mov_b64 exec, -1
    v_exp_f32 v42, v42
    v_exp_f32 v43, v43
    v_exp_f32 v44, v44
    v_exp_f32 v45, v45
    v_exp_f32 v46, v46
    v_exp_f32 v47, v47
    v_exp_f32 v48, v48
    v_exp_f32 v49, v49
    s_waitcnt lgkmcnt(4)
    v_mfma_f32_32x32x16_bf16 v[106:121], v[90:93], v[74:77], v[106:121]
    v_exp_f32 v50, v50
    v_exp_f32 v51, v51
    v_exp_f32 v52, v52
    v_exp_f32 v53, v53
    v_exp_f32 v54, v54
    v_exp_f32 v55, v55
    v_exp_f32 v56, v56
    v_exp_f32 v57, v57
    s_waitcnt lgkmcnt(3)
    v_mfma_f32_32x32x16_bf16 v[106:121], v[94:97], v[78:81], v[106:121]
    v_cvt_pk_bf16_f32 v82, v42, v43
    v_cvt_pk_bf16_f32 v83, v44, v45
    v_cvt_pk_bf16_f32 v84, v46, v47
    v_cvt_pk_bf16_f32 v85, v48, v49
    v_cvt_pk_bf16_f32 v86, v50, v51
    v_cvt_pk_bf16_f32 v87, v52, v53
    v_cvt_pk_bf16_f32 v88, v54, v55
    v_cvt_pk_bf16_f32 v89, v56, v57
    ds_read_b128 v[18:21], v6 offset:20480
    s_waitcnt lgkmcnt(3)
    v_mfma_f32_32x32x16_bf16 v[42:57], v[14:17], v[10:13], v[58:73]
    s_mov_b64 exec, s[20:21]
    ds_read_b128 v[90:93], v7 offset:38912
    ds_read_b128 v[94:97], v7 offset:39424
    s_mov_b64 exec, -1
    v_exp_f32 v26, v26
    v_exp_f32 v27, v27
    v_exp_f32 v28, v28
    v_exp_f32 v29, v29
    v_exp_f32 v30, v30
    v_exp_f32 v31, v31
    v_exp_f32 v32, v32
    v_exp_f32 v33, v33
    s_waitcnt lgkmcnt(4)
    v_mfma_f32_32x32x16_bf16 v[106:121], v[98:101], v[82:85], v[106:121]
    v_exp_f32 v34, v34
    v_exp_f32 v35, v35
    v_exp_f32 v36, v36
    v_exp_f32 v37, v37
    v_exp_f32 v38, v38
    v_exp_f32 v39, v39
    v_exp_f32 v40, v40
    v_exp_f32 v41, v41
    s_waitcnt lgkmcnt(3)
    v_mfma_f32_32x32x16_bf16 v[106:121], v[102:105], v[86:89], v[106:121]
    v_cvt_pk_bf16_f32 v74, v26, v27
    v_cvt_pk_bf16_f32 v75, v28, v29
    v_cvt_pk_bf16_f32 v76, v30, v31
    v_cvt_pk_bf16_f32 v77, v32, v33
    v_cvt_pk_bf16_f32 v78, v34, v35
    v_cvt_pk_bf16_f32 v79, v36, v37
    v_cvt_pk_bf16_f32 v80, v38, v39
    v_cvt_pk_bf16_f32 v81, v40, v41
    ds_read_b128 v[22:25], v6 offset:20992
    s_waitcnt lgkmcnt(3)
    v_mfma_f32_32x32x16_bf16 v[26:41], v[18:21], v[10:13], v[58:73]
    s_mov_b64 exec, s[20:21]
    ds_read_b128 v[98:101], v7 offset:39936
    ds_read_b128 v[102:105], v7 offset:40448
    s_mov_b64 exec, -1
    v_exp_f32 v42, v42
    v_exp_f32 v43, v43
    v_exp_f32 v44, v44
    v_exp_f32 v45, v45
    v_exp_f32 v46, v46
    v_exp_f32 v47, v47
    v_exp_f32 v48, v48
    v_exp_f32 v49, v49
    s_waitcnt lgkmcnt(4)
    v_mfma_f32_32x32x16_bf16 v[106:121], v[90:93], v[74:77], v[106:121]
    v_exp_f32 v50, v50
    v_exp_f32 v51, v51
    v_exp_f32 v52, v52
    v_exp_f32 v53, v53
    v_exp_f32 v54, v54
    v_exp_f32 v55, v55
    v_exp_f32 v56, v56
    v_exp_f32 v57, v57
    s_waitcnt lgkmcnt(3)
    v_mfma_f32_32x32x16_bf16 v[106:121], v[94:97], v[78:81], v[106:121]
    v_cvt_pk_bf16_f32 v82, v42, v43
    v_cvt_pk_bf16_f32 v83, v44, v45
    v_cvt_pk_bf16_f32 v84, v46, v47
    v_cvt_pk_bf16_f32 v85, v48, v49
    v_cvt_pk_bf16_f32 v86, v50, v51
    v_cvt_pk_bf16_f32 v87, v52, v53
    v_cvt_pk_bf16_f32 v88, v54, v55
    v_cvt_pk_bf16_f32 v89, v56, v57
    ds_read_b128 v[14:17], v6 offset:21504
    s_waitcnt lgkmcnt(3)
    v_mfma_f32_32x32x16_bf16 v[42:57], v[22:25], v[10:13], v[58:73]
    s_mov_b64 exec, s[20:21]
    ds_read_b128 v[90:93], v7 offset:40960
    ds_read_b128 v[94:97], v7 offset:41472
    s_mov_b64 exec, -1
    v_exp_f32 v26, v26
    v_exp_f32 v27, v27
    v_exp_f32 v28, v28
    v_exp_f32 v29, v29
    v_exp_f32 v30, v30
    v_exp_f32 v31, v31
    v_exp_f32 v32, v32
    v_exp_f32 v33, v33
    s_waitcnt lgkmcnt(4)
    v_mfma_f32_32x32x16_bf16 v[106:121], v[98:101], v[82:85], v[106:121]
    v_exp_f32 v34, v34
    v_exp_f32 v35, v35
    v_exp_f32 v36, v36
    v_exp_f32 v37, v37
    v_exp_f32 v38, v38
    v_exp_f32 v39, v39
    v_exp_f32 v40, v40
    v_exp_f32 v41, v41
    s_waitcnt lgkmcnt(3)
    v_mfma_f32_32x32x16_bf16 v[106:121], v[102:105], v[86:89], v[106:121]
    v_cvt_pk_bf16_f32 v74, v26, v27
    v_cvt_pk_bf16_f32 v75, v28, v29
    v_cvt_pk_bf16_f32 v76, v30, v31
    v_cvt_pk_bf16_f32 v77, v32, v33
    v_cvt_pk_bf16_f32 v78, v34, v35
    v_cvt_pk_bf16_f32 v79, v36, v37
    v_cvt_pk_bf16_f32 v80, v38, v39
    v_cvt_pk_bf16_f32 v81, v40, v41
    ds_read_b128 v[18:21], v6 offset:22016
    s_waitcnt lgkmcnt(3)
    v_mfma_f32_32x32x16_bf16 v[26:41], v[14:17], v[10:13], v[58:73]
    s_mov_b64 exec, s[20:21]
    ds_read_b128 v[98:101], v7 offset:41984
    ds_read_b128 v[102:105], v7 offset:42496
    s_mov_b64 exec, -1
    v_exp_f32 v42, v42
    v_exp_f32 v43, v43
    v_exp_f32 v44, v44
    v_exp_f32 v45, v45
    v_exp_f32 v46, v46
    v_exp_f32 v47, v47
    v_exp_f32 v48, v48
    v_exp_f32 v49, v49
    s_waitcnt lgkmcnt(4)
    v_mfma_f32_32x32x16_bf16 v[106:121], v[90:93], v[74:77], v[106:121]
    v_exp_f32 v50, v50
    v_exp_f32 v51, v51
    v_exp_f32 v52, v52
    v_exp_f32 v53, v53
    v_exp_f32 v54, v54
    v_exp_f32 v55, v55
    v_exp_f32 v56, v56
    v_exp_f32 v57, v57
    s_waitcnt lgkmcnt(3)
    v_mfma_f32_32x32x16_bf16 v[106:121], v[94:97], v[78:81], v[106:121]
    v_cvt_pk_bf16_f32 v82, v42, v43
    v_cvt_pk_bf16_f32 v83, v44, v45
    v_cvt_pk_bf16_f32 v84, v46, v47
    v_cvt_pk_bf16_f32 v85, v48, v49
    v_cvt_pk_bf16_f32 v86, v50, v51
    v_cvt_pk_bf16_f32 v87, v52, v53
    v_cvt_pk_bf16_f32 v88, v54, v55
    v_cvt_pk_bf16_f32 v89, v56, v57
    ds_read_b128 v[22:25], v6 offset:22528
    s_waitcnt lgkmcnt(3)
    v_mfma_f32_32x32x16_bf16 v[42:57], v[18:21], v[10:13], v[58:73]
    s_mov_b64 exec, s[20:21]
    ds_read_b128 v[90:93], v7 offset:43008
    ds_read_b128 v[94:97], v7 offset:43520
    s_mov_b64 exec, -1
    v_exp_f32 v26, v26
    v_exp_f32 v27, v27
    v_exp_f32 v28, v28
    v_exp_f32 v29, v29
    v_exp_f32 v30, v30
    v_exp_f32 v31, v31
    v_exp_f32 v32, v32
    v_exp_f32 v33, v33
    s_waitcnt lgkmcnt(4)
    v_mfma_f32_32x32x16_bf16 v[106:121], v[98:101], v[82:85], v[106:121]
    v_exp_f32 v34, v34
    v_exp_f32 v35, v35
    v_exp_f32 v36, v36
    v_exp_f32 v37, v37
    v_exp_f32 v38, v38
    v_exp_f32 v39, v39
    v_exp_f32 v40, v40
    v_exp_f32 v41, v41
    s_waitcnt lgkmcnt(3)
    v_mfma_f32_32x32x16_bf16 v[106:121], v[102:105], v[86:89], v[106:121]
    v_cvt_pk_bf16_f32 v74, v26, v27
    v_cvt_pk_bf16_f32 v75, v28, v29
    v_cvt_pk_bf16_f32 v76, v30, v31
    v_cvt_pk_bf16_f32 v77, v32, v33
    v_cvt_pk_bf16_f32 v78, v34, v35
    v_cvt_pk_bf16_f32 v79, v36, v37
    v_cvt_pk_bf16_f32 v80, v38, v39
    v_cvt_pk_bf16_f32 v81, v40, v41
    ds_read_b128 v[14:17], v6 offset:23040
    s_waitcnt lgkmcnt(3)
    v_mfma_f32_32x32x16_bf16 v[26:41], v[22:25], v[10:13], v[58:73]
    s_mov_b64 exec, s[20:21]
    ds_read_b128 v[98:101], v7 offset:44032
    ds_read_b128 v[102:105], v7 offset:44544
    s_mov_b64 exec, -1
    v_exp_f32 v42, v42
    v_exp_f32 v43, v43
    v_exp_f32 v44, v44
    v_exp_f32 v45, v45
    v_exp_f32 v46, v46
    v_exp_f32 v47, v47
    v_exp_f32 v48, v48
    v_exp_f32 v49, v49
    s_waitcnt lgkmcnt(4)
    v_mfma_f32_32x32x16_bf16 v[106:121], v[90:93], v[74:77], v[106:121]
    v_exp_f32 v50, v50
    v_exp_f32 v51, v51
    v_exp_f32 v52, v52
    v_exp_f32 v53, v53
    v_exp_f32 v54, v54
    v_exp_f32 v55, v55
    v_exp_f32 v56, v56
    v_exp_f32 v57, v57
    s_waitcnt lgkmcnt(3)
    v_mfma_f32_32x32x16_bf16 v[106:121], v[94:97], v[78:81], v[106:121]
    v_cvt_pk_bf16_f32 v82, v42, v43
    v_cvt_pk_bf16_f32 v83, v44, v45
    v_cvt_pk_bf16_f32 v84, v46, v47
    v_cvt_pk_bf16_f32 v85, v48, v49
    v_cvt_pk_bf16_f32 v86, v50, v51
    v_cvt_pk_bf16_f32 v87, v52, v53
    v_cvt_pk_bf16_f32 v88, v54, v55
    v_cvt_pk_bf16_f32 v89, v56, v57
    ds_read_b128 v[18:21], v6 offset:23552
    s_waitcnt lgkmcnt(3)
    v_mfma_f32_32x32x16_bf16 v[42:57], v[14:17], v[10:13], v[58:73]
    s_mov_b64 exec, s[20:21]
    ds_read_b128 v[90:93], v7 offset:45056
    ds_read_b128 v[94:97], v7 offset:45568
    s_mov_b64 exec, -1
    v_exp_f32 v26, v26
    v_exp_f32 v27, v27
    v_exp_f32 v28, v28
    v_exp_f32 v29, v29
    v_exp_f32 v30, v30
    v_exp_f32 v31, v31
    v_exp_f32 v32, v32
    v_exp_f32 v33, v33
    s_waitcnt lgkmcnt(4)
    v_mfma_f32_32x32x16_bf16 v[106:121], v[98:101], v[82:85], v[106:121]
    v_exp_f32 v34, v34
    v_exp_f32 v35, v35
    v_exp_f32 v36, v36
    v_exp_f32 v37, v37
    v_exp_f32 v38, v38
    v_exp_f32 v39, v39
    v_exp_f32 v40, v40
    v_exp_f32 v41, v41
    s_waitcnt lgkmcnt(3)
    v_mfma_f32_32x32x16_bf16 v[106:121], v[102:105], v[86:89], v[106:121]
    v_cvt_pk_bf16_f32 v74, v26, v27
    v_cvt_pk_bf16_f32 v75, v28, v29
    v_cvt_pk_bf16_f32 v76, v30, v31
    v_cvt_pk_bf16_f32 v77, v32, v33
    v_cvt_pk_bf16_f32 v78, v34, v35
    v_cvt_pk_bf16_f32 v79, v36, v37
    v_cvt_pk_bf16_f32 v80, v38, v39
    v_cvt_pk_bf16_f32 v81, v40, v41
    ds_read_b128 v[22:25], v6 offset:24064
    s_waitcnt lgkmcnt(3)
    v_mfma_f32_32x32x16_bf16 v[26:41], v[18:21], v[10:13], v[58:73]
    s_mov_b64 exec, s[20:21]
    ds_read_b128 v[98:101], v7 offset:46080
    ds_read_b128 v[102:105], v7 offset:46592
    s_mov_b64 exec, -1
    v_exp_f32 v42, v42
    v_exp_f32 v43, v43
    v_exp_f32 v44, v44
    v_exp_f32 v45, v45
    v_exp_f32 v46, v46
    v_exp_f32 v47, v47
    v_exp_f32 v48, v48
    v_exp_f32 v49, v49
    s_waitcnt lgkmcnt(4)
    v_mfma_f32_32x32x16_bf16 v[106:121], v[90:93], v[74:77], v[106:121]
    v_exp_f32 v50, v50
    v_exp_f32 v51, v51
    v_exp_f32 v52, v52
    v_exp_f32 v53, v53
    v_exp_f32 v54, v54
    v_exp_f32 v55, v55
    v_exp_f32 v56, v56
    v_exp_f32 v57, v57
    s_waitcnt lgkmcnt(3)
    v_mfma_f32_32x32x16_bf16 v[106:121], v[94:97], v[78:81], v[106:121]
    v_cvt_pk_bf16_f32 v82, v42, v43
    v_cvt_pk_bf16_f32 v83, v44, v45
    v_cvt_pk_bf16_f32 v84, v46, v47
    v_cvt_pk_bf16_f32 v85, v48, v49
    v_cvt_pk_bf16_f32 v86, v50, v51
    v_cvt_pk_bf16_f32 v87, v52, v53
    v_cvt_pk_bf16_f32 v88, v54, v55
    v_cvt_pk_bf16_f32 v89, v56, v57
    ds_read_b128 v[14:17], v6 offset:24576
    s_waitcnt lgkmcnt(3)
    v_mfma_f32_32x32x16_bf16 v[42:57], v[22:25], v[10:13], v[58:73]
    s_mov_b64 exec, s[20:21]
    ds_read_b128 v[90:93], v7 offset:47104
    ds_read_b128 v[94:97], v7 offset:47616
    s_mov_b64 exec, -1
    v_exp_f32 v26, v26
    v_exp_f32 v27, v27
    v_exp_f32 v28, v28
    v_exp_f32 v29, v29
    v_exp_f32 v30, v30
    v_exp_f32 v31, v31
    v_exp_f32 v32, v32
    v_exp_f32 v33, v33
    s_waitcnt lgkmcnt(4)
    v_mfma_f32_32x32x16_bf16 v[106:121], v[98:101], v[82:85], v[106:121]
    v_exp_f32 v34, v34
    v_exp_f32 v35, v35
    v_exp_f32 v36, v36
    v_exp_f32 v37, v37
    v_exp_f32 v38, v38
    v_exp_f32 v39, v39
    v_exp_f32 v40, v40
    v_exp_f32 v41, v41
    s_waitcnt lgkmcnt(3)
    v_mfma_f32_32x32x16_bf16 v[106:121], v[102:105], v[86:89], v[106:121]
    v_cvt_pk_bf16_f32 v74, v26, v27
    v_cvt_pk_bf16_f32 v75, v28, v29
    v_cvt_pk_bf16_f32 v76, v30, v31
    v_cvt_pk_bf16_f32 v77, v32, v33
    v_cvt_pk_bf16_f32 v78, v34, v35
    v_cvt_pk_bf16_f32 v79, v36, v37
    v_cvt_pk_bf16_f32 v80, v38, v39
    v_cvt_pk_bf16_f32 v81, v40, v41
    ds_read_b128 v[18:21], v6 offset:25088
    s_waitcnt lgkmcnt(3)
    v_mfma_f32_32x32x16_bf16 v[26:41], v[14:17], v[10:13], v[58:73]
    s_mov_b64 exec, s[20:21]
    ds_read_b128 v[98:101], v7 offset:48128
    ds_read_b128 v[102:105], v7 offset:48640
    s_mov_b64 exec, -1
    v_exp_f32 v42, v42
    v_exp_f32 v43, v43
    v_exp_f32 v44, v44
    v_exp_f32 v45, v45
    v_exp_f32 v46, v46
    v_exp_f32 v47, v47
    v_exp_f32 v48, v48
    v_exp_f32 v49, v49
    s_waitcnt lgkmcnt(4)
    v_mfma_f32_32x32x16_bf16 v[106:121], v[90:93], v[74:77], v[106:121]
    v_exp_f32 v50, v50
    v_exp_f32 v51, v51
    v_exp_f32 v52, v52
    v_exp_f32 v53, v53
    v_exp_f32 v54, v54
    v_exp_f32 v55, v55
    v_exp_f32 v56, v56
    v_exp_f32 v57, v57
    s_waitcnt lgkmcnt(3)
    v_mfma_f32_32x32x16_bf16 v[106:121], v[94:97], v[78:81], v[106:121]
    v_cvt_pk_bf16_f32 v82, v42, v43
    v_cvt_pk_bf16_f32 v83, v44, v45
    v_cvt_pk_bf16_f32 v84, v46, v47
    v_cvt_pk_bf16_f32 v85, v48, v49
    v_cvt_pk_bf16_f32 v86, v50, v51
    v_cvt_pk_bf16_f32 v87, v52, v53
    v_cvt_pk_bf16_f32 v88, v54, v55
    v_cvt_pk_bf16_f32 v89, v56, v57
    ds_read_b128 v[22:25], v6 offset:25600
    s_waitcnt lgkmcnt(3)
    v_mfma_f32_32x32x16_bf16 v[42:57], v[18:21], v[10:13], v[58:73]
    s_mov_b64 exec, s[20:21]
    ds_read_b128 v[90:93], v7 offset:49152
    ds_read_b128 v[94:97], v7 offset:49664
    s_mov_b64 exec, -1
    v_exp_f32 v26, v26
    v_exp_f32 v27, v27
    v_exp_f32 v28, v28
    v_exp_f32 v29, v29
    v_exp_f32 v30, v30
    v_exp_f32 v31, v31
    v_exp_f32 v32, v32
    v_exp_f32 v33, v33
    s_waitcnt lgkmcnt(4)
    v_mfma_f32_32x32x16_bf16 v[106:121], v[98:101], v[82:85], v[106:121]
    v_exp_f32 v34, v34
    v_exp_f32 v35, v35
    v_exp_f32 v36, v36
    v_exp_f32 v37, v37
    v_exp_f32 v38, v38
    v_exp_f32 v39, v39
    v_exp_f32 v40, v40
    v_exp_f32 v41, v41
    s_waitcnt lgkmcnt(3)
    v_mfma_f32_32x32x16_bf16 v[106:121], v[102:105], v[86:89], v[106:121]
    v_cvt_pk_bf16_f32 v74, v26, v27
    v_cvt_pk_bf16_f32 v75, v28, v29
    v_cvt_pk_bf16_f32 v76, v30, v31
    v_cvt_pk_bf16_f32 v77, v32, v33
    v_cvt_pk_bf16_f32 v78, v34, v35
    v_cvt_pk_bf16_f32 v79, v36, v37
    v_cvt_pk_bf16_f32 v80, v38, v39
    v_cvt_pk_bf16_f32 v81, v40, v41
    ds_read_b128 v[14:17], v6 offset:26112
    s_waitcnt lgkmcnt(3)
    v_mfma_f32_32x32x16_bf16 v[26:41], v[22:25], v[10:13], v[58:73]
    s_mov_b64 exec, s[20:21]
    ds_read_b128 v[98:101], v7 offset:50176
    ds_read_b128 v[102:105], v7 offset:50688
    s_mov_b64 exec, -1
    v_exp_f32 v42, v42
    v_exp_f32 v43, v43
    v_exp_f32 v44, v44
    v_exp_f32 v45, v45
    v_exp_f32 v46, v46
    v_exp_f32 v47, v47
    v_exp_f32 v48, v48
    v_exp_f32 v49, v49
    s_waitcnt lgkmcnt(4)
    v_mfma_f32_32x32x16_bf16 v[106:121], v[90:93], v[74:77], v[106:121]
    v_exp_f32 v50, v50
    v_exp_f32 v51, v51
    v_exp_f32 v52, v52
    v_exp_f32 v53, v53
    v_exp_f32 v54, v54
    v_exp_f32 v55, v55
    v_exp_f32 v56, v56
    v_exp_f32 v57, v57
    s_waitcnt lgkmcnt(3)
    v_mfma_f32_32x32x16_bf16 v[106:121], v[94:97], v[78:81], v[106:121]
    v_cvt_pk_bf16_f32 v82, v42, v43
    v_cvt_pk_bf16_f32 v83, v44, v45
    v_cvt_pk_bf16_f32 v84, v46, v47
    v_cvt_pk_bf16_f32 v85, v48, v49
    v_cvt_pk_bf16_f32 v86, v50, v51
    v_cvt_pk_bf16_f32 v87, v52, v53
    v_cvt_pk_bf16_f32 v88, v54, v55
    v_cvt_pk_bf16_f32 v89, v56, v57
    ds_read_b128 v[18:21], v6 offset:26624
    s_waitcnt lgkmcnt(3)
    v_mfma_f32_32x32x16_bf16 v[42:57], v[14:17], v[10:13], v[58:73]
    s_mov_b64 exec, s[20:21]
    ds_read_b128 v[90:93], v7 offset:51200
    ds_read_b128 v[94:97], v7 offset:51712
    s_mov_b64 exec, -1
    v_exp_f32 v26, v26
    v_exp_f32 v27, v27
    v_exp_f32 v28, v28
    v_exp_f32 v29, v29
    v_exp_f32 v30, v30
    v_exp_f32 v31, v31
    v_exp_f32 v32, v32
    v_exp_f32 v33, v33
    s_waitcnt lgkmcnt(4)
    v_mfma_f32_32x32x16_bf16 v[106:121], v[98:101], v[82:85], v[106:121]
    v_exp_f32 v34, v34
    v_exp_f32 v35, v35
    v_exp_f32 v36, v36
    v_exp_f32 v37, v37
    v_exp_f32 v38, v38
    v_exp_f32 v39, v39
    v_exp_f32 v40, v40
    v_exp_f32 v41, v41
    s_waitcnt lgkmcnt(3)
    v_mfma_f32_32x32x16_bf16 v[106:121], v[102:105], v[86:89], v[106:121]
    v_cvt_pk_bf16_f32 v74, v26, v27
    v_cvt_pk_bf16_f32 v75, v28, v29
    v_cvt_pk_bf16_f32 v76, v30, v31
    v_cvt_pk_bf16_f32 v77, v32, v33
    v_cvt_pk_bf16_f32 v78, v34, v35
    v_cvt_pk_bf16_f32 v79, v36, v37
    v_cvt_pk_bf16_f32 v80, v38, v39
    v_cvt_pk_bf16_f32 v81, v40, v41
    ds_read_b128 v[22:25], v6 offset:27136
    s_waitcnt lgkmcnt(3)
    v_mfma_f32_32x32x16_bf16 v[26:41], v[18:21], v[10:13], v[58:73]
    s_mov_b64 exec, s[20:21]
    ds_read_b128 v[98:101], v7 offset:52224
    ds_read_b128 v[102:105], v7 offset:52736
    s_mov_b64 exec, -1
    v_exp_f32 v42, v42
    v_exp_f32 v43, v43
    v_exp_f32 v44, v44
    v_exp_f32 v45, v45
    v_exp_f32 v46, v46
    v_exp_f32 v47, v47
    v_exp_f32 v48, v48
    v_exp_f32 v49, v49
    s_waitcnt lgkmcnt(4)
    v_mfma_f32_32x32x16_bf16 v[106:121], v[90:93], v[74:77], v[106:121]
    v_exp_f32 v50, v50
    v_exp_f32 v51, v51
    v_exp_f32 v52, v52
    v_exp_f32 v53, v53
    v_exp_f32 v54, v54
    v_exp_f32 v55, v55
    v_exp_f32 v56, v56
    v_exp_f32 v57, v57
    s_waitcnt lgkmcnt(3)
    v_mfma_f32_32x32x16_bf16 v[106:121], v[94:97], v[78:81], v[106:121]
    v_cvt_pk_bf16_f32 v82, v42, v43
    v_cvt_pk_bf16_f32 v83, v44, v45
    v_cvt_pk_bf16_f32 v84, v46, v47
    v_cvt_pk_bf16_f32 v85, v48, v49
    v_cvt_pk_bf16_f32 v86, v50, v51
    v_cvt_pk_bf16_f32 v87, v52, v53
    v_cvt_pk_bf16_f32 v88, v54, v55
    v_cvt_pk_bf16_f32 v89, v56, v57
    ds_read_b128 v[14:17], v6 offset:27648
    s_waitcnt lgkmcnt(3)
    v_mfma_f32_32x32x16_bf16 v[42:57], v[22:25], v[10:13], v[58:73]
    s_mov_b64 exec, s[20:21]
    ds_read_b128 v[90:93], v7 offset:53248
    ds_read_b128 v[94:97], v7 offset:53760
    s_mov_b64 exec, -1
    v_exp_f32 v26, v26
    v_exp_f32 v27, v27
    v_exp_f32 v28, v28
    v_exp_f32 v29, v29
    v_exp_f32 v30, v30
    v_exp_f32 v31, v31
    v_exp_f32 v32, v32
    v_exp_f32 v33, v33
    s_waitcnt lgkmcnt(4)
    v_mfma_f32_32x32x16_bf16 v[106:121], v[98:101], v[82:85], v[106:121]
    v_exp_f32 v34, v34
    v_exp_f32 v35, v35
    v_exp_f32 v36, v36
    v_exp_f32 v37, v37
    v_exp_f32 v38, v38
    v_exp_f32 v39, v39
    v_exp_f32 v40, v40
    v_exp_f32 v41, v41
    s_waitcnt lgkmcnt(3)
    v_mfma_f32_32x32x16_bf16 v[106:121], v[102:105], v[86:89], v[106:121]
    v_cvt_pk_bf16_f32 v74, v26, v27
    v_cvt_pk_bf16_f32 v75, v28, v29
    v_cvt_pk_bf16_f32 v76, v30, v31
    v_cvt_pk_bf16_f32 v77, v32, v33
    v_cvt_pk_bf16_f32 v78, v34, v35
    v_cvt_pk_bf16_f32 v79, v36, v37
    v_cvt_pk_bf16_f32 v80, v38, v39
    v_cvt_pk_bf16_f32 v81, v40, v41
    ds_read_b128 v[18:21], v6 offset:28160
    s_waitcnt lgkmcnt(3)
    v_mfma_f32_32x32x16_bf16 v[26:41], v[14:17], v[10:13], v[58:73]
    s_mov_b64 exec, s[20:21]
    ds_read_b128 v[98:101], v7 offset:54272
    ds_read_b128 v[102:105], v7 offset:54784
    s_mov_b64 exec, -1
    v_exp_f32 v42, v42
    v_exp_f32 v43, v43
    v_exp_f32 v44, v44
    v_exp_f32 v45, v45
    v_exp_f32 v46, v46
    v_exp_f32 v47, v47
    v_exp_f32 v48, v48
    v_exp_f32 v49, v49
    s_waitcnt lgkmcnt(4)
    v_mfma_f32_32x32x16_bf16 v[106:121], v[90:93], v[74:77], v[106:121]
    v_exp_f32 v50, v50
    v_exp_f32 v51, v51
    v_exp_f32 v52, v52
    v_exp_f32 v53, v53
    v_exp_f32 v54, v54
    v_exp_f32 v55, v55
    v_exp_f32 v56, v56
    v_exp_f32 v57, v57
    s_waitcnt lgkmcnt(3)
    v_mfma_f32_32x32x16_bf16 v[106:121], v[94:97], v[78:81], v[106:121]
    v_cvt_pk_bf16_f32 v82, v42, v43
    v_cvt_pk_bf16_f32 v83, v44, v45
    v_cvt_pk_bf16_f32 v84, v46, v47
    v_cvt_pk_bf16_f32 v85, v48, v49
    v_cvt_pk_bf16_f32 v86, v50, v51
    v_cvt_pk_bf16_f32 v87, v52, v53
    v_cvt_pk_bf16_f32 v88, v54, v55
    v_cvt_pk_bf16_f32 v89, v56, v57
    ds_read_b128 v[22:25], v6 offset:28672
    s_waitcnt lgkmcnt(3)
    v_mfma_f32_32x32x16_bf16 v[42:57], v[18:21], v[10:13], v[58:73]
    s_mov_b64 exec, s[20:21]
    ds_read_b128 v[90:93], v7 offset:55296
    ds_read_b128 v[94:97], v7 offset:55808
    s_mov_b64 exec, -1
    v_exp_f32 v26, v26
    v_exp_f32 v27, v27
    v_exp_f32 v28, v28
    v_exp_f32 v29, v29
    v_exp_f32 v30, v30
    v_exp_f32 v31, v31
    v_exp_f32 v32, v32
    v_exp_f32 v33, v33
    s_waitcnt lgkmcnt(4)
    v_mfma_f32_32x32x16_bf16 v[106:121], v[98:101], v[82:85], v[106:121]
    v_exp_f32 v34, v34
    v_exp_f32 v35, v35
    v_exp_f32 v36, v36
    v_exp_f32 v37, v37
    v_exp_f32 v38, v38
    v_exp_f32 v39, v39
    v_exp_f32 v40, v40
    v_exp_f32 v41, v41
    s_waitcnt lgkmcnt(3)
    v_mfma_f32_32x32x16_bf16 v[106:121], v[102:105], v[86:89], v[106:121]
    v_cvt_pk_bf16_f32 v74, v26, v27
    v_cvt_pk_bf16_f32 v75, v28, v29
    v_cvt_pk_bf16_f32 v76, v30, v31
    v_cvt_pk_bf16_f32 v77, v32, v33
    v_cvt_pk_bf16_f32 v78, v34, v35
    v_cvt_pk_bf16_f32 v79, v36, v37
    v_cvt_pk_bf16_f32 v80, v38, v39
    v_cvt_pk_bf16_f32 v81, v40, v41
    ds_read_b128 v[14:17], v6 offset:29184
    s_waitcnt lgkmcnt(3)
    v_mfma_f32_32x32x16_bf16 v[26:41], v[22:25], v[10:13], v[58:73]
    s_mov_b64 exec, s[20:21]
    ds_read_b128 v[98:101], v7 offset:56320
    ds_read_b128 v[102:105], v7 offset:56832
    s_mov_b64 exec, -1
    v_exp_f32 v42, v42
    v_exp_f32 v43, v43
    v_exp_f32 v44, v44
    v_exp_f32 v45, v45
    v_exp_f32 v46, v46
    v_exp_f32 v47, v47
    v_exp_f32 v48, v48
    v_exp_f32 v49, v49
    s_waitcnt lgkmcnt(4)
    v_mfma_f32_32x32x16_bf16 v[106:121], v[90:93], v[74:77], v[106:121]
    v_exp_f32 v50, v50
    v_exp_f32 v51, v51
    v_exp_f32 v52, v52
    v_exp_f32 v53, v53
    v_exp_f32 v54, v54
    v_exp_f32 v55, v55
    v_exp_f32 v56, v56
    v_exp_f32 v57, v57
    s_waitcnt lgkmcnt(3)
    v_mfma_f32_32x32x16_bf16 v[106:121], v[94:97], v[78:81], v[106:121]
    v_cvt_pk_bf16_f32 v82, v42, v43
    v_cvt_pk_bf16_f32 v83, v44, v45
    v_cvt_pk_bf16_f32 v84, v46, v47
    v_cvt_pk_bf16_f32 v85, v48, v49
    v_cvt_pk_bf16_f32 v86, v50, v51
    v_cvt_pk_bf16_f32 v87, v52, v53
    v_cvt_pk_bf16_f32 v88, v54, v55
    v_cvt_pk_bf16_f32 v89, v56, v57
    ds_read_b128 v[18:21], v6 offset:29696
    s_waitcnt lgkmcnt(3)
    v_mfma_f32_32x32x16_bf16 v[42:57], v[14:17], v[10:13], v[58:73]
    s_mov_b64 exec, s[20:21]
    ds_read_b128 v[90:93], v7 offset:57344
    ds_read_b128 v[94:97], v7 offset:57856
    s_mov_b64 exec, -1
    v_exp_f32 v26, v26
    v_exp_f32 v27, v27
    v_exp_f32 v28, v28
    v_exp_f32 v29, v29
    v_exp_f32 v30, v30
    v_exp_f32 v31, v31
    v_exp_f32 v32, v32
    v_exp_f32 v33, v33
    s_waitcnt lgkmcnt(4)
    v_mfma_f32_32x32x16_bf16 v[106:121], v[98:101], v[82:85], v[106:121]
    v_exp_f32 v34, v34
    v_exp_f32 v35, v35
    v_exp_f32 v36, v36
    v_exp_f32 v37, v37
    v_exp_f32 v38, v38
    v_exp_f32 v39, v39
    v_exp_f32 v40, v40
    v_exp_f32 v41, v41
    s_waitcnt lgkmcnt(3)
    v_mfma_f32_32x32x16_bf16 v[106:121], v[102:105], v[86:89], v[106:121]
    v_cvt_pk_bf16_f32 v74, v26, v27
    v_cvt_pk_bf16_f32 v75, v28, v29
    v_cvt_pk_bf16_f32 v76, v30, v31
    v_cvt_pk_bf16_f32 v77, v32, v33
    v_cvt_pk_bf16_f32 v78, v34, v35
    v_cvt_pk_bf16_f32 v79, v36, v37
    v_cvt_pk_bf16_f32 v80, v38, v39
    v_cvt_pk_bf16_f32 v81, v40, v41
    ds_read_b128 v[22:25], v6 offset:30208
    s_waitcnt lgkmcnt(3)
    v_mfma_f32_32x32x16_bf16 v[26:41], v[18:21], v[10:13], v[58:73]
    s_mov_b64 exec, s[20:21]
    ds_read_b128 v[98:101], v7 offset:58368
    ds_read_b128 v[102:105], v7 offset:58880
    s_mov_b64 exec, -1
    v_exp_f32 v42, v42
    v_exp_f32 v43, v43
    v_exp_f32 v44, v44
    v_exp_f32 v45, v45
    v_exp_f32 v46, v46
    v_exp_f32 v47, v47
    v_exp_f32 v48, v48
    v_exp_f32 v49, v49
    s_waitcnt lgkmcnt(4)
    v_mfma_f32_32x32x16_bf16 v[106:121], v[90:93], v[74:77], v[106:121]
    v_exp_f32 v50, v50
    v_exp_f32 v51, v51
    v_exp_f32 v52, v52
    v_exp_f32 v53, v53
    v_exp_f32 v54, v54
    v_exp_f32 v55, v55
    v_exp_f32 v56, v56
    v_exp_f32 v57, v57
    s_waitcnt lgkmcnt(3)
    v_mfma_f32_32x32x16_bf16 v[106:121], v[94:97], v[78:81], v[106:121]
    v_cvt_pk_bf16_f32 v82, v42, v43
    v_cvt_pk_bf16_f32 v83, v44, v45
    v_cvt_pk_bf16_f32 v84, v46, v47
    v_cvt_pk_bf16_f32 v85, v48, v49
    v_cvt_pk_bf16_f32 v86, v50, v51
    v_cvt_pk_bf16_f32 v87, v52, v53
    v_cvt_pk_bf16_f32 v88, v54, v55
    v_cvt_pk_bf16_f32 v89, v56, v57
    ds_read_b128 v[14:17], v6 offset:30720
    s_waitcnt lgkmcnt(3)
    v_mfma_f32_32x32x16_bf16 v[42:57], v[22:25], v[10:13], v[58:73]
    s_mov_b64 exec, s[20:21]
    ds_read_b128 v[90:93], v7 offset:59392
    ds_read_b128 v[94:97], v7 offset:59904
    s_mov_b64 exec, -1
    v_exp_f32 v26, v26
    v_exp_f32 v27, v27
    v_exp_f32 v28, v28
    v_exp_f32 v29, v29
    v_exp_f32 v30, v30
    v_exp_f32 v31, v31
    v_exp_f32 v32, v32
    v_exp_f32 v33, v33
    s_waitcnt lgkmcnt(4)
    v_mfma_f32_32x32x16_bf16 v[106:121], v[98:101], v[82:85], v[106:121]
    v_exp_f32 v34, v34
    v_exp_f32 v35, v35
    v_exp_f32 v36, v36
    v_exp_f32 v37, v37
    v_exp_f32 v38, v38
    v_exp_f32 v39, v39
    v_exp_f32 v40, v40
    v_exp_f32 v41, v41
    s_waitcnt lgkmcnt(3)
    v_mfma_f32_32x32x16_bf16 v[106:121], v[102:105], v[86:89], v[106:121]
    v_cvt_pk_bf16_f32 v74, v26, v27
    v_cvt_pk_bf16_f32 v75, v28, v29
    v_cvt_pk_bf16_f32 v76, v30, v31
    v_cvt_pk_bf16_f32 v77, v32, v33
    v_cvt_pk_bf16_f32 v78, v34, v35
    v_cvt_pk_bf16_f32 v79, v36, v37
    v_cvt_pk_bf16_f32 v80, v38, v39
    v_cvt_pk_bf16_f32 v81, v40, v41
    ds_read_b128 v[18:21], v6 offset:31232
    s_waitcnt lgkmcnt(3)
    v_mfma_f32_32x32x16_bf16 v[26:41], v[14:17], v[10:13], v[58:73]
    s_mov_b64 exec, s[20:21]
    ds_read_b128 v[98:101], v7 offset:60416
    ds_read_b128 v[102:105], v7 offset:60928
    s_mov_b64 exec, -1
    v_exp_f32 v42, v42
    v_exp_f32 v43, v43
    v_exp_f32 v44, v44
    v_exp_f32 v45, v45
    v_exp_f32 v46, v46
    v_exp_f32 v47, v47
    v_exp_f32 v48, v48
    v_exp_f32 v49, v49
    s_waitcnt lgkmcnt(4)
    v_mfma_f32_32x32x16_bf16 v[106:121], v[90:93], v[74:77], v[106:121]
    v_exp_f32 v50, v50
    v_exp_f32 v51, v51
    v_exp_f32 v52, v52
    v_exp_f32 v53, v53
    v_exp_f32 v54, v54
    v_exp_f32 v55, v55
    v_exp_f32 v56, v56
    v_exp_f32 v57, v57
    s_waitcnt lgkmcnt(3)
    v_mfma_f32_32x32x16_bf16 v[106:121], v[94:97], v[78:81], v[106:121]
    v_cvt_pk_bf16_f32 v82, v42, v43
    v_cvt_pk_bf16_f32 v83, v44, v45
    v_cvt_pk_bf16_f32 v84, v46, v47
    v_cvt_pk_bf16_f32 v85, v48, v49
    v_cvt_pk_bf16_f32 v86, v50, v51
    v_cvt_pk_bf16_f32 v87, v52, v53
    v_cvt_pk_bf16_f32 v88, v54, v55
    v_cvt_pk_bf16_f32 v89, v56, v57
    ds_read_b128 v[22:25], v6 offset:31744
    s_waitcnt lgkmcnt(3)
    v_mfma_f32_32x32x16_bf16 v[42:57], v[18:21], v[10:13], v[58:73]
    s_mov_b64 exec, s[20:21]
    ds_read_b128 v[90:93], v7 offset:61440
    ds_read_b128 v[94:97], v7 offset:61952
    s_mov_b64 exec, -1
    v_exp_f32 v26, v26
    v_exp_f32 v27, v27
    v_exp_f32 v28, v28
    v_exp_f32 v29, v29
    v_exp_f32 v30, v30
    v_exp_f32 v31, v31
    v_exp_f32 v32, v32
    v_exp_f32 v33, v33
    s_waitcnt lgkmcnt(4)
    v_mfma_f32_32x32x16_bf16 v[106:121], v[98:101], v[82:85], v[106:121]
    v_exp_f32 v34, v34
    v_exp_f32 v35, v35
    v_exp_f32 v36, v36
    v_exp_f32 v37, v37
    v_exp_f32 v38, v38
    v_exp_f32 v39, v39
    v_exp_f32 v40, v40
    v_exp_f32 v41, v41
    s_waitcnt lgkmcnt(3)
    v_mfma_f32_32x32x16_bf16 v[106:121], v[102:105], v[86:89], v[106:121]
    v_cvt_pk_bf16_f32 v74, v26, v27
    v_cvt_pk_bf16_f32 v75, v28, v29
    v_cvt_pk_bf16_f32 v76, v30, v31
    v_cvt_pk_bf16_f32 v77, v32, v33
    v_cvt_pk_bf16_f32 v78, v34, v35
    v_cvt_pk_bf16_f32 v79, v36, v37
    v_cvt_pk_bf16_f32 v80, v38, v39
    v_cvt_pk_bf16_f32 v81, v40, v41
    ds_read_b128 v[14:17], v6 offset:32256
    s_waitcnt lgkmcnt(3)
    v_mfma_f32_32x32x16_bf16 v[26:41], v[22:25], v[10:13], v[58:73]
    s_mov_b64 exec, s[20:21]
    ds_read_b128 v[98:101], v7 offset:62464
    ds_read_b128 v[102:105], v7 offset:62976
    s_mov_b64 exec, -1
    v_exp_f32 v42, v42
    v_exp_f32 v43, v43
    v_exp_f32 v44, v44
    v_exp_f32 v45, v45
    v_exp_f32 v46, v46
    v_exp_f32 v47, v47
    v_exp_f32 v48, v48
    v_exp_f32 v49, v49
    s_waitcnt lgkmcnt(4)
    v_mfma_f32_32x32x16_bf16 v[106:121], v[90:93], v[74:77], v[106:121]
    v_exp_f32 v50, v50
    v_exp_f32 v51, v51
    v_exp_f32 v52, v52
    v_exp_f32 v53, v53
    v_exp_f32 v54, v54
    v_exp_f32 v55, v55
    v_exp_f32 v56, v56
    v_exp_f32 v57, v57
    s_waitcnt lgkmcnt(3)
    v_mfma_f32_32x32x16_bf16 v[106:121], v[94:97], v[78:81], v[106:121]
    v_cvt_pk_bf16_f32 v82, v42, v43
    v_cvt_pk_bf16_f32 v83, v44, v45
    v_cvt_pk_bf16_f32 v84, v46, v47
    v_cvt_pk_bf16_f32 v85, v48, v49
    v_cvt_pk_bf16_f32 v86, v50, v51
    v_cvt_pk_bf16_f32 v87, v52, v53
    v_cvt_pk_bf16_f32 v88, v54, v55
    v_cvt_pk_bf16_f32 v89, v56, v57
    s_waitcnt lgkmcnt(2)
    v_mfma_f32_32x32x16_bf16 v[42:57], v[14:17], v[10:13], v[58:73]
    s_mov_b64 exec, s[20:21]
    ds_read_b128 v[90:93], v7 offset:63488
    ds_read_b128 v[94:97], v7 offset:64000
    s_mov_b64 exec, -1
    v_exp_f32 v26, v26
    v_exp_f32 v27, v27
    v_exp_f32 v28, v28
    v_exp_f32 v29, v29
    v_exp_f32 v30, v30
    v_exp_f32 v31, v31
    v_exp_f32 v32, v32
    v_exp_f32 v33, v33
    s_waitcnt lgkmcnt(3)
    v_mfma_f32_32x32x16_bf16 v[106:121], v[98:101], v[82:85], v[106:121]
    v_exp_f32 v34, v34
    v_exp_f32 v35, v35
    v_exp_f32 v36, v36
    v_exp_f32 v37, v37
    v_exp_f32 v38, v38
    v_exp_f32 v39, v39
    v_exp_f32 v40, v40
    v_exp_f32 v41, v41
    s_waitcnt lgkmcnt(2)
    v_mfma_f32_32x32x16_bf16 v[106:121], v[102:105], v[86:89], v[106:121]
    v_cvt_pk_bf16_f32 v74, v26, v27
    v_cvt_pk_bf16_f32 v75, v28, v29
    v_cvt_pk_bf16_f32 v76, v30, v31
    v_cvt_pk_bf16_f32 v77, v32, v33
    v_cvt_pk_bf16_f32 v78, v34, v35
    v_cvt_pk_bf16_f32 v79, v36, v37
    v_cvt_pk_bf16_f32 v80, v38, v39
    v_cvt_pk_bf16_f32 v81, v40, v41
    s_mov_b64 exec, s[20:21]
    ds_read_b128 v[98:101], v7 offset:64512
    ds_read_b128 v[102:105], v7 offset:65024
    s_mov_b64 exec, -1
    v_exp_f32 v42, v42
    v_exp_f32 v43, v43
    v_exp_f32 v44, v44
    v_exp_f32 v45, v45
    v_exp_f32 v46, v46
    v_exp_f32 v47, v47
    v_exp_f32 v48, v48
    v_exp_f32 v49, v49
    s_waitcnt lgkmcnt(3)
    v_mfma_f32_32x32x16_bf16 v[106:121], v[90:93], v[74:77], v[106:121]
    v_exp_f32 v50, v50
    v_exp_f32 v51, v51
    v_exp_f32 v52, v52
    v_exp_f32 v53, v53
    v_exp_f32 v54, v54
    v_exp_f32 v55, v55
    v_exp_f32 v56, v56
    v_exp_f32 v57, v57
    s_waitcnt lgkmcnt(2)
    v_mfma_f32_32x32x16_bf16 v[106:121], v[94:97], v[78:81], v[106:121]
    v_cvt_pk_bf16_f32 v82, v42, v43
    v_cvt_pk_bf16_f32 v83, v44, v45
    v_cvt_pk_bf16_f32 v84, v46, v47
    v_cvt_pk_bf16_f32 v85, v48, v49
    v_cvt_pk_bf16_f32 v86, v50, v51
    v_cvt_pk_bf16_f32 v87, v52, v53
    v_cvt_pk_bf16_f32 v88, v54, v55
    v_cvt_pk_bf16_f32 v89, v56, v57
    s_waitcnt lgkmcnt(1)
    v_mfma_f32_32x32x16_bf16 v[106:121], v[98:101], v[82:85], v[106:121]
    s_waitcnt lgkmcnt(0)
    v_mfma_f32_32x32x16_bf16 v[106:121], v[102:105], v[86:89], v[106:121]
L_a_done:
    s_nop 11
    v_rcp_f32 v2, v114
    s_nop 0
    v_mul_f32 v106, v106, v2
    v_mul_f32 v107, v107, v2
    v_mul_f32 v108, v108, v2
    v_mul_f32 v109, v109, v2
    v_mul_f32 v110, v110, v2
    v_mul_f32 v111, v111, v2
    v_mul_f32 v112, v112, v2
    v_mul_f32 v113, v113, v2
    v_cvt_pk_bf16_f32 v74, v106, v107
    v_cvt_pk_bf16_f32 v75, v108, v109
    v_cvt_pk_bf16_f32 v76, v110, v111
    v_cvt_pk_bf16_f32 v77, v112, v113
    v_and_b32 v2, 31, v1
    v_lshrrev_b32 v3, 5, v1
    v_lshlrev_b32 v2, 10, v2
    v_lshl_add_u32 v2, v3, 3, v2
    s_lshl_b32 s15, s14, 10
    s_lshl_b32 s16, s13, 5
    s_add_u32 s15, s15, s16
    s_add_u32 s15, s15, 6291456
    buffer_store_dwordx2 v[74:75], v2, s[8:11], s15 offen
    buffer_store_dwordx2 v[76:77], v2, s[8:11], s15 offen offset:16
    s_endpgm
L_a_conv:
    s_sub_u32 s12, s12, 8
    s_barrier
    s_load_dwordx2 s[40:41], s[0:1], 96
    s_load_dwordx2 s[42:43], s[0:1], 32
    s_load_dwordx2 s[44:45], s[0:1], 40
    v_and_b32 v1, 63, v0
    v_lshlrev_b32 v2, 4, v1
    s_lshr_b32 s60, s12, 1
    s_and_b32 s61, s12, 1
    s_lshl_b32 s62, s2, 1
    s_add_u32 s62, s62, s60
    s_waitcnt lgkmcnt(0)
    s_mov_b32 s48, s40
    s_and_b32 s49, s41, 0xffff
    s_mov_b32 s50, 13631488
    s_mov_b32 s51, 0x00020000
    s_mov_b32 s52, s42
    s_and_b32 s53, s43, 0xffff
    s_mov_b32 s54, 2097152
    s_mov_b32 s55, 0x00020000
    s_mov_b32 s56, s44
    s_and_b32 s57, s45, 0xffff
    s_mov_b32 s58, 1024
    s_mov_b32 s59, 0x00020000
    s_lshl_b32 s63, s62, 1
    v_mov_b32 v3, s63
    buffer_load_ushort v8, v3, s[56:59], 0 offen
    s_lshl_b32 s63, s62, 12
    s_cmp_eq_u32 s61, 1
    s_cbranch_scc1 L_cv_tables
    s_add_u32 s64, s63, 8388608
    buffer_load_dwordx4 v[28:31], v2, s[48:51], s64 offen offset:0
    buffer_load_dwordx4 v[32:35], v2, s[48:51], s64 offen offset:1024
    buffer_load_dwordx4 v[36:39], v2, s[48:51], s64 offen offset:2048
    buffer_load_dwordx4 v[40:43], v2, s[48:51], s64 offen offset:3072
    s_waitcnt vmcnt(0)
    s_cmp_eq_u32 s60, 1
    s_cbranch_scc1 L_cv_x1
    v_mov_b32 v12, 0
    v_mov_b32 v13, 0
    v_mov_b32 v14, 0
    v_mov_b32 v15, 0
    v_add_u32 v3, 135680, v2
    ds_write_b128 v3, v[12:15] offset:0
    ds_write_b128 v3, v[12:15] offset:1024
    ds_write_b128 v3, v[12:15] offset:2048
    ds_write_b128 v3, v[12:15] offset:3072
    s_mov_b32 exec_hi, 0
    s_mov_b32 exec_lo, 0x7fffff
    ds_write_b128 v3, v[12:15] offset:4096
    s_mov_b64 exec, -1
    v_lshrrev_b32 v4, 3, v1
    v_mul_u32_u24 v4, 144, v4
    v_and_b32 v5, 7, v1
    v_lshl_add_u32 v4, v5, 4, v4
    v_add_u32 v4, 140144, v4
    ds_write_b128 v4, v[28:31] offset:0
    ds_write_b128 v4, v[32:35] offset:1152
    ds_write_b128 v4, v[36:39] offset:2304
    ds_write_b128 v4, v[40:43] offset:3456
    s_branch L_cv_built
L_cv_x1:
    v_lshrrev_b32 v4, 3, v1
    v_mul_u32_u24 v4, 144, v4
    v_and_b32 v5, 7, v1
    v_lshlrev_b32 v5, 4, v5
    v_sub_u32 v4, v5, v4
    v_add_u32 v4, 131072, v4
    ds_write_b128 v4, v[28:31] offset:4464
    ds_write_b128 v4, v[32:35] offset:3312
    ds_write_b128 v4, v[36:39] offset:2160
    ds_write_b128 v4, v[40:43] offset:1008
    s_branch L_cv_built
L_cv_tables:
    buffer_load_dwordx4 v[28:31], v2, s[52:55], s63 offen offset:0
    buffer_load_dwordx4 v[32:35], v2, s[52:55], s63 offen offset:1024
    buffer_load_dwordx4 v[36:39], v2, s[52:55], s63 offen offset:2048
    buffer_load_dwordx4 v[40:43], v2, s[52:55], s63 offen offset:3072
    s_mul_i32 s64, s60, 8576
    s_add_u32 s64, s64, 144896
    v_mov_b32 v12, 0
    v_mov_b32 v13, 0
    v_mov_b32 v14, 0
    v_mov_b32 v15, 0
    v_add_u32 v3, s64, v2
    s_mov_b64 exec, 0xff
    ds_write_b128 v3, v[12:15] offset:4096
    s_mov_b64 exec, -1
    v_sub_u32 v4, s64, v2
    s_waitcnt vmcnt(3)
    v_alignbit_b32 v16, v31, v31, 16
    v_alignbit_b32 v17, v30, v30, 16
    v_alignbit_b32 v18, v29, v29, 16
    v_alignbit_b32 v19, v28, v28, 16
    s_waitcnt lgkmcnt(12)
    ds_write_b128 v4, v[16:19] offset:4080
    s_waitcnt vmcnt(2)
    s_nop 0
    v_alignbit_b32 v16, v35, v35, 16
    v_alignbit_b32 v17, v34, v34, 16
    v_alignbit_b32 v18, v33, v33, 16
    v_alignbit_b32 v19, v32, v32, 16
    ds_write_b128 v4, v[16:19] offset:3056
    s_waitcnt vmcnt(1)
    s_nop 0
    v_alignbit_b32 v16, v39, v39, 16
    v_alignbit_b32 v17, v38, v38, 16
    v_alignbit_b32 v18, v37, v37, 16
    v_alignbit_b32 v19, v36, v36, 16
    s_waitcnt lgkmcnt(12)
    ds_write_b128 v4, v[16:19] offset:2032
    s_waitcnt vmcnt(0)
    s_nop 0
    v_alignbit_b32 v16, v43, v43, 16
    v_alignbit_b32 v17, v42, v42, 16
    v_alignbit_b32 v18, v41, v41, 16
    v_alignbit_b32 v19, v40, v40, 16
    ds_write_b128 v4, v[16:19] offset:1008
    s_waitcnt lgkmcnt(12)
    ds_read_b128 v[28:31], v3 offset:0
    ds_read_b32 v36, v3 offset:16
    s_waitcnt lgkmcnt(1)
    v_alignbit_b32 v16, v29, v28, 16
    v_alignbit_b32 v17, v30, v29, 16
    v_alignbit_b32 v18, v31, v30, 16
    s_waitcnt lgkmcnt(0)
    v_alignbit_b32 v19, v36, v31, 16
    ds_write_b128 v3, v[16:19] offset:4288
    ds_read_b128 v[32:35], v3 offset:1024
    ds_read_b32 v37, v3 offset:1040
    s_waitcnt lgkmcnt(1)
    v_alignbit_b32 v16, v33, v32, 16
    v_alignbit_b32 v17, v34, v33, 16
    v_alignbit_b32 v18, v35, v34, 16
    s_waitcnt lgkmcnt(0)
    v_alignbit_b32 v19, v37, v35, 16
    ds_write_b128 v3, v[16:19] offset:5312
    ds_read_b128 v[28:31], v3 offset:2048
    ds_read_b32 v36, v3 offset:2064
    s_waitcnt lgkmcnt(1)
    v_alignbit_b32 v16, v29, v28, 16
    v_alignbit_b32 v17, v30, v29, 16
    v_alignbit_b32 v18, v31, v30, 16
    s_waitcnt lgkmcnt(0)
    v_alignbit_b32 v19, v36, v31, 16
    ds_write_b128 v3, v[16:19] offset:6336
    ds_read_b128 v[32:35], v3 offset:3072
    ds_read_b32 v37, v3 offset:3088
    s_waitcnt lgkmcnt(1)
    v_alignbit_b32 v16, v33, v32, 16
    v_alignbit_b32 v17, v34, v33, 16
    v_alignbit_b32 v18, v35, v34, 16
    s_waitcnt lgkmcnt(0)
    v_alignbit_b32 v19, v37, v35, 16
    ds_write_b128 v3, v[16:19] offset:7360
    s_mov_b64 exec, 0xff
    ds_read_b128 v[28:31], v3 offset:4096
    ds_read_b32 v36, v3 offset:4112
    s_waitcnt lgkmcnt(1)
    v_alignbit_b32 v16, v29, v28, 16
    v_alignbit_b32 v17, v30, v29, 16
    v_alignbit_b32 v18, v31, v30, 16
    s_waitcnt lgkmcnt(0)
    v_alignbit_b32 v19, v36, v31, 16
    ds_write_b128 v3, v[16:19] offset:8384
    s_mov_b64 exec, -1
L_cv_built:
    s_waitcnt vmcnt(0) lgkmcnt(0)
    s_barrier
    v_and_b32 v10, 31, v1
    v_lshrrev_b32 v9, 5, v1
    v_mul_u32_u24 v3, 144, v10
    s_mul_i32 s64, s60, 8576
    s_add_u32 s64, s64, 144896
    v_and_b32 v5, 1, v10
    v_mul_u32_u24 v5, 4288, v5
    v_sub_u32 v7, 8380, v5
    v_and_b32 v5, 30, v10
    v_lshlrev_b32 v5, 1, v5
    v_sub_u32 v7, v7, v5
    v_lshl_add_u32 v7, v9, 4, v7
    v_add_u32 v7, s64, v7
    s_lshl_b32 s63, s61, 6
    v_subrev_u32 v7, s63, v7
    v_lshlrev_b32 v8, 16, v8
    s_cmp_eq_u32 s60, 1
    s_cbranch_scc1 L_cv_var1
    v_lshl_add_u32 v6, v9, 4, v3
    v_add_u32 v6, 135680, v6
    ds_read2_b32 v[44:45], v7 offset0:0 offset1:1
    ds_read2_b32 v[46:47], v7 offset0:2 offset1:3
    ds_read_b128 v[76:79], v6 offset:4464
    ds_read2_b32 v[48:49], v7 offset0:8 offset1:9
    ds_read2_b32 v[50:51], v7 offset0:10 offset1:11
    ds_read_b128 v[80:83], v6 offset:4496
    ds_read2_b32 v[52:53], v7 offset0:16 offset1:17
    ds_read2_b32 v[54:55], v7 offset0:18 offset1:19
    ds_read_b128 v[84:87], v6 offset:4528
    ds_read2_b32 v[56:57], v7 offset0:24 offset1:25
    ds_read2_b32 v[58:59], v7 offset0:26 offset1:27
    ds_read_b128 v[88:91], v6 offset:4560
    v_subrev_u32 v7, 128, v7
    ds_read_b128 v[92:95], v6 offset:4320
    ds_read2_b32 v[60:61], v7 offset0:0 offset1:1
    s_waitcnt lgkmcnt(12)
    ds_read2_b32 v[62:63], v7 offset0:2 offset1:3
    s_waitcnt lgkmcnt(12)
    v_mfma_f32_32x32x16_bf16 v[12:27], v[76:79], v[44:47], 0
    ds_read_b128 v[96:99], v6 offset:4352
    ds_read2_b32 v[64:65], v7 offset0:8 offset1:9
    s_waitcnt lgkmcnt(12)
    ds_read2_b32 v[66:67], v7 offset0:10 offset1:11
    s_waitcnt lgkmcnt(12)
    v_mfma_f32_32x32x16_bf16 v[12:27], v[80:83], v[48:51], v[12:27]
    ds_read_b128 v[100:103], v6 offset:4384
    ds_read2_b32 v[68:69], v7 offset0:16 offset1:17
    s_waitcnt lgkmcnt(12)
    ds_read2_b32 v[70:71], v7 offset0:18 offset1:19
    s_waitcnt lgkmcnt(12)
    v_mfma_f32_32x32x16_bf16 v[12:27], v[84:87], v[52:55], v[12:27]
    ds_read_b128 v[104:107], v6 offset:4416
    ds_read2_b32 v[72:73], v7 offset0:24 offset1:25
    s_waitcnt lgkmcnt(12)
    ds_read2_b32 v[74:75], v7 offset0:26 offset1:27
    s_waitcnt lgkmcnt(12)
    v_mfma_f32_32x32x16_bf16 v[12:27], v[88:91], v[56:59], v[12:27]
    v_subrev_u32 v7, 128, v7
    ds_read_b128 v[76:79], v6 offset:4176
    ds_read2_b32 v[44:45], v7 offset0:0 offset1:1
    s_waitcnt lgkmcnt(12)
    ds_read2_b32 v[46:47], v7 offset0:2 offset1:3
    s_waitcnt lgkmcnt(12)
    v_mfma_f32_32x32x16_bf16 v[12:27], v[92:95], v[60:63], v[12:27]
    ds_read_b128 v[80:83], v6 offset:4208
    ds_read2_b32 v[48:49], v7 offset0:8 offset1:9
    s_waitcnt lgkmcnt(12)
    ds_read2_b32 v[50:51], v7 offset0:10 offset1:11
    s_waitcnt lgkmcnt(12)
    v_mfma_f32_32x32x16_bf16 v[12:27], v[96:99], v[64:67], v[12:27]
    ds_read_b128 v[84:87], v6 offset:4240
    ds_read2_b32 v[52:53], v7 offset0:16 offset1:17
    s_waitcnt lgkmcnt(12)
    ds_read2_b32 v[54:55], v7 offset0:18 offset1:19
    s_waitcnt lgkmcnt(12)
    v_mfma_f32_32x32x16_bf16 v[12:27], v[100:103], v[68:71], v[12:27]
    ds_read_b128 v[88:91], v6 offset:4272
    ds_read2_b32 v[56:57], v7 offset0:24 offset1:25
    s_waitcnt lgkmcnt(12)
    ds_read2_b32 v[58:59], v7 offset0:26 offset1:27
    s_waitcnt lgkmcnt(12)
    v_mfma_f32_32x32x16_bf16 v[12:27], v[104:107], v[72:75], v[12:27]
    v_subrev_u32 v7, 128, v7
    ds_read_b128 v[92:95], v6 offset:4032
    ds_read2_b32 v[60:61], v7 offset0:0 offset1:1
    s_waitcnt lgkmcnt(12)
    ds_read2_b32 v[62:63], v7 offset0:2 offset1:3
    s_waitcnt lgkmcnt(12)
    v_mfma_f32_32x32x16_bf16 v[12:27], v[76:79], v[44:47], v[12:27]
    ds_read_b128 v[96:99], v6 offset:4064
    ds_read2_b32 v[64:65], v7 offset0:8 offset1:9
    s_waitcnt lgkmcnt(12)
    ds_read2_b32 v[66:67], v7 offset0:10 offset1:11
    s_waitcnt lgkmcnt(12)
    v_mfma_f32_32x32x16_bf16 v[12:27], v[80:83], v[48:51], v[12:27]
    ds_read_b128 v[100:103], v6 offset:4096
    ds_read2_b32 v[68:69], v7 offset0:16 offset1:17
    s_waitcnt lgkmcnt(12)
    ds_read2_b32 v[70:71], v7 offset0:18 offset1:19
    s_waitcnt lgkmcnt(12)
    v_mfma_f32_32x32x16_bf16 v[12:27], v[84:87], v[52:55], v[12:27]
    ds_read_b128 v[104:107], v6 offset:4128
    ds_read2_b32 v[72:73], v7 offset0:24 offset1:25
    s_waitcnt lgkmcnt(12)
    ds_read2_b32 v[74:75], v7 offset0:26 offset1:27
    s_waitcnt lgkmcnt(12)
    v_mfma_f32_32x32x16_bf16 v[12:27], v[88:91], v[56:59], v[12:27]
    v_subrev_u32 v7, 128, v7
    ds_read_b128 v[76:79], v6 offset:3888
    ds_read2_b32 v[44:45], v7 offset0:0 offset1:1
    s_waitcnt lgkmcnt(12)
    ds_read2_b32 v[46:47], v7 offset0:2 offset1:3
    s_waitcnt lgkmcnt(12)
    v_mfma_f32_32x32x16_bf16 v[12:27], v[92:95], v[60:63], v[12:27]
    ds_read_b128 v[80:83], v6 offset:3920
    ds_read2_b32 v[48:49], v7 offset0:8 offset1:9
    s_waitcnt lgkmcnt(12)
    ds_read2_b32 v[50:51], v7 offset0:10 offset1:11
    s_waitcnt lgkmcnt(12)
    v_mfma_f32_32x32x16_bf16 v[12:27], v[96:99], v[64:67], v[12:27]
    ds_read_b128 v[84:87], v6 offset:3952
    ds_read2_b32 v[52:53], v7 offset0:16 offset1:17
    s_waitcnt lgkmcnt(12)
    ds_read2_b32 v[54:55], v7 offset0:18 offset1:19
    s_waitcnt lgkmcnt(12)
    v_mfma_f32_32x32x16_bf16 v[12:27], v[100:103], v[68:71], v[12:27]
    ds_read_b128 v[88:91], v6 offset:3984
    ds_read2_b32 v[56:57], v7 offset0:24 offset1:25
    s_waitcnt lgkmcnt(12)
    ds_read2_b32 v[58:59], v7 offset0:26 offset1:27
    s_waitcnt lgkmcnt(12)
    v_mfma_f32_32x32x16_bf16 v[12:27], v[104:107], v[72:75], v[12:27]
    v_subrev_u32 v7, 128, v7
    ds_read_b128 v[92:95], v6 offset:3744
    ds_read2_b32 v[60:61], v7 offset0:0 offset1:1
    s_waitcnt lgkmcnt(12)
    ds_read2_b32 v[62:63], v7 offset0:2 offset1:3
    s_waitcnt lgkmcnt(12)
    v_mfma_f32_32x32x16_bf16 v[12:27], v[76:79], v[44:47], v[12:27]
    ds_read_b128 v[96:99], v6 offset:3776
    ds_read2_b32 v[64:65], v7 offset0:8 offset1:9
    s_waitcnt lgkmcnt(12)
    ds_read2_b32 v[66:67], v7 offset0:10 offset1:11
    s_waitcnt lgkmcnt(12)
    v_mfma_f32_32x32x16_bf16 v[12:27], v[80:83], v[48:51], v[12:27]
    ds_read_b128 v[100:103], v6 offset:3808
    ds_read2_b32 v[68:69], v7 offset0:16 offset1:17
    s_waitcnt lgkmcnt(12)
    ds_read2_b32 v[70:71], v7 offset0:18 offset1:19
    s_waitcnt lgkmcnt(12)
    v_mfma_f32_32x32x16_bf16 v[12:27], v[84:87], v[52:55], v[12:27]
    ds_read_b128 v[104:107], v6 offset:3840
    ds_read2_b32 v[72:73], v7 offset0:24 offset1:25
    s_waitcnt lgkmcnt(12)
    ds_read2_b32 v[74:75], v7 offset0:26 offset1:27
    s_waitcnt lgkmcnt(12)
    v_mfma_f32_32x32x16_bf16 v[12:27], v[88:91], v[56:59], v[12:27]
    v_subrev_u32 v7, 128, v7
    ds_read_b128 v[76:79], v6 offset:3600
    ds_read2_b32 v[44:45], v7 offset0:0 offset1:1
    s_waitcnt lgkmcnt(12)
    ds_read2_b32 v[46:47], v7 offset0:2 offset1:3
    s_waitcnt lgkmcnt(12)
    v_mfma_f32_32x32x16_bf16 v[12:27], v[92:95], v[60:63], v[12:27]
    ds_read_b128 v[80:83], v6 offset:3632
    ds_read2_b32 v[48:49], v7 offset0:8 offset1:9
    s_waitcnt lgkmcnt(12)
    ds_read2_b32 v[50:51], v7 offset0:10 offset1:11
    s_waitcnt lgkmcnt(12)
    v_mfma_f32_32x32x16_bf16 v[12:27], v[96:99], v[64:67], v[12:27]
    ds_read_b128 v[84:87], v6 offset:3664
    ds_read2_b32 v[52:53], v7 offset0:16 offset1:17
    s_waitcnt lgkmcnt(12)
    ds_read2_b32 v[54:55], v7 offset0:18 offset1:19
    s_waitcnt lgkmcnt(12)
    v_mfma_f32_32x32x16_bf16 v[12:27], v[100:103], v[68:71], v[12:27]
    ds_read_b128 v[88:91], v6 offset:3696
    ds_read2_b32 v[56:57], v7 offset0:24 offset1:25
    s_waitcnt lgkmcnt(12)
    ds_read2_b32 v[58:59], v7 offset0:26 offset1:27
    s_waitcnt lgkmcnt(12)
    v_mfma_f32_32x32x16_bf16 v[12:27], v[104:107], v[72:75], v[12:27]
    v_subrev_u32 v7, 128, v7
    ds_read_b128 v[92:95], v6 offset:3456
    ds_read2_b32 v[60:61], v7 offset0:0 offset1:1
    s_waitcnt lgkmcnt(12)
    ds_read2_b32 v[62:63], v7 offset0:2 offset1:3
    s_waitcnt lgkmcnt(12)
    v_mfma_f32_32x32x16_bf16 v[12:27], v[76:79], v[44:47], v[12:27]
    ds_read_b128 v[96:99], v6 offset:3488
    ds_read2_b32 v[64:65], v7 offset0:8 offset1:9
    s_waitcnt lgkmcnt(12)
    ds_read2_b32 v[66:67], v7 offset0:10 offset1:11
    s_waitcnt lgkmcnt(12)
    v_mfma_f32_32x32x16_bf16 v[12:27], v[80:83], v[48:51], v[12:27]
    ds_read_b128 v[100:103], v6 offset:3520
    ds_read2_b32 v[68:69], v7 offset0:16 offset1:17
    s_waitcnt lgkmcnt(12)
    ds_read2_b32 v[70:71], v7 offset0:18 offset1:19
    s_waitcnt lgkmcnt(12)
    v_mfma_f32_32x32x16_bf16 v[12:27], v[84:87], v[52:55], v[12:27]
    ds_read_b128 v[104:107], v6 offset:3552
    ds_read2_b32 v[72:73], v7 offset0:24 offset1:25
    s_waitcnt lgkmcnt(12)
    ds_read2_b32 v[74:75], v7 offset0:26 offset1:27
    s_waitcnt lgkmcnt(12)
    v_mfma_f32_32x32x16_bf16 v[12:27], v[88:91], v[56:59], v[12:27]
    v_subrev_u32 v7, 128, v7
    ds_read_b128 v[76:79], v6 offset:3312
    ds_read2_b32 v[44:45], v7 offset0:0 offset1:1
    s_waitcnt lgkmcnt(12)
    ds_read2_b32 v[46:47], v7 offset0:2 offset1:3
    s_waitcnt lgkmcnt(12)
    v_mfma_f32_32x32x16_bf16 v[12:27], v[92:95], v[60:63], v[12:27]
    ds_read_b128 v[80:83], v6 offset:3344
    ds_read2_b32 v[48:49], v7 offset0:8 offset1:9
    s_waitcnt lgkmcnt(12)
    ds_read2_b32 v[50:51], v7 offset0:10 offset1:11
    s_waitcnt lgkmcnt(12)
    v_mfma_f32_32x32x16_bf16 v[12:27], v[96:99], v[64:67], v[12:27]
    ds_read_b128 v[84:87], v6 offset:3376
    ds_read2_b32 v[52:53], v7 offset0:16 offset1:17
    s_waitcnt lgkmcnt(12)
    ds_read2_b32 v[54:55], v7 offset0:18 offset1:19
    s_waitcnt lgkmcnt(12)
    v_mfma_f32_32x32x16_bf16 v[12:27], v[100:103], v[68:71], v[12:27]
    ds_read_b128 v[88:91], v6 offset:3408
    ds_read2_b32 v[56:57], v7 offset0:24 offset1:25
    s_waitcnt lgkmcnt(12)
    ds_read2_b32 v[58:59], v7 offset0:26 offset1:27
    s_waitcnt lgkmcnt(12)
    v_mfma_f32_32x32x16_bf16 v[12:27], v[104:107], v[72:75], v[12:27]
    v_subrev_u32 v7, 128, v7
    ds_read_b128 v[92:95], v6 offset:3168
    ds_read2_b32 v[60:61], v7 offset0:0 offset1:1
    s_waitcnt lgkmcnt(12)
    ds_read2_b32 v[62:63], v7 offset0:2 offset1:3
    s_waitcnt lgkmcnt(12)
    v_mfma_f32_32x32x16_bf16 v[12:27], v[76:79], v[44:47], v[12:27]
    ds_read_b128 v[96:99], v6 offset:3200
    ds_read2_b32 v[64:65], v7 offset0:8 offset1:9
    s_waitcnt lgkmcnt(12)
    ds_read2_b32 v[66:67], v7 offset0:10 offset1:11
    s_waitcnt lgkmcnt(12)
    v_mfma_f32_32x32x16_bf16 v[12:27], v[80:83], v[48:51], v[12:27]
    ds_read_b128 v[100:103], v6 offset:3232
    ds_read2_b32 v[68:69], v7 offset0:16 offset1:17
    s_waitcnt lgkmcnt(12)
    ds_read2_b32 v[70:71], v7 offset0:18 offset1:19
    s_waitcnt lgkmcnt(12)
    v_mfma_f32_32x32x16_bf16 v[12:27], v[84:87], v[52:55], v[12:27]
    ds_read_b128 v[104:107], v6 offset:3264
    ds_read2_b32 v[72:73], v7 offset0:24 offset1:25
    s_waitcnt lgkmcnt(12)
    ds_read2_b32 v[74:75], v7 offset0:26 offset1:27
    s_waitcnt lgkmcnt(12)
    v_mfma_f32_32x32x16_bf16 v[12:27], v[88:91], v[56:59], v[12:27]
    v_subrev_u32 v7, 128, v7
    ds_read_b128 v[76:79], v6 offset:3024
    ds_read2_b32 v[44:45], v7 offset0:0 offset1:1
    s_waitcnt lgkmcnt(12)
    ds_read2_b32 v[46:47], v7 offset0:2 offset1:3
    s_waitcnt lgkmcnt(12)
    v_mfma_f32_32x32x16_bf16 v[12:27], v[92:95], v[60:63], v[12:27]
    ds_read_b128 v[80:83], v6 offset:3056
    ds_read2_b32 v[48:49], v7 offset0:8 offset1:9
    s_waitcnt lgkmcnt(12)
    ds_read2_b32 v[50:51], v7 offset0:10 offset1:11
    s_waitcnt lgkmcnt(12)
    v_mfma_f32_32x32x16_bf16 v[12:27], v[96:99], v[64:67], v[12:27]
    ds_read_b128 v[84:87], v6 offset:3088
    ds_read2_b32 v[52:53], v7 offset0:16 offset1:17
    s_waitcnt lgkmcnt(12)
    ds_read2_b32 v[54:55], v7 offset0:18 offset1:19
    s_waitcnt lgkmcnt(12)
    v_mfma_f32_32x32x16_bf16 v[12:27], v[100:103], v[68:71], v[12:27]
    ds_read_b128 v[88:91], v6 offset:3120
    ds_read2_b32 v[56:57], v7 offset0:24 offset1:25
    s_waitcnt lgkmcnt(12)
    ds_read2_b32 v[58:59], v7 offset0:26 offset1:27
    s_waitcnt lgkmcnt(12)
    v_mfma_f32_32x32x16_bf16 v[12:27], v[104:107], v[72:75], v[12:27]
    v_subrev_u32 v7, 128, v7
    ds_read_b128 v[92:95], v6 offset:2880
    ds_read2_b32 v[60:61], v7 offset0:0 offset1:1
    s_waitcnt lgkmcnt(12)
    ds_read2_b32 v[62:63], v7 offset0:2 offset1:3
    s_waitcnt lgkmcnt(12)
    v_mfma_f32_32x32x16_bf16 v[12:27], v[76:79], v[44:47], v[12:27]
    ds_read_b128 v[96:99], v6 offset:2912
    ds_read2_b32 v[64:65], v7 offset0:8 offset1:9
    s_waitcnt lgkmcnt(12)
    ds_read2_b32 v[66:67], v7 offset0:10 offset1:11
    s_waitcnt lgkmcnt(12)
    v_mfma_f32_32x32x16_bf16 v[12:27], v[80:83], v[48:51], v[12:27]
    ds_read_b128 v[100:103], v6 offset:2944
    ds_read2_b32 v[68:69], v7 offset0:16 offset1:17
    s_waitcnt lgkmcnt(12)
    ds_read2_b32 v[70:71], v7 offset0:18 offset1:19
    s_waitcnt lgkmcnt(12)
    v_mfma_f32_32x32x16_bf16 v[12:27], v[84:87], v[52:55], v[12:27]
    ds_read_b128 v[104:107], v6 offset:2976
    ds_read2_b32 v[72:73], v7 offset0:24 offset1:25
    s_waitcnt lgkmcnt(12)
    ds_read2_b32 v[74:75], v7 offset0:26 offset1:27
    s_waitcnt lgkmcnt(12)
    v_mfma_f32_32x32x16_bf16 v[12:27], v[88:91], v[56:59], v[12:27]
    v_subrev_u32 v7, 128, v7
    ds_read_b128 v[76:79], v6 offset:2736
    ds_read2_b32 v[44:45], v7 offset0:0 offset1:1
    s_waitcnt lgkmcnt(12)
    ds_read2_b32 v[46:47], v7 offset0:2 offset1:3
    s_waitcnt lgkmcnt(12)
    v_mfma_f32_32x32x16_bf16 v[12:27], v[92:95], v[60:63], v[12:27]
    ds_read_b128 v[80:83], v6 offset:2768
    ds_read2_b32 v[48:49], v7 offset0:8 offset1:9
    s_waitcnt lgkmcnt(12)
    ds_read2_b32 v[50:51], v7 offset0:10 offset1:11
    s_waitcnt lgkmcnt(12)
    v_mfma_f32_32x32x16_bf16 v[12:27], v[96:99], v[64:67], v[12:27]
    ds_read_b128 v[84:87], v6 offset:2800
    ds_read2_b32 v[52:53], v7 offset0:16 offset1:17
    s_waitcnt lgkmcnt(12)
    ds_read2_b32 v[54:55], v7 offset0:18 offset1:19
    s_waitcnt lgkmcnt(12)
    v_mfma_f32_32x32x16_bf16 v[12:27], v[100:103], v[68:71], v[12:27]
    ds_read_b128 v[88:91], v6 offset:2832
    ds_read2_b32 v[56:57], v7 offset0:24 offset1:25
    s_waitcnt lgkmcnt(12)
    ds_read2_b32 v[58:59], v7 offset0:26 offset1:27
    s_waitcnt lgkmcnt(12)
    v_mfma_f32_32x32x16_bf16 v[12:27], v[104:107], v[72:75], v[12:27]
    v_subrev_u32 v7, 128, v7
    ds_read_b128 v[92:95], v6 offset:2592
    ds_read2_b32 v[60:61], v7 offset0:0 offset1:1
    s_waitcnt lgkmcnt(12)
    ds_read2_b32 v[62:63], v7 offset0:2 offset1:3
    s_waitcnt lgkmcnt(12)
    v_mfma_f32_32x32x16_bf16 v[12:27], v[76:79], v[44:47], v[12:27]
    ds_read_b128 v[96:99], v6 offset:2624
    ds_read2_b32 v[64:65], v7 offset0:8 offset1:9
    s_waitcnt lgkmcnt(12)
    ds_read2_b32 v[66:67], v7 offset0:10 offset1:11
    s_waitcnt lgkmcnt(12)
    v_mfma_f32_32x32x16_bf16 v[12:27], v[80:83], v[48:51], v[12:27]
    ds_read_b128 v[100:103], v6 offset:2656
    ds_read2_b32 v[68:69], v7 offset0:16 offset1:17
    s_waitcnt lgkmcnt(12)
    ds_read2_b32 v[70:71], v7 offset0:18 offset1:19
    s_waitcnt lgkmcnt(12)
    v_mfma_f32_32x32x16_bf16 v[12:27], v[84:87], v[52:55], v[12:27]
    ds_read_b128 v[104:107], v6 offset:2688
    ds_read2_b32 v[72:73], v7 offset0:24 offset1:25
    s_waitcnt lgkmcnt(12)
    ds_read2_b32 v[74:75], v7 offset0:26 offset1:27
    s_waitcnt lgkmcnt(12)
    v_mfma_f32_32x32x16_bf16 v[12:27], v[88:91], v[56:59], v[12:27]
    v_subrev_u32 v7, 128, v7
    ds_read_b128 v[76:79], v6 offset:2448
    ds_read2_b32 v[44:45], v7 offset0:0 offset1:1
    s_waitcnt lgkmcnt(12)
    ds_read2_b32 v[46:47], v7 offset0:2 offset1:3
    s_waitcnt lgkmcnt(12)
    v_mfma_f32_32x32x16_bf16 v[12:27], v[92:95], v[60:63], v[12:27]
    ds_read_b128 v[80:83], v6 offset:2480
    ds_read2_b32 v[48:49], v7 offset0:8 offset1:9
    s_waitcnt lgkmcnt(12)
    ds_read2_b32 v[50:51], v7 offset0:10 offset1:11
    s_waitcnt lgkmcnt(12)
    v_mfma_f32_32x32x16_bf16 v[12:27], v[96:99], v[64:67], v[12:27]
    ds_read_b128 v[84:87], v6 offset:2512
    ds_read2_b32 v[52:53], v7 offset0:16 offset1:17
    s_waitcnt lgkmcnt(12)
    ds_read2_b32 v[54:55], v7 offset0:18 offset1:19
    s_waitcnt lgkmcnt(12)
    v_mfma_f32_32x32x16_bf16 v[12:27], v[100:103], v[68:71], v[12:27]
    ds_read_b128 v[88:91], v6 offset:2544
    ds_read2_b32 v[56:57], v7 offset0:24 offset1:25
    s_waitcnt lgkmcnt(12)
    ds_read2_b32 v[58:59], v7 offset0:26 offset1:27
    s_waitcnt lgkmcnt(12)
    v_mfma_f32_32x32x16_bf16 v[12:27], v[104:107], v[72:75], v[12:27]
    v_subrev_u32 v7, 128, v7
    ds_read_b128 v[92:95], v6 offset:2304
    ds_read2_b32 v[60:61], v7 offset0:0 offset1:1
    s_waitcnt lgkmcnt(12)
    ds_read2_b32 v[62:63], v7 offset0:2 offset1:3
    s_waitcnt lgkmcnt(12)
    v_mfma_f32_32x32x16_bf16 v[12:27], v[76:79], v[44:47], v[12:27]
    ds_read_b128 v[96:99], v6 offset:2336
    ds_read2_b32 v[64:65], v7 offset0:8 offset1:9
    s_waitcnt lgkmcnt(12)
    ds_read2_b32 v[66:67], v7 offset0:10 offset1:11
    s_waitcnt lgkmcnt(12)
    v_mfma_f32_32x32x16_bf16 v[12:27], v[80:83], v[48:51], v[12:27]
    ds_read_b128 v[100:103], v6 offset:2368
    ds_read2_b32 v[68:69], v7 offset0:16 offset1:17
    s_waitcnt lgkmcnt(12)
    ds_read2_b32 v[70:71], v7 offset0:18 offset1:19
    s_waitcnt lgkmcnt(12)
    v_mfma_f32_32x32x16_bf16 v[12:27], v[84:87], v[52:55], v[12:27]
    ds_read_b128 v[104:107], v6 offset:2400
    ds_read2_b32 v[72:73], v7 offset0:24 offset1:25
    s_waitcnt lgkmcnt(12)
    ds_read2_b32 v[74:75], v7 offset0:26 offset1:27
    s_waitcnt lgkmcnt(12)
    v_mfma_f32_32x32x16_bf16 v[12:27], v[88:91], v[56:59], v[12:27]
    v_subrev_u32 v7, 128, v7
    ds_read_b128 v[76:79], v6 offset:2160
    ds_read2_b32 v[44:45], v7 offset0:0 offset1:1
    s_waitcnt lgkmcnt(12)
    ds_read2_b32 v[46:47], v7 offset0:2 offset1:3
    s_waitcnt lgkmcnt(12)
    v_mfma_f32_32x32x16_bf16 v[12:27], v[92:95], v[60:63], v[12:27]
    ds_read_b128 v[80:83], v6 offset:2192
    ds_read2_b32 v[48:49], v7 offset0:8 offset1:9
    s_waitcnt lgkmcnt(12)
    ds_read2_b32 v[50:51], v7 offset0:10 offset1:11
    s_waitcnt lgkmcnt(12)
    v_mfma_f32_32x32x16_bf16 v[12:27], v[96:99], v[64:67], v[12:27]
    ds_read_b128 v[84:87], v6 offset:2224
    ds_read2_b32 v[52:53], v7 offset0:16 offset1:17
    s_waitcnt lgkmcnt(12)
    ds_read2_b32 v[54:55], v7 offset0:18 offset1:19
    s_waitcnt lgkmcnt(12)
    v_mfma_f32_32x32x16_bf16 v[12:27], v[100:103], v[68:71], v[12:27]
    ds_read_b128 v[88:91], v6 offset:2256
    ds_read2_b32 v[56:57], v7 offset0:24 offset1:25
    s_waitcnt lgkmcnt(12)
    ds_read2_b32 v[58:59], v7 offset0:26 offset1:27
    s_waitcnt lgkmcnt(12)
    v_mfma_f32_32x32x16_bf16 v[12:27], v[104:107], v[72:75], v[12:27]
    v_subrev_u32 v7, 128, v7
    ds_read_b128 v[92:95], v6 offset:2016
    ds_read2_b32 v[60:61], v7 offset0:0 offset1:1
    s_waitcnt lgkmcnt(12)
    ds_read2_b32 v[62:63], v7 offset0:2 offset1:3
    s_waitcnt lgkmcnt(12)
    v_mfma_f32_32x32x16_bf16 v[12:27], v[76:79], v[44:47], v[12:27]
    ds_read_b128 v[96:99], v6 offset:2048
    ds_read2_b32 v[64:65], v7 offset0:8 offset1:9
    s_waitcnt lgkmcnt(12)
    ds_read2_b32 v[66:67], v7 offset0:10 offset1:11
    s_waitcnt lgkmcnt(12)
    v_mfma_f32_32x32x16_bf16 v[12:27], v[80:83], v[48:51], v[12:27]
    ds_read_b128 v[100:103], v6 offset:2080
    ds_read2_b32 v[68:69], v7 offset0:16 offset1:17
    s_waitcnt lgkmcnt(12)
    ds_read2_b32 v[70:71], v7 offset0:18 offset1:19
    s_waitcnt lgkmcnt(12)
    v_mfma_f32_32x32x16_bf16 v[12:27], v[84:87], v[52:55], v[12:27]
    ds_read_b128 v[104:107], v6 offset:2112
    ds_read2_b32 v[72:73], v7 offset0:24 offset1:25
    s_waitcnt lgkmcnt(12)
    ds_read2_b32 v[74:75], v7 offset0:26 offset1:27
    s_waitcnt lgkmcnt(12)
    v_mfma_f32_32x32x16_bf16 v[12:27], v[88:91], v[56:59], v[12:27]
    v_subrev_u32 v7, 128, v7
    ds_read_b128 v[76:79], v6 offset:1872
    ds_read2_b32 v[44:45], v7 offset0:0 offset1:1
    s_waitcnt lgkmcnt(12)
    ds_read2_b32 v[46:47], v7 offset0:2 offset1:3
    s_waitcnt lgkmcnt(12)
    v_mfma_f32_32x32x16_bf16 v[12:27], v[92:95], v[60:63], v[12:27]
    ds_read_b128 v[80:83], v6 offset:1904
    ds_read2_b32 v[48:49], v7 offset0:8 offset1:9
    s_waitcnt lgkmcnt(12)
    ds_read2_b32 v[50:51], v7 offset0:10 offset1:11
    s_waitcnt lgkmcnt(12)
    v_mfma_f32_32x32x16_bf16 v[12:27], v[96:99], v[64:67], v[12:27]
    ds_read_b128 v[84:87], v6 offset:1936
    ds_read2_b32 v[52:53], v7 offset0:16 offset1:17
    s_waitcnt lgkmcnt(12)
    ds_read2_b32 v[54:55], v7 offset0:18 offset1:19
    s_waitcnt lgkmcnt(12)
    v_mfma_f32_32x32x16_bf16 v[12:27], v[100:103], v[68:71], v[12:27]
    ds_read_b128 v[88:91], v6 offset:1968
    ds_read2_b32 v[56:57], v7 offset0:24 offset1:25
    s_waitcnt lgkmcnt(12)
    ds_read2_b32 v[58:59], v7 offset0:26 offset1:27
    s_waitcnt lgkmcnt(12)
    v_mfma_f32_32x32x16_bf16 v[12:27], v[104:107], v[72:75], v[12:27]
    v_subrev_u32 v7, 128, v7
    ds_read_b128 v[92:95], v6 offset:1728
    ds_read2_b32 v[60:61], v7 offset0:0 offset1:1
    s_waitcnt lgkmcnt(12)
    ds_read2_b32 v[62:63], v7 offset0:2 offset1:3
    s_waitcnt lgkmcnt(12)
    v_mfma_f32_32x32x16_bf16 v[12:27], v[76:79], v[44:47], v[12:27]
    ds_read_b128 v[96:99], v6 offset:1760
    ds_read2_b32 v[64:65], v7 offset0:8 offset1:9
    s_waitcnt lgkmcnt(12)
    ds_read2_b32 v[66:67], v7 offset0:10 offset1:11
    s_waitcnt lgkmcnt(12)
    v_mfma_f32_32x32x16_bf16 v[12:27], v[80:83], v[48:51], v[12:27]
    ds_read_b128 v[100:103], v6 offset:1792
    ds_read2_b32 v[68:69], v7 offset0:16 offset1:17
    s_waitcnt lgkmcnt(12)
    ds_read2_b32 v[70:71], v7 offset0:18 offset1:19
    s_waitcnt lgkmcnt(12)
    v_mfma_f32_32x32x16_bf16 v[12:27], v[84:87], v[52:55], v[12:27]
    ds_read_b128 v[104:107], v6 offset:1824
    ds_read2_b32 v[72:73], v7 offset0:24 offset1:25
    s_waitcnt lgkmcnt(12)
    ds_read2_b32 v[74:75], v7 offset0:26 offset1:27
    s_waitcnt lgkmcnt(12)
    v_mfma_f32_32x32x16_bf16 v[12:27], v[88:91], v[56:59], v[12:27]
    v_subrev_u32 v7, 128, v7
    ds_read_b128 v[76:79], v6 offset:1584
    ds_read2_b32 v[44:45], v7 offset0:0 offset1:1
    s_waitcnt lgkmcnt(12)
    ds_read2_b32 v[46:47], v7 offset0:2 offset1:3
    s_waitcnt lgkmcnt(12)
    v_mfma_f32_32x32x16_bf16 v[12:27], v[92:95], v[60:63], v[12:27]
    ds_read_b128 v[80:83], v6 offset:1616
    ds_read2_b32 v[48:49], v7 offset0:8 offset1:9
    s_waitcnt lgkmcnt(12)
    ds_read2_b32 v[50:51], v7 offset0:10 offset1:11
    s_waitcnt lgkmcnt(12)
    v_mfma_f32_32x32x16_bf16 v[12:27], v[96:99], v[64:67], v[12:27]
    ds_read_b128 v[84:87], v6 offset:1648
    ds_read2_b32 v[52:53], v7 offset0:16 offset1:17
    s_waitcnt lgkmcnt(12)
    ds_read2_b32 v[54:55], v7 offset0:18 offset1:19
    s_waitcnt lgkmcnt(12)
    v_mfma_f32_32x32x16_bf16 v[12:27], v[100:103], v[68:71], v[12:27]
    ds_read_b128 v[88:91], v6 offset:1680
    ds_read2_b32 v[56:57], v7 offset0:24 offset1:25
    s_waitcnt lgkmcnt(12)
    ds_read2_b32 v[58:59], v7 offset0:26 offset1:27
    s_waitcnt lgkmcnt(12)
    v_mfma_f32_32x32x16_bf16 v[12:27], v[104:107], v[72:75], v[12:27]
    v_subrev_u32 v7, 128, v7
    ds_read_b128 v[92:95], v6 offset:1440
    ds_read2_b32 v[60:61], v7 offset0:0 offset1:1
    s_waitcnt lgkmcnt(12)
    ds_read2_b32 v[62:63], v7 offset0:2 offset1:3
    s_waitcnt lgkmcnt(12)
    v_mfma_f32_32x32x16_bf16 v[12:27], v[76:79], v[44:47], v[12:27]
    ds_read_b128 v[96:99], v6 offset:1472
    ds_read2_b32 v[64:65], v7 offset0:8 offset1:9
    s_waitcnt lgkmcnt(12)
    ds_read2_b32 v[66:67], v7 offset0:10 offset1:11
    s_waitcnt lgkmcnt(12)
    v_mfma_f32_32x32x16_bf16 v[12:27], v[80:83], v[48:51], v[12:27]
    ds_read_b128 v[100:103], v6 offset:1504
    ds_read2_b32 v[68:69], v7 offset0:16 offset1:17
    s_waitcnt lgkmcnt(12)
    ds_read2_b32 v[70:71], v7 offset0:18 offset1:19
    s_waitcnt lgkmcnt(12)
    v_mfma_f32_32x32x16_bf16 v[12:27], v[84:87], v[52:55], v[12:27]
    ds_read_b128 v[104:107], v6 offset:1536
    ds_read2_b32 v[72:73], v7 offset0:24 offset1:25
    s_waitcnt lgkmcnt(12)
    ds_read2_b32 v[74:75], v7 offset0:26 offset1:27
    s_waitcnt lgkmcnt(12)
    v_mfma_f32_32x32x16_bf16 v[12:27], v[88:91], v[56:59], v[12:27]
    v_subrev_u32 v7, 128, v7
    ds_read_b128 v[76:79], v6 offset:1296
    ds_read2_b32 v[44:45], v7 offset0:0 offset1:1
    s_waitcnt lgkmcnt(12)
    ds_read2_b32 v[46:47], v7 offset0:2 offset1:3
    s_waitcnt lgkmcnt(12)
    v_mfma_f32_32x32x16_bf16 v[12:27], v[92:95], v[60:63], v[12:27]
    ds_read_b128 v[80:83], v6 offset:1328
    ds_read2_b32 v[48:49], v7 offset0:8 offset1:9
    s_waitcnt lgkmcnt(12)
    ds_read2_b32 v[50:51], v7 offset0:10 offset1:11
    s_waitcnt lgkmcnt(12)
    v_mfma_f32_32x32x16_bf16 v[12:27], v[96:99], v[64:67], v[12:27]
    ds_read_b128 v[84:87], v6 offset:1360
    ds_read2_b32 v[52:53], v7 offset0:16 offset1:17
    s_waitcnt lgkmcnt(12)
    ds_read2_b32 v[54:55], v7 offset0:18 offset1:19
    s_waitcnt lgkmcnt(12)
    v_mfma_f32_32x32x16_bf16 v[12:27], v[100:103], v[68:71], v[12:27]
    ds_read_b128 v[88:91], v6 offset:1392
    ds_read2_b32 v[56:57], v7 offset0:24 offset1:25
    s_waitcnt lgkmcnt(12)
    ds_read2_b32 v[58:59], v7 offset0:26 offset1:27
    s_waitcnt lgkmcnt(12)
    v_mfma_f32_32x32x16_bf16 v[12:27], v[104:107], v[72:75], v[12:27]
    v_subrev_u32 v7, 128, v7
    ds_read_b128 v[92:95], v6 offset:1152
    ds_read2_b32 v[60:61], v7 offset0:0 offset1:1
    s_waitcnt lgkmcnt(12)
    ds_read2_b32 v[62:63], v7 offset0:2 offset1:3
    s_waitcnt lgkmcnt(12)
    v_mfma_f32_32x32x16_bf16 v[12:27], v[76:79], v[44:47], v[12:27]
    ds_read_b128 v[96:99], v6 offset:1184
    ds_read2_b32 v[64:65], v7 offset0:8 offset1:9
    s_waitcnt lgkmcnt(12)
    ds_read2_b32 v[66:67], v7 offset0:10 offset1:11
    s_waitcnt lgkmcnt(12)
    v_mfma_f32_32x32x16_bf16 v[12:27], v[80:83], v[48:51], v[12:27]
    ds_read_b128 v[100:103], v6 offset:1216
    ds_read2_b32 v[68:69], v7 offset0:16 offset1:17
    s_waitcnt lgkmcnt(12)
    ds_read2_b32 v[70:71], v7 offset0:18 offset1:19
    s_waitcnt lgkmcnt(12)
    v_mfma_f32_32x32x16_bf16 v[12:27], v[84:87], v[52:55], v[12:27]
    ds_read_b128 v[104:107], v6 offset:1248
    ds_read2_b32 v[72:73], v7 offset0:24 offset1:25
    s_waitcnt lgkmcnt(12)
    ds_read2_b32 v[74:75], v7 offset0:26 offset1:27
    s_waitcnt lgkmcnt(12)
    v_mfma_f32_32x32x16_bf16 v[12:27], v[88:91], v[56:59], v[12:27]
    v_subrev_u32 v7, 128, v7
    ds_read_b128 v[76:79], v6 offset:1008
    ds_read2_b32 v[44:45], v7 offset0:0 offset1:1
    s_waitcnt lgkmcnt(12)
    ds_read2_b32 v[46:47], v7 offset0:2 offset1:3
    s_waitcnt lgkmcnt(12)
    v_mfma_f32_32x32x16_bf16 v[12:27], v[92:95], v[60:63], v[12:27]
    ds_read_b128 v[80:83], v6 offset:1040
    ds_read2_b32 v[48:49], v7 offset0:8 offset1:9
    s_waitcnt lgkmcnt(12)
    ds_read2_b32 v[50:51], v7 offset0:10 offset1:11
    s_waitcnt lgkmcnt(12)
    v_mfma_f32_32x32x16_bf16 v[12:27], v[96:99], v[64:67], v[12:27]
    ds_read_b128 v[84:87], v6 offset:1072
    ds_read2_b32 v[52:53], v7 offset0:16 offset1:17
    s_waitcnt lgkmcnt(12)
    ds_read2_b32 v[54:55], v7 offset0:18 offset1:19
    s_waitcnt lgkmcnt(12)
    v_mfma_f32_32x32x16_bf16 v[12:27], v[100:103], v[68:71], v[12:27]
    ds_read_b128 v[88:91], v6 offset:1104
    ds_read2_b32 v[56:57], v7 offset0:24 offset1:25
    s_waitcnt lgkmcnt(12)
    ds_read2_b32 v[58:59], v7 offset0:26 offset1:27
    s_waitcnt lgkmcnt(12)
    v_mfma_f32_32x32x16_bf16 v[12:27], v[104:107], v[72:75], v[12:27]
    v_subrev_u32 v7, 128, v7
    ds_read_b128 v[92:95], v6 offset:864
    ds_read2_b32 v[60:61], v7 offset0:0 offset1:1
    s_waitcnt lgkmcnt(12)
    ds_read2_b32 v[62:63], v7 offset0:2 offset1:3
    s_waitcnt lgkmcnt(12)
    v_mfma_f32_32x32x16_bf16 v[12:27], v[76:79], v[44:47], v[12:27]
    ds_read_b128 v[96:99], v6 offset:896
    ds_read2_b32 v[64:65], v7 offset0:8 offset1:9
    s_waitcnt lgkmcnt(12)
    ds_read2_b32 v[66:67], v7 offset0:10 offset1:11
    s_waitcnt lgkmcnt(12)
    v_mfma_f32_32x32x16_bf16 v[12:27], v[80:83], v[48:51], v[12:27]
    ds_read_b128 v[100:103], v6 offset:928
    ds_read2_b32 v[68:69], v7 offset0:16 offset1:17
    s_waitcnt lgkmcnt(12)
    ds_read2_b32 v[70:71], v7 offset0:18 offset1:19
    s_waitcnt lgkmcnt(12)
    v_mfma_f32_32x32x16_bf16 v[12:27], v[84:87], v[52:55], v[12:27]
    ds_read_b128 v[104:107], v6 offset:960
    ds_read2_b32 v[72:73], v7 offset0:24 offset1:25
    s_waitcnt lgkmcnt(12)
    ds_read2_b32 v[74:75], v7 offset0:26 offset1:27
    s_waitcnt lgkmcnt(12)
    v_mfma_f32_32x32x16_bf16 v[12:27], v[88:91], v[56:59], v[12:27]
    v_subrev_u32 v7, 128, v7
    ds_read_b128 v[76:79], v6 offset:720
    ds_read2_b32 v[44:45], v7 offset0:0 offset1:1
    s_waitcnt lgkmcnt(12)
    ds_read2_b32 v[46:47], v7 offset0:2 offset1:3
    s_waitcnt lgkmcnt(12)
    v_mfma_f32_32x32x16_bf16 v[12:27], v[92:95], v[60:63], v[12:27]
    ds_read_b128 v[80:83], v6 offset:752
    ds_read2_b32 v[48:49], v7 offset0:8 offset1:9
    s_waitcnt lgkmcnt(12)
    ds_read2_b32 v[50:51], v7 offset0:10 offset1:11
    s_waitcnt lgkmcnt(12)
    v_mfma_f32_32x32x16_bf16 v[12:27], v[96:99], v[64:67], v[12:27]
    ds_read_b128 v[84:87], v6 offset:784
    ds_read2_b32 v[52:53], v7 offset0:16 offset1:17
    s_waitcnt lgkmcnt(12)
    ds_read2_b32 v[54:55], v7 offset0:18 offset1:19
    s_waitcnt lgkmcnt(12)
    v_mfma_f32_32x32x16_bf16 v[12:27], v[100:103], v[68:71], v[12:27]
    ds_read_b128 v[88:91], v6 offset:816
    ds_read2_b32 v[56:57], v7 offset0:24 offset1:25
    s_waitcnt lgkmcnt(12)
    ds_read2_b32 v[58:59], v7 offset0:26 offset1:27
    s_waitcnt lgkmcnt(12)
    v_mfma_f32_32x32x16_bf16 v[12:27], v[104:107], v[72:75], v[12:27]
    v_subrev_u32 v7, 128, v7
    ds_read_b128 v[92:95], v6 offset:576
    ds_read2_b32 v[60:61], v7 offset0:0 offset1:1
    s_waitcnt lgkmcnt(12)
    ds_read2_b32 v[62:63], v7 offset0:2 offset1:3
    s_waitcnt lgkmcnt(12)
    v_mfma_f32_32x32x16_bf16 v[12:27], v[76:79], v[44:47], v[12:27]
    ds_read_b128 v[96:99], v6 offset:608
    ds_read2_b32 v[64:65], v7 offset0:8 offset1:9
    s_waitcnt lgkmcnt(12)
    ds_read2_b32 v[66:67], v7 offset0:10 offset1:11
    s_waitcnt lgkmcnt(12)
    v_mfma_f32_32x32x16_bf16 v[12:27], v[80:83], v[48:51], v[12:27]
    ds_read_b128 v[100:103], v6 offset:640
    ds_read2_b32 v[68:69], v7 offset0:16 offset1:17
    s_waitcnt lgkmcnt(12)
    ds_read2_b32 v[70:71], v7 offset0:18 offset1:19
    s_waitcnt lgkmcnt(12)
    v_mfma_f32_32x32x16_bf16 v[12:27], v[84:87], v[52:55], v[12:27]
    ds_read_b128 v[104:107], v6 offset:672
    ds_read2_b32 v[72:73], v7 offset0:24 offset1:25
    s_waitcnt lgkmcnt(12)
    ds_read2_b32 v[74:75], v7 offset0:26 offset1:27
    s_waitcnt lgkmcnt(12)
    v_mfma_f32_32x32x16_bf16 v[12:27], v[88:91], v[56:59], v[12:27]
    v_subrev_u32 v7, 128, v7
    ds_read_b128 v[76:79], v6 offset:432
    ds_read2_b32 v[44:45], v7 offset0:0 offset1:1
    s_waitcnt lgkmcnt(12)
    ds_read2_b32 v[46:47], v7 offset0:2 offset1:3
    s_waitcnt lgkmcnt(12)
    v_mfma_f32_32x32x16_bf16 v[12:27], v[92:95], v[60:63], v[12:27]
    ds_read_b128 v[80:83], v6 offset:464
    ds_read2_b32 v[48:49], v7 offset0:8 offset1:9
    s_waitcnt lgkmcnt(12)
    ds_read2_b32 v[50:51], v7 offset0:10 offset1:11
    s_waitcnt lgkmcnt(12)
    v_mfma_f32_32x32x16_bf16 v[12:27], v[96:99], v[64:67], v[12:27]
    ds_read_b128 v[84:87], v6 offset:496
    ds_read2_b32 v[52:53], v7 offset0:16 offset1:17
    s_waitcnt lgkmcnt(12)
    ds_read2_b32 v[54:55], v7 offset0:18 offset1:19
    s_waitcnt lgkmcnt(12)
    v_mfma_f32_32x32x16_bf16 v[12:27], v[100:103], v[68:71], v[12:27]
    ds_read_b128 v[88:91], v6 offset:528
    ds_read2_b32 v[56:57], v7 offset0:24 offset1:25
    s_waitcnt lgkmcnt(12)
    ds_read2_b32 v[58:59], v7 offset0:26 offset1:27
    s_waitcnt lgkmcnt(12)
    v_mfma_f32_32x32x16_bf16 v[12:27], v[104:107], v[72:75], v[12:27]
    v_subrev_u32 v7, 128, v7
    ds_read_b128 v[92:95], v6 offset:288
    ds_read2_b32 v[60:61], v7 offset0:0 offset1:1
    s_waitcnt lgkmcnt(12)
    ds_read2_b32 v[62:63], v7 offset0:2 offset1:3
    s_waitcnt lgkmcnt(12)
    v_mfma_f32_32x32x16_bf16 v[12:27], v[76:79], v[44:47], v[12:27]
    ds_read_b128 v[96:99], v6 offset:320
    ds_read2_b32 v[64:65], v7 offset0:8 offset1:9
    s_waitcnt lgkmcnt(12)
    ds_read2_b32 v[66:67], v7 offset0:10 offset1:11
    s_waitcnt lgkmcnt(12)
    v_mfma_f32_32x32x16_bf16 v[12:27], v[80:83], v[48:51], v[12:27]
    ds_read_b128 v[100:103], v6 offset:352
    ds_read2_b32 v[68:69], v7 offset0:16 offset1:17
    s_waitcnt lgkmcnt(12)
    ds_read2_b32 v[70:71], v7 offset0:18 offset1:19
    s_waitcnt lgkmcnt(12)
    v_mfma_f32_32x32x16_bf16 v[12:27], v[84:87], v[52:55], v[12:27]
    ds_read_b128 v[104:107], v6 offset:384
    ds_read2_b32 v[72:73], v7 offset0:24 offset1:25
    s_waitcnt lgkmcnt(12)
    ds_read2_b32 v[74:75], v7 offset0:26 offset1:27
    s_waitcnt lgkmcnt(12)
    v_mfma_f32_32x32x16_bf16 v[12:27], v[88:91], v[56:59], v[12:27]
    v_subrev_u32 v7, 128, v7
    ds_read_b128 v[76:79], v6 offset:144
    ds_read2_b32 v[44:45], v7 offset0:0 offset1:1
    s_waitcnt lgkmcnt(12)
    ds_read2_b32 v[46:47], v7 offset0:2 offset1:3
    s_waitcnt lgkmcnt(12)
    v_mfma_f32_32x32x16_bf16 v[12:27], v[92:95], v[60:63], v[12:27]
    ds_read_b128 v[80:83], v6 offset:176
    ds_read2_b32 v[48:49], v7 offset0:8 offset1:9
    s_waitcnt lgkmcnt(12)
    ds_read2_b32 v[50:51], v7 offset0:10 offset1:11
    s_waitcnt lgkmcnt(12)
    v_mfma_f32_32x32x16_bf16 v[12:27], v[96:99], v[64:67], v[12:27]
    ds_read_b128 v[84:87], v6 offset:208
    ds_read2_b32 v[52:53], v7 offset0:16 offset1:17
    s_waitcnt lgkmcnt(12)
    ds_read2_b32 v[54:55], v7 offset0:18 offset1:19
    s_waitcnt lgkmcnt(12)
    v_mfma_f32_32x32x16_bf16 v[12:27], v[100:103], v[68:71], v[12:27]
    ds_read_b128 v[88:91], v6 offset:240
    ds_read2_b32 v[56:57], v7 offset0:24 offset1:25
    s_waitcnt lgkmcnt(12)
    ds_read2_b32 v[58:59], v7 offset0:26 offset1:27
    s_waitcnt lgkmcnt(12)
    v_mfma_f32_32x32x16_bf16 v[12:27], v[104:107], v[72:75], v[12:27]
    v_subrev_u32 v7, 128, v7
    ds_read_b128 v[92:95], v6 offset:0
    ds_read2_b32 v[60:61], v7 offset0:0 offset1:1
    s_waitcnt lgkmcnt(12)
    ds_read2_b32 v[62:63], v7 offset0:2 offset1:3
    s_waitcnt lgkmcnt(12)
    v_mfma_f32_32x32x16_bf16 v[12:27], v[76:79], v[44:47], v[12:27]
    ds_read_b128 v[96:99], v6 offset:32
    ds_read2_b32 v[64:65], v7 offset0:8 offset1:9
    s_waitcnt lgkmcnt(12)
    ds_read2_b32 v[66:67], v7 offset0:10 offset1:11
    s_waitcnt lgkmcnt(12)
    v_mfma_f32_32x32x16_bf16 v[12:27], v[80:83], v[48:51], v[12:27]
    ds_read_b128 v[100:103], v6 offset:64
    ds_read2_b32 v[68:69], v7 offset0:16 offset1:17
    s_waitcnt lgkmcnt(12)
    ds_read2_b32 v[70:71], v7 offset0:18 offset1:19
    s_waitcnt lgkmcnt(12)
    v_mfma_f32_32x32x16_bf16 v[12:27], v[84:87], v[52:55], v[12:27]
    ds_read_b128 v[104:107], v6 offset:96
    ds_read2_b32 v[72:73], v7 offset0:24 offset1:25
    s_waitcnt lgkmcnt(12)
    ds_read2_b32 v[74:75], v7 offset0:26 offset1:27
    s_waitcnt lgkmcnt(12)
    v_mfma_f32_32x32x16_bf16 v[12:27], v[88:91], v[56:59], v[12:27]
    s_waitcnt lgkmcnt(9)
    v_mfma_f32_32x32x16_bf16 v[12:27], v[92:95], v[60:63], v[12:27]
    s_waitcnt lgkmcnt(6)
    v_mfma_f32_32x32x16_bf16 v[12:27], v[96:99], v[64:67], v[12:27]
    s_waitcnt lgkmcnt(3)
    v_mfma_f32_32x32x16_bf16 v[12:27], v[100:103], v[68:71], v[12:27]
    s_waitcnt lgkmcnt(0)
    v_mfma_f32_32x32x16_bf16 v[12:27], v[104:107], v[72:75], v[12:27]
    v_mul_u32_u24 v6, 576, v9
    v_lshl_add_u32 v6, v10, 1, v6
    v_add_u32 v6, 140144, v6
    s_lshl_b32 s63, s61, 6
    v_add_u32 v6, s63, v6
    v_lshlrev_b32 v7, 9, v9
    v_lshl_add_u32 v7, v10, 1, v7
    v_add_u32 v7, s63, v7
    s_lshl_b32 s63, s62, 12
    s_add_u32 s63, s63, 10485760
    ds_read_u16 v76, v6 offset:0
    ds_read_u16 v77, v6 offset:144
    ds_read_u16 v78, v6 offset:288
    ds_read_u16 v79, v6 offset:432
    ds_read_u16 v80, v6 offset:1152
    ds_read_u16 v81, v6 offset:1296
    ds_read_u16 v82, v6 offset:1440
    ds_read_u16 v83, v6 offset:1584
    ds_read_u16 v84, v6 offset:2304
    ds_read_u16 v85, v6 offset:2448
    ds_read_u16 v86, v6 offset:2592
    ds_read_u16 v87, v6 offset:2736
    ds_read_u16 v88, v6 offset:3456
    ds_read_u16 v89, v6 offset:3600
    s_waitcnt lgkmcnt(12)
    ds_read_u16 v90, v6 offset:3744
    ds_read_u16 v91, v6 offset:3888
    v_lshlrev_b32 v76, 16, v76
    v_lshlrev_b32 v77, 16, v77
    v_mul_f32 v76, v76, v8
    v_mul_f32 v77, v77, v8
    v_cvt_pk_bf16_f32 v44, v76, v77
    v_lshlrev_b32 v76, 16, v44
    v_and_b32 v77, 0xffff0000, v44
    v_cvt_pk_bf16_f32 v45, v12, v13
    v_lshlrev_b32 v46, 16, v45
    v_and_b32 v47, 0xffff0000, v45
    v_add_f32 v46, v46, v76
    v_add_f32 v47, v47, v77
    v_cvt_pk_bf16_f32 v44, v46, v47
    buffer_store_short v44, v7, s[48:51], s63 offen offset:0
    buffer_store_short_d16_hi v44, v7, s[48:51], s63 offen offset:128
    s_waitcnt lgkmcnt(13)
    v_lshlrev_b32 v78, 16, v78
    s_waitcnt lgkmcnt(12)
    v_lshlrev_b32 v79, 16, v79
    v_mul_f32 v78, v78, v8
    v_mul_f32 v79, v79, v8
    v_cvt_pk_bf16_f32 v44, v78, v79
    v_lshlrev_b32 v78, 16, v44
    v_and_b32 v79, 0xffff0000, v44
    v_cvt_pk_bf16_f32 v45, v14, v15
    v_lshlrev_b32 v46, 16, v45
    v_and_b32 v47, 0xffff0000, v45
    v_add_f32 v46, v46, v78
    v_add_f32 v47, v47, v79
    v_cvt_pk_bf16_f32 v44, v46, v47
    buffer_store_short v44, v7, s[48:51], s63 offen offset:256
    buffer_store_short_d16_hi v44, v7, s[48:51], s63 offen offset:384
    s_waitcnt lgkmcnt(11)
    v_lshlrev_b32 v80, 16, v80
    s_waitcnt lgkmcnt(10)
    v_lshlrev_b32 v81, 16, v81
    v_mul_f32 v80, v80, v8
    v_mul_f32 v81, v81, v8
    v_cvt_pk_bf16_f32 v44, v80, v81
    v_lshlrev_b32 v80, 16, v44
    v_and_b32 v81, 0xffff0000, v44
    v_cvt_pk_bf16_f32 v45, v16, v17
    v_lshlrev_b32 v46, 16, v45
    v_and_b32 v47, 0xffff0000, v45
    v_add_f32 v46, v46, v80
    v_add_f32 v47, v47, v81
    v_cvt_pk_bf16_f32 v44, v46, v47
    buffer_store_short v44, v7, s[48:51], s63 offen offset:1024
    buffer_store_short_d16_hi v44, v7, s[48:51], s63 offen offset:1152
    s_waitcnt lgkmcnt(9)
    v_lshlrev_b32 v82, 16, v82
    s_waitcnt lgkmcnt(8)
    v_lshlrev_b32 v83, 16, v83
    v_mul_f32 v82, v82, v8
    v_mul_f32 v83, v83, v8
    v_cvt_pk_bf16_f32 v44, v82, v83
    v_lshlrev_b32 v82, 16, v44
    v_and_b32 v83, 0xffff0000, v44
    v_cvt_pk_bf16_f32 v45, v18, v19
    v_lshlrev_b32 v46, 16, v45
    v_and_b32 v47, 0xffff0000, v45
    v_add_f32 v46, v46, v82
    v_add_f32 v47, v47, v83
    v_cvt_pk_bf16_f32 v44, v46, v47
    buffer_store_short v44, v7, s[48:51], s63 offen offset:1280
    buffer_store_short_d16_hi v44, v7, s[48:51], s63 offen offset:1408
    s_waitcnt lgkmcnt(7)
    v_lshlrev_b32 v84, 16, v84
    s_waitcnt lgkmcnt(6)
    v_lshlrev_b32 v85, 16, v85
    v_mul_f32 v84, v84, v8
    v_mul_f32 v85, v85, v8
    v_cvt_pk_bf16_f32 v44, v84, v85
    v_lshlrev_b32 v84, 16, v44
    v_and_b32 v85, 0xffff0000, v44
    v_cvt_pk_bf16_f32 v45, v20, v21
    v_lshlrev_b32 v46, 16, v45
    v_and_b32 v47, 0xffff0000, v45
    v_add_f32 v46, v46, v84
    v_add_f32 v47, v47, v85
    v_cvt_pk_bf16_f32 v44, v46, v47
    buffer_store_short v44, v7, s[48:51], s63 offen offset:2048
    buffer_store_short_d16_hi v44, v7, s[48:51], s63 offen offset:2176
    s_waitcnt lgkmcnt(5)
    v_lshlrev_b32 v86, 16, v86
    s_waitcnt lgkmcnt(4)
    v_lshlrev_b32 v87, 16, v87
    v_mul_f32 v86, v86, v8
    v_mul_f32 v87, v87, v8
    v_cvt_pk_bf16_f32 v44, v86, v87
    v_lshlrev_b32 v86, 16, v44
    v_and_b32 v87, 0xffff0000, v44
    v_cvt_pk_bf16_f32 v45, v22, v23
    v_lshlrev_b32 v46, 16, v45
    v_and_b32 v47, 0xffff0000, v45
    v_add_f32 v46, v46, v86
    v_add_f32 v47, v47, v87
    v_cvt_pk_bf16_f32 v44, v46, v47
    buffer_store_short v44, v7, s[48:51], s63 offen offset:2304
    buffer_store_short_d16_hi v44, v7, s[48:51], s63 offen offset:2432
    s_waitcnt lgkmcnt(3)
    v_lshlrev_b32 v88, 16, v88
    s_waitcnt lgkmcnt(2)
    v_lshlrev_b32 v89, 16, v89
    v_mul_f32 v88, v88, v8
    v_mul_f32 v89, v89, v8
    v_cvt_pk_bf16_f32 v44, v88, v89
    v_lshlrev_b32 v88, 16, v44
    v_and_b32 v89, 0xffff0000, v44
    v_cvt_pk_bf16_f32 v45, v24, v25
    v_lshlrev_b32 v46, 16, v45
    v_and_b32 v47, 0xffff0000, v45
    v_add_f32 v46, v46, v88
    v_add_f32 v47, v47, v89
    v_cvt_pk_bf16_f32 v44, v46, v47
    buffer_store_short v44, v7, s[48:51], s63 offen offset:3072
    buffer_store_short_d16_hi v44, v7, s[48:51], s63 offen offset:3200
    s_waitcnt lgkmcnt(1)
    v_lshlrev_b32 v90, 16, v90
    s_waitcnt lgkmcnt(0)
    v_lshlrev_b32 v91, 16, v91
    v_mul_f32 v90, v90, v8
    v_mul_f32 v91, v91, v8
    v_cvt_pk_bf16_f32 v44, v90, v91
    v_lshlrev_b32 v90, 16, v44
    v_and_b32 v91, 0xffff0000, v44
    v_cvt_pk_bf16_f32 v45, v26, v27
    v_lshlrev_b32 v46, 16, v45
    v_and_b32 v47, 0xffff0000, v45
    v_add_f32 v46, v46, v90
    v_add_f32 v47, v47, v91
    v_cvt_pk_bf16_f32 v44, v46, v47
    buffer_store_short v44, v7, s[48:51], s63 offen offset:3328
    buffer_store_short_d16_hi v44, v7, s[48:51], s63 offen offset:3456
    s_endpgm
L_cv_var1:
    v_lshlrev_b32 v6, 4, v9
    v_sub_u32 v6, v6, v3
    v_add_u32 v6, 135536, v6
    ds_read2_b32 v[44:45], v7 offset0:0 offset1:1
    ds_read2_b32 v[46:47], v7 offset0:2 offset1:3
    ds_read_b128 v[76:79], v6 offset:0
    ds_read2_b32 v[48:49], v7 offset0:8 offset1:9
    ds_read2_b32 v[50:51], v7 offset0:10 offset1:11
    ds_read_b128 v[80:83], v6 offset:32
    ds_read2_b32 v[52:53], v7 offset0:16 offset1:17
    ds_read2_b32 v[54:55], v7 offset0:18 offset1:19
    ds_read_b128 v[84:87], v6 offset:64
    ds_read2_b32 v[56:57], v7 offset0:24 offset1:25
    ds_read2_b32 v[58:59], v7 offset0:26 offset1:27
    ds_read_b128 v[88:91], v6 offset:96
    v_subrev_u32 v7, 128, v7
    ds_read_b128 v[92:95], v6 offset:144
    ds_read2_b32 v[60:61], v7 offset0:0 offset1:1
    s_waitcnt lgkmcnt(12)
    ds_read2_b32 v[62:63], v7 offset0:2 offset1:3
    s_waitcnt lgkmcnt(12)
    v_mfma_f32_32x32x16_bf16 v[12:27], v[76:79], v[44:47], 0
    ds_read_b128 v[96:99], v6 offset:176
    ds_read2_b32 v[64:65], v7 offset0:8 offset1:9
    s_waitcnt lgkmcnt(12)
    ds_read2_b32 v[66:67], v7 offset0:10 offset1:11
    s_waitcnt lgkmcnt(12)
    v_mfma_f32_32x32x16_bf16 v[12:27], v[80:83], v[48:51], v[12:27]
    ds_read_b128 v[100:103], v6 offset:208
    ds_read2_b32 v[68:69], v7 offset0:16 offset1:17
    s_waitcnt lgkmcnt(12)
    ds_read2_b32 v[70:71], v7 offset0:18 offset1:19
    s_waitcnt lgkmcnt(12)
    v_mfma_f32_32x32x16_bf16 v[12:27], v[84:87], v[52:55], v[12:27]
    ds_read_b128 v[104:107], v6 offset:240
    ds_read2_b32 v[72:73], v7 offset0:24 offset1:25
    s_waitcnt lgkmcnt(12)
    ds_read2_b32 v[74:75], v7 offset0:26 offset1:27
    s_waitcnt lgkmcnt(12)
    v_mfma_f32_32x32x16_bf16 v[12:27], v[88:91], v[56:59], v[12:27]
    v_subrev_u32 v7, 128, v7
    ds_read_b128 v[76:79], v6 offset:288
    ds_read2_b32 v[44:45], v7 offset0:0 offset1:1
    s_waitcnt lgkmcnt(12)
    ds_read2_b32 v[46:47], v7 offset0:2 offset1:3
    s_waitcnt lgkmcnt(12)
    v_mfma_f32_32x32x16_bf16 v[12:27], v[92:95], v[60:63], v[12:27]
    ds_read_b128 v[80:83], v6 offset:320
    ds_read2_b32 v[48:49], v7 offset0:8 offset1:9
    s_waitcnt lgkmcnt(12)
    ds_read2_b32 v[50:51], v7 offset0:10 offset1:11
    s_waitcnt lgkmcnt(12)
    v_mfma_f32_32x32x16_bf16 v[12:27], v[96:99], v[64:67], v[12:27]
    ds_read_b128 v[84:87], v6 offset:352
    ds_read2_b32 v[52:53], v7 offset0:16 offset1:17
    s_waitcnt lgkmcnt(12)
    ds_read2_b32 v[54:55], v7 offset0:18 offset1:19
    s_waitcnt lgkmcnt(12)
    v_mfma_f32_32x32x16_bf16 v[12:27], v[100:103], v[68:71], v[12:27]
    ds_read_b128 v[88:91], v6 offset:384
    ds_read2_b32 v[56:57], v7 offset0:24 offset1:25
    s_waitcnt lgkmcnt(12)
    ds_read2_b32 v[58:59], v7 offset0:26 offset1:27
    s_waitcnt lgkmcnt(12)
    v_mfma_f32_32x32x16_bf16 v[12:27], v[104:107], v[72:75], v[12:27]
    v_subrev_u32 v7, 128, v7
    ds_read_b128 v[92:95], v6 offset:432
    ds_read2_b32 v[60:61], v7 offset0:0 offset1:1
    s_waitcnt lgkmcnt(12)
    ds_read2_b32 v[62:63], v7 offset0:2 offset1:3
    s_waitcnt lgkmcnt(12)
    v_mfma_f32_32x32x16_bf16 v[12:27], v[76:79], v[44:47], v[12:27]
    ds_read_b128 v[96:99], v6 offset:464
    ds_read2_b32 v[64:65], v7 offset0:8 offset1:9
    s_waitcnt lgkmcnt(12)
    ds_read2_b32 v[66:67], v7 offset0:10 offset1:11
    s_waitcnt lgkmcnt(12)
    v_mfma_f32_32x32x16_bf16 v[12:27], v[80:83], v[48:51], v[12:27]
    ds_read_b128 v[100:103], v6 offset:496
    ds_read2_b32 v[68:69], v7 offset0:16 offset1:17
    s_waitcnt lgkmcnt(12)
    ds_read2_b32 v[70:71], v7 offset0:18 offset1:19
    s_waitcnt lgkmcnt(12)
    v_mfma_f32_32x32x16_bf16 v[12:27], v[84:87], v[52:55], v[12:27]
    ds_read_b128 v[104:107], v6 offset:528
    ds_read2_b32 v[72:73], v7 offset0:24 offset1:25
    s_waitcnt lgkmcnt(12)
    ds_read2_b32 v[74:75], v7 offset0:26 offset1:27
    s_waitcnt lgkmcnt(12)
    v_mfma_f32_32x32x16_bf16 v[12:27], v[88:91], v[56:59], v[12:27]
    v_subrev_u32 v7, 128, v7
    ds_read_b128 v[76:79], v6 offset:576
    ds_read2_b32 v[44:45], v7 offset0:0 offset1:1
    s_waitcnt lgkmcnt(12)
    ds_read2_b32 v[46:47], v7 offset0:2 offset1:3
    s_waitcnt lgkmcnt(12)
    v_mfma_f32_32x32x16_bf16 v[12:27], v[92:95], v[60:63], v[12:27]
    ds_read_b128 v[80:83], v6 offset:608
    ds_read2_b32 v[48:49], v7 offset0:8 offset1:9
    s_waitcnt lgkmcnt(12)
    ds_read2_b32 v[50:51], v7 offset0:10 offset1:11
    s_waitcnt lgkmcnt(12)
    v_mfma_f32_32x32x16_bf16 v[12:27], v[96:99], v[64:67], v[12:27]
    ds_read_b128 v[84:87], v6 offset:640
    ds_read2_b32 v[52:53], v7 offset0:16 offset1:17
    s_waitcnt lgkmcnt(12)
    ds_read2_b32 v[54:55], v7 offset0:18 offset1:19
    s_waitcnt lgkmcnt(12)
    v_mfma_f32_32x32x16_bf16 v[12:27], v[100:103], v[68:71], v[12:27]
    ds_read_b128 v[88:91], v6 offset:672
    ds_read2_b32 v[56:57], v7 offset0:24 offset1:25
    s_waitcnt lgkmcnt(12)
    ds_read2_b32 v[58:59], v7 offset0:26 offset1:27
    s_waitcnt lgkmcnt(12)
    v_mfma_f32_32x32x16_bf16 v[12:27], v[104:107], v[72:75], v[12:27]
    v_subrev_u32 v7, 128, v7
    ds_read_b128 v[92:95], v6 offset:720
    ds_read2_b32 v[60:61], v7 offset0:0 offset1:1
    s_waitcnt lgkmcnt(12)
    ds_read2_b32 v[62:63], v7 offset0:2 offset1:3
    s_waitcnt lgkmcnt(12)
    v_mfma_f32_32x32x16_bf16 v[12:27], v[76:79], v[44:47], v[12:27]
    ds_read_b128 v[96:99], v6 offset:752
    ds_read2_b32 v[64:65], v7 offset0:8 offset1:9
    s_waitcnt lgkmcnt(12)
    ds_read2_b32 v[66:67], v7 offset0:10 offset1:11
    s_waitcnt lgkmcnt(12)
    v_mfma_f32_32x32x16_bf16 v[12:27], v[80:83], v[48:51], v[12:27]
    ds_read_b128 v[100:103], v6 offset:784
    ds_read2_b32 v[68:69], v7 offset0:16 offset1:17
    s_waitcnt lgkmcnt(12)
    ds_read2_b32 v[70:71], v7 offset0:18 offset1:19
    s_waitcnt lgkmcnt(12)
    v_mfma_f32_32x32x16_bf16 v[12:27], v[84:87], v[52:55], v[12:27]
    ds_read_b128 v[104:107], v6 offset:816
    ds_read2_b32 v[72:73], v7 offset0:24 offset1:25
    s_waitcnt lgkmcnt(12)
    ds_read2_b32 v[74:75], v7 offset0:26 offset1:27
    s_waitcnt lgkmcnt(12)
    v_mfma_f32_32x32x16_bf16 v[12:27], v[88:91], v[56:59], v[12:27]
    v_subrev_u32 v7, 128, v7
    ds_read_b128 v[76:79], v6 offset:864
    ds_read2_b32 v[44:45], v7 offset0:0 offset1:1
    s_waitcnt lgkmcnt(12)
    ds_read2_b32 v[46:47], v7 offset0:2 offset1:3
    s_waitcnt lgkmcnt(12)
    v_mfma_f32_32x32x16_bf16 v[12:27], v[92:95], v[60:63], v[12:27]
    ds_read_b128 v[80:83], v6 offset:896
    ds_read2_b32 v[48:49], v7 offset0:8 offset1:9
    s_waitcnt lgkmcnt(12)
    ds_read2_b32 v[50:51], v7 offset0:10 offset1:11
    s_waitcnt lgkmcnt(12)
    v_mfma_f32_32x32x16_bf16 v[12:27], v[96:99], v[64:67], v[12:27]
    ds_read_b128 v[84:87], v6 offset:928
    ds_read2_b32 v[52:53], v7 offset0:16 offset1:17
    s_waitcnt lgkmcnt(12)
    ds_read2_b32 v[54:55], v7 offset0:18 offset1:19
    s_waitcnt lgkmcnt(12)
    v_mfma_f32_32x32x16_bf16 v[12:27], v[100:103], v[68:71], v[12:27]
    ds_read_b128 v[88:91], v6 offset:960
    ds_read2_b32 v[56:57], v7 offset0:24 offset1:25
    s_waitcnt lgkmcnt(12)
    ds_read2_b32 v[58:59], v7 offset0:26 offset1:27
    s_waitcnt lgkmcnt(12)
    v_mfma_f32_32x32x16_bf16 v[12:27], v[104:107], v[72:75], v[12:27]
    v_subrev_u32 v7, 128, v7
    ds_read_b128 v[92:95], v6 offset:1008
    ds_read2_b32 v[60:61], v7 offset0:0 offset1:1
    s_waitcnt lgkmcnt(12)
    ds_read2_b32 v[62:63], v7 offset0:2 offset1:3
    s_waitcnt lgkmcnt(12)
    v_mfma_f32_32x32x16_bf16 v[12:27], v[76:79], v[44:47], v[12:27]
    ds_read_b128 v[96:99], v6 offset:1040
    ds_read2_b32 v[64:65], v7 offset0:8 offset1:9
    s_waitcnt lgkmcnt(12)
    ds_read2_b32 v[66:67], v7 offset0:10 offset1:11
    s_waitcnt lgkmcnt(12)
    v_mfma_f32_32x32x16_bf16 v[12:27], v[80:83], v[48:51], v[12:27]
    ds_read_b128 v[100:103], v6 offset:1072
    ds_read2_b32 v[68:69], v7 offset0:16 offset1:17
    s_waitcnt lgkmcnt(12)
    ds_read2_b32 v[70:71], v7 offset0:18 offset1:19
    s_waitcnt lgkmcnt(12)
    v_mfma_f32_32x32x16_bf16 v[12:27], v[84:87], v[52:55], v[12:27]
    ds_read_b128 v[104:107], v6 offset:1104
    ds_read2_b32 v[72:73], v7 offset0:24 offset1:25
    s_waitcnt lgkmcnt(12)
    ds_read2_b32 v[74:75], v7 offset0:26 offset1:27
    s_waitcnt lgkmcnt(12)
    v_mfma_f32_32x32x16_bf16 v[12:27], v[88:91], v[56:59], v[12:27]
    v_subrev_u32 v7, 128, v7
    ds_read_b128 v[76:79], v6 offset:1152
    ds_read2_b32 v[44:45], v7 offset0:0 offset1:1
    s_waitcnt lgkmcnt(12)
    ds_read2_b32 v[46:47], v7 offset0:2 offset1:3
    s_waitcnt lgkmcnt(12)
    v_mfma_f32_32x32x16_bf16 v[12:27], v[92:95], v[60:63], v[12:27]
    ds_read_b128 v[80:83], v6 offset:1184
    ds_read2_b32 v[48:49], v7 offset0:8 offset1:9
    s_waitcnt lgkmcnt(12)
    ds_read2_b32 v[50:51], v7 offset0:10 offset1:11
    s_waitcnt lgkmcnt(12)
    v_mfma_f32_32x32x16_bf16 v[12:27], v[96:99], v[64:67], v[12:27]
    ds_read_b128 v[84:87], v6 offset:1216
    ds_read2_b32 v[52:53], v7 offset0:16 offset1:17
    s_waitcnt lgkmcnt(12)
    ds_read2_b32 v[54:55], v7 offset0:18 offset1:19
    s_waitcnt lgkmcnt(12)
    v_mfma_f32_32x32x16_bf16 v[12:27], v[100:103], v[68:71], v[12:27]
    ds_read_b128 v[88:91], v6 offset:1248
    ds_read2_b32 v[56:57], v7 offset0:24 offset1:25
    s_waitcnt lgkmcnt(12)
    ds_read2_b32 v[58:59], v7 offset0:26 offset1:27
    s_waitcnt lgkmcnt(12)
    v_mfma_f32_32x32x16_bf16 v[12:27], v[104:107], v[72:75], v[12:27]
    v_subrev_u32 v7, 128, v7
    ds_read_b128 v[92:95], v6 offset:1296
    ds_read2_b32 v[60:61], v7 offset0:0 offset1:1
    s_waitcnt lgkmcnt(12)
    ds_read2_b32 v[62:63], v7 offset0:2 offset1:3
    s_waitcnt lgkmcnt(12)
    v_mfma_f32_32x32x16_bf16 v[12:27], v[76:79], v[44:47], v[12:27]
    ds_read_b128 v[96:99], v6 offset:1328
    ds_read2_b32 v[64:65], v7 offset0:8 offset1:9
    s_waitcnt lgkmcnt(12)
    ds_read2_b32 v[66:67], v7 offset0:10 offset1:11
    s_waitcnt lgkmcnt(12)
    v_mfma_f32_32x32x16_bf16 v[12:27], v[80:83], v[48:51], v[12:27]
    ds_read_b128 v[100:103], v6 offset:1360
    ds_read2_b32 v[68:69], v7 offset0:16 offset1:17
    s_waitcnt lgkmcnt(12)
    ds_read2_b32 v[70:71], v7 offset0:18 offset1:19
    s_waitcnt lgkmcnt(12)
    v_mfma_f32_32x32x16_bf16 v[12:27], v[84:87], v[52:55], v[12:27]
    ds_read_b128 v[104:107], v6 offset:1392
    ds_read2_b32 v[72:73], v7 offset0:24 offset1:25
    s_waitcnt lgkmcnt(12)
    ds_read2_b32 v[74:75], v7 offset0:26 offset1:27
    s_waitcnt lgkmcnt(12)
    v_mfma_f32_32x32x16_bf16 v[12:27], v[88:91], v[56:59], v[12:27]
    v_subrev_u32 v7, 128, v7
    ds_read_b128 v[76:79], v6 offset:1440
    ds_read2_b32 v[44:45], v7 offset0:0 offset1:1
    s_waitcnt lgkmcnt(12)
    ds_read2_b32 v[46:47], v7 offset0:2 offset1:3
    s_waitcnt lgkmcnt(12)
    v_mfma_f32_32x32x16_bf16 v[12:27], v[92:95], v[60:63], v[12:27]
    ds_read_b128 v[80:83], v6 offset:1472
    ds_read2_b32 v[48:49], v7 offset0:8 offset1:9
    s_waitcnt lgkmcnt(12)
    ds_read2_b32 v[50:51], v7 offset0:10 offset1:11
    s_waitcnt lgkmcnt(12)
    v_mfma_f32_32x32x16_bf16 v[12:27], v[96:99], v[64:67], v[12:27]
    ds_read_b128 v[84:87], v6 offset:1504
    ds_read2_b32 v[52:53], v7 offset0:16 offset1:17
    s_waitcnt lgkmcnt(12)
    ds_read2_b32 v[54:55], v7 offset0:18 offset1:19
    s_waitcnt lgkmcnt(12)
    v_mfma_f32_32x32x16_bf16 v[12:27], v[100:103], v[68:71], v[12:27]
    ds_read_b128 v[88:91], v6 offset:1536
    ds_read2_b32 v[56:57], v7 offset0:24 offset1:25
    s_waitcnt lgkmcnt(12)
    ds_read2_b32 v[58:59], v7 offset0:26 offset1:27
    s_waitcnt lgkmcnt(12)
    v_mfma_f32_32x32x16_bf16 v[12:27], v[104:107], v[72:75], v[12:27]
    v_subrev_u32 v7, 128, v7
    ds_read_b128 v[92:95], v6 offset:1584
    ds_read2_b32 v[60:61], v7 offset0:0 offset1:1
    s_waitcnt lgkmcnt(12)
    ds_read2_b32 v[62:63], v7 offset0:2 offset1:3
    s_waitcnt lgkmcnt(12)
    v_mfma_f32_32x32x16_bf16 v[12:27], v[76:79], v[44:47], v[12:27]
    ds_read_b128 v[96:99], v6 offset:1616
    ds_read2_b32 v[64:65], v7 offset0:8 offset1:9
    s_waitcnt lgkmcnt(12)
    ds_read2_b32 v[66:67], v7 offset0:10 offset1:11
    s_waitcnt lgkmcnt(12)
    v_mfma_f32_32x32x16_bf16 v[12:27], v[80:83], v[48:51], v[12:27]
    ds_read_b128 v[100:103], v6 offset:1648
    ds_read2_b32 v[68:69], v7 offset0:16 offset1:17
    s_waitcnt lgkmcnt(12)
    ds_read2_b32 v[70:71], v7 offset0:18 offset1:19
    s_waitcnt lgkmcnt(12)
    v_mfma_f32_32x32x16_bf16 v[12:27], v[84:87], v[52:55], v[12:27]
    ds_read_b128 v[104:107], v6 offset:1680
    ds_read2_b32 v[72:73], v7 offset0:24 offset1:25
    s_waitcnt lgkmcnt(12)
    ds_read2_b32 v[74:75], v7 offset0:26 offset1:27
    s_waitcnt lgkmcnt(12)
    v_mfma_f32_32x32x16_bf16 v[12:27], v[88:91], v[56:59], v[12:27]
    v_subrev_u32 v7, 128, v7
    ds_read_b128 v[76:79], v6 offset:1728
    ds_read2_b32 v[44:45], v7 offset0:0 offset1:1
    s_waitcnt lgkmcnt(12)
    ds_read2_b32 v[46:47], v7 offset0:2 offset1:3
    s_waitcnt lgkmcnt(12)
    v_mfma_f32_32x32x16_bf16 v[12:27], v[92:95], v[60:63], v[12:27]
    ds_read_b128 v[80:83], v6 offset:1760
    ds_read2_b32 v[48:49], v7 offset0:8 offset1:9
    s_waitcnt lgkmcnt(12)
    ds_read2_b32 v[50:51], v7 offset0:10 offset1:11
    s_waitcnt lgkmcnt(12)
    v_mfma_f32_32x32x16_bf16 v[12:27], v[96:99], v[64:67], v[12:27]
    ds_read_b128 v[84:87], v6 offset:1792
    ds_read2_b32 v[52:53], v7 offset0:16 offset1:17
    s_waitcnt lgkmcnt(12)
    ds_read2_b32 v[54:55], v7 offset0:18 offset1:19
    s_waitcnt lgkmcnt(12)
    v_mfma_f32_32x32x16_bf16 v[12:27], v[100:103], v[68:71], v[12:27]
    ds_read_b128 v[88:91], v6 offset:1824
    ds_read2_b32 v[56:57], v7 offset0:24 offset1:25
    s_waitcnt lgkmcnt(12)
    ds_read2_b32 v[58:59], v7 offset0:26 offset1:27
    s_waitcnt lgkmcnt(12)
    v_mfma_f32_32x32x16_bf16 v[12:27], v[104:107], v[72:75], v[12:27]
    v_subrev_u32 v7, 128, v7
    ds_read_b128 v[92:95], v6 offset:1872
    ds_read2_b32 v[60:61], v7 offset0:0 offset1:1
    s_waitcnt lgkmcnt(12)
    ds_read2_b32 v[62:63], v7 offset0:2 offset1:3
    s_waitcnt lgkmcnt(12)
    v_mfma_f32_32x32x16_bf16 v[12:27], v[76:79], v[44:47], v[12:27]
    ds_read_b128 v[96:99], v6 offset:1904
    ds_read2_b32 v[64:65], v7 offset0:8 offset1:9
    s_waitcnt lgkmcnt(12)
    ds_read2_b32 v[66:67], v7 offset0:10 offset1:11
    s_waitcnt lgkmcnt(12)
    v_mfma_f32_32x32x16_bf16 v[12:27], v[80:83], v[48:51], v[12:27]
    ds_read_b128 v[100:103], v6 offset:1936
    ds_read2_b32 v[68:69], v7 offset0:16 offset1:17
    s_waitcnt lgkmcnt(12)
    ds_read2_b32 v[70:71], v7 offset0:18 offset1:19
    s_waitcnt lgkmcnt(12)
    v_mfma_f32_32x32x16_bf16 v[12:27], v[84:87], v[52:55], v[12:27]
    ds_read_b128 v[104:107], v6 offset:1968
    ds_read2_b32 v[72:73], v7 offset0:24 offset1:25
    s_waitcnt lgkmcnt(12)
    ds_read2_b32 v[74:75], v7 offset0:26 offset1:27
    s_waitcnt lgkmcnt(12)
    v_mfma_f32_32x32x16_bf16 v[12:27], v[88:91], v[56:59], v[12:27]
    v_subrev_u32 v7, 128, v7
    ds_read_b128 v[76:79], v6 offset:2016
    ds_read2_b32 v[44:45], v7 offset0:0 offset1:1
    s_waitcnt lgkmcnt(12)
    ds_read2_b32 v[46:47], v7 offset0:2 offset1:3
    s_waitcnt lgkmcnt(12)
    v_mfma_f32_32x32x16_bf16 v[12:27], v[92:95], v[60:63], v[12:27]
    ds_read_b128 v[80:83], v6 offset:2048
    ds_read2_b32 v[48:49], v7 offset0:8 offset1:9
    s_waitcnt lgkmcnt(12)
    ds_read2_b32 v[50:51], v7 offset0:10 offset1:11
    s_waitcnt lgkmcnt(12)
    v_mfma_f32_32x32x16_bf16 v[12:27], v[96:99], v[64:67], v[12:27]
    ds_read_b128 v[84:87], v6 offset:2080
    ds_read2_b32 v[52:53], v7 offset0:16 offset1:17
    s_waitcnt lgkmcnt(12)
    ds_read2_b32 v[54:55], v7 offset0:18 offset1:19
    s_waitcnt lgkmcnt(12)
    v_mfma_f32_32x32x16_bf16 v[12:27], v[100:103], v[68:71], v[12:27]
    ds_read_b128 v[88:91], v6 offset:2112
    ds_read2_b32 v[56:57], v7 offset0:24 offset1:25
    s_waitcnt lgkmcnt(12)
    ds_read2_b32 v[58:59], v7 offset0:26 offset1:27
    s_waitcnt lgkmcnt(12)
    v_mfma_f32_32x32x16_bf16 v[12:27], v[104:107], v[72:75], v[12:27]
    v_subrev_u32 v7, 128, v7
    ds_read_b128 v[92:95], v6 offset:2160
    ds_read2_b32 v[60:61], v7 offset0:0 offset1:1
    s_waitcnt lgkmcnt(12)
    ds_read2_b32 v[62:63], v7 offset0:2 offset1:3
    s_waitcnt lgkmcnt(12)
    v_mfma_f32_32x32x16_bf16 v[12:27], v[76:79], v[44:47], v[12:27]
    ds_read_b128 v[96:99], v6 offset:2192
    ds_read2_b32 v[64:65], v7 offset0:8 offset1:9
    s_waitcnt lgkmcnt(12)
    ds_read2_b32 v[66:67], v7 offset0:10 offset1:11
    s_waitcnt lgkmcnt(12)
    v_mfma_f32_32x32x16_bf16 v[12:27], v[80:83], v[48:51], v[12:27]
    ds_read_b128 v[100:103], v6 offset:2224
    ds_read2_b32 v[68:69], v7 offset0:16 offset1:17
    s_waitcnt lgkmcnt(12)
    ds_read2_b32 v[70:71], v7 offset0:18 offset1:19
    s_waitcnt lgkmcnt(12)
    v_mfma_f32_32x32x16_bf16 v[12:27], v[84:87], v[52:55], v[12:27]
    ds_read_b128 v[104:107], v6 offset:2256
    ds_read2_b32 v[72:73], v7 offset0:24 offset1:25
    s_waitcnt lgkmcnt(12)
    ds_read2_b32 v[74:75], v7 offset0:26 offset1:27
    s_waitcnt lgkmcnt(12)
    v_mfma_f32_32x32x16_bf16 v[12:27], v[88:91], v[56:59], v[12:27]
    v_subrev_u32 v7, 128, v7
    ds_read_b128 v[76:79], v6 offset:2304
    ds_read2_b32 v[44:45], v7 offset0:0 offset1:1
    s_waitcnt lgkmcnt(12)
    ds_read2_b32 v[46:47], v7 offset0:2 offset1:3
    s_waitcnt lgkmcnt(12)
    v_mfma_f32_32x32x16_bf16 v[12:27], v[92:95], v[60:63], v[12:27]
    ds_read_b128 v[80:83], v6 offset:2336
    ds_read2_b32 v[48:49], v7 offset0:8 offset1:9
    s_waitcnt lgkmcnt(12)
    ds_read2_b32 v[50:51], v7 offset0:10 offset1:11
    s_waitcnt lgkmcnt(12)
    v_mfma_f32_32x32x16_bf16 v[12:27], v[96:99], v[64:67], v[12:27]
    ds_read_b128 v[84:87], v6 offset:2368
    ds_read2_b32 v[52:53], v7 offset0:16 offset1:17
    s_waitcnt lgkmcnt(12)
    ds_read2_b32 v[54:55], v7 offset0:18 offset1:19
    s_waitcnt lgkmcnt(12)
    v_mfma_f32_32x32x16_bf16 v[12:27], v[100:103], v[68:71], v[12:27]
    ds_read_b128 v[88:91], v6 offset:2400
    ds_read2_b32 v[56:57], v7 offset0:24 offset1:25
    s_waitcnt lgkmcnt(12)
    ds_read2_b32 v[58:59], v7 offset0:26 offset1:27
    s_waitcnt lgkmcnt(12)
    v_mfma_f32_32x32x16_bf16 v[12:27], v[104:107], v[72:75], v[12:27]
    v_subrev_u32 v7, 128, v7
    ds_read_b128 v[92:95], v6 offset:2448
    ds_read2_b32 v[60:61], v7 offset0:0 offset1:1
    s_waitcnt lgkmcnt(12)
    ds_read2_b32 v[62:63], v7 offset0:2 offset1:3
    s_waitcnt lgkmcnt(12)
    v_mfma_f32_32x32x16_bf16 v[12:27], v[76:79], v[44:47], v[12:27]
    ds_read_b128 v[96:99], v6 offset:2480
    ds_read2_b32 v[64:65], v7 offset0:8 offset1:9
    s_waitcnt lgkmcnt(12)
    ds_read2_b32 v[66:67], v7 offset0:10 offset1:11
    s_waitcnt lgkmcnt(12)
    v_mfma_f32_32x32x16_bf16 v[12:27], v[80:83], v[48:51], v[12:27]
    ds_read_b128 v[100:103], v6 offset:2512
    ds_read2_b32 v[68:69], v7 offset0:16 offset1:17
    s_waitcnt lgkmcnt(12)
    ds_read2_b32 v[70:71], v7 offset0:18 offset1:19
    s_waitcnt lgkmcnt(12)
    v_mfma_f32_32x32x16_bf16 v[12:27], v[84:87], v[52:55], v[12:27]
    ds_read_b128 v[104:107], v6 offset:2544
    ds_read2_b32 v[72:73], v7 offset0:24 offset1:25
    s_waitcnt lgkmcnt(12)
    ds_read2_b32 v[74:75], v7 offset0:26 offset1:27
    s_waitcnt lgkmcnt(12)
    v_mfma_f32_32x32x16_bf16 v[12:27], v[88:91], v[56:59], v[12:27]
    v_subrev_u32 v7, 128, v7
    ds_read_b128 v[76:79], v6 offset:2592
    ds_read2_b32 v[44:45], v7 offset0:0 offset1:1
    s_waitcnt lgkmcnt(12)
    ds_read2_b32 v[46:47], v7 offset0:2 offset1:3
    s_waitcnt lgkmcnt(12)
    v_mfma_f32_32x32x16_bf16 v[12:27], v[92:95], v[60:63], v[12:27]
    ds_read_b128 v[80:83], v6 offset:2624
    ds_read2_b32 v[48:49], v7 offset0:8 offset1:9
    s_waitcnt lgkmcnt(12)
    ds_read2_b32 v[50:51], v7 offset0:10 offset1:11
    s_waitcnt lgkmcnt(12)
    v_mfma_f32_32x32x16_bf16 v[12:27], v[96:99], v[64:67], v[12:27]
    ds_read_b128 v[84:87], v6 offset:2656
    ds_read2_b32 v[52:53], v7 offset0:16 offset1:17
    s_waitcnt lgkmcnt(12)
    ds_read2_b32 v[54:55], v7 offset0:18 offset1:19
    s_waitcnt lgkmcnt(12)
    v_mfma_f32_32x32x16_bf16 v[12:27], v[100:103], v[68:71], v[12:27]
    ds_read_b128 v[88:91], v6 offset:2688
    ds_read2_b32 v[56:57], v7 offset0:24 offset1:25
    s_waitcnt lgkmcnt(12)
    ds_read2_b32 v[58:59], v7 offset0:26 offset1:27
    s_waitcnt lgkmcnt(12)
    v_mfma_f32_32x32x16_bf16 v[12:27], v[104:107], v[72:75], v[12:27]
    v_subrev_u32 v7, 128, v7
    ds_read_b128 v[92:95], v6 offset:2736
    ds_read2_b32 v[60:61], v7 offset0:0 offset1:1
    s_waitcnt lgkmcnt(12)
    ds_read2_b32 v[62:63], v7 offset0:2 offset1:3
    s_waitcnt lgkmcnt(12)
    v_mfma_f32_32x32x16_bf16 v[12:27], v[76:79], v[44:47], v[12:27]
    ds_read_b128 v[96:99], v6 offset:2768
    ds_read2_b32 v[64:65], v7 offset0:8 offset1:9
    s_waitcnt lgkmcnt(12)
    ds_read2_b32 v[66:67], v7 offset0:10 offset1:11
    s_waitcnt lgkmcnt(12)
    v_mfma_f32_32x32x16_bf16 v[12:27], v[80:83], v[48:51], v[12:27]
    ds_read_b128 v[100:103], v6 offset:2800
    ds_read2_b32 v[68:69], v7 offset0:16 offset1:17
    s_waitcnt lgkmcnt(12)
    ds_read2_b32 v[70:71], v7 offset0:18 offset1:19
    s_waitcnt lgkmcnt(12)
    v_mfma_f32_32x32x16_bf16 v[12:27], v[84:87], v[52:55], v[12:27]
    ds_read_b128 v[104:107], v6 offset:2832
    ds_read2_b32 v[72:73], v7 offset0:24 offset1:25
    s_waitcnt lgkmcnt(12)
    ds_read2_b32 v[74:75], v7 offset0:26 offset1:27
    s_waitcnt lgkmcnt(12)
    v_mfma_f32_32x32x16_bf16 v[12:27], v[88:91], v[56:59], v[12:27]
    v_subrev_u32 v7, 128, v7
    ds_read_b128 v[76:79], v6 offset:2880
    ds_read2_b32 v[44:45], v7 offset0:0 offset1:1
    s_waitcnt lgkmcnt(12)
    ds_read2_b32 v[46:47], v7 offset0:2 offset1:3
    s_waitcnt lgkmcnt(12)
    v_mfma_f32_32x32x16_bf16 v[12:27], v[92:95], v[60:63], v[12:27]
    ds_read_b128 v[80:83], v6 offset:2912
    ds_read2_b32 v[48:49], v7 offset0:8 offset1:9
    s_waitcnt lgkmcnt(12)
    ds_read2_b32 v[50:51], v7 offset0:10 offset1:11
    s_waitcnt lgkmcnt(12)
    v_mfma_f32_32x32x16_bf16 v[12:27], v[96:99], v[64:67], v[12:27]
    ds_read_b128 v[84:87], v6 offset:2944
    ds_read2_b32 v[52:53], v7 offset0:16 offset1:17
    s_waitcnt lgkmcnt(12)
    ds_read2_b32 v[54:55], v7 offset0:18 offset1:19
    s_waitcnt lgkmcnt(12)
    v_mfma_f32_32x32x16_bf16 v[12:27], v[100:103], v[68:71], v[12:27]
    ds_read_b128 v[88:91], v6 offset:2976
    ds_read2_b32 v[56:57], v7 offset0:24 offset1:25
    s_waitcnt lgkmcnt(12)
    ds_read2_b32 v[58:59], v7 offset0:26 offset1:27
    s_waitcnt lgkmcnt(12)
    v_mfma_f32_32x32x16_bf16 v[12:27], v[104:107], v[72:75], v[12:27]
    v_subrev_u32 v7, 128, v7
    ds_read_b128 v[92:95], v6 offset:3024
    ds_read2_b32 v[60:61], v7 offset0:0 offset1:1
    s_waitcnt lgkmcnt(12)
    ds_read2_b32 v[62:63], v7 offset0:2 offset1:3
    s_waitcnt lgkmcnt(12)
    v_mfma_f32_32x32x16_bf16 v[12:27], v[76:79], v[44:47], v[12:27]
    ds_read_b128 v[96:99], v6 offset:3056
    ds_read2_b32 v[64:65], v7 offset0:8 offset1:9
    s_waitcnt lgkmcnt(12)
    ds_read2_b32 v[66:67], v7 offset0:10 offset1:11
    s_waitcnt lgkmcnt(12)
    v_mfma_f32_32x32x16_bf16 v[12:27], v[80:83], v[48:51], v[12:27]
    ds_read_b128 v[100:103], v6 offset:3088
    ds_read2_b32 v[68:69], v7 offset0:16 offset1:17
    s_waitcnt lgkmcnt(12)
    ds_read2_b32 v[70:71], v7 offset0:18 offset1:19
    s_waitcnt lgkmcnt(12)
    v_mfma_f32_32x32x16_bf16 v[12:27], v[84:87], v[52:55], v[12:27]
    ds_read_b128 v[104:107], v6 offset:3120
    ds_read2_b32 v[72:73], v7 offset0:24 offset1:25
    s_waitcnt lgkmcnt(12)
    ds_read2_b32 v[74:75], v7 offset0:26 offset1:27
    s_waitcnt lgkmcnt(12)
    v_mfma_f32_32x32x16_bf16 v[12:27], v[88:91], v[56:59], v[12:27]
    v_subrev_u32 v7, 128, v7
    ds_read_b128 v[76:79], v6 offset:3168
    ds_read2_b32 v[44:45], v7 offset0:0 offset1:1
    s_waitcnt lgkmcnt(12)
    ds_read2_b32 v[46:47], v7 offset0:2 offset1:3
    s_waitcnt lgkmcnt(12)
    v_mfma_f32_32x32x16_bf16 v[12:27], v[92:95], v[60:63], v[12:27]
    ds_read_b128 v[80:83], v6 offset:3200
    ds_read2_b32 v[48:49], v7 offset0:8 offset1:9
    s_waitcnt lgkmcnt(12)
    ds_read2_b32 v[50:51], v7 offset0:10 offset1:11
    s_waitcnt lgkmcnt(12)
    v_mfma_f32_32x32x16_bf16 v[12:27], v[96:99], v[64:67], v[12:27]
    ds_read_b128 v[84:87], v6 offset:3232
    ds_read2_b32 v[52:53], v7 offset0:16 offset1:17
    s_waitcnt lgkmcnt(12)
    ds_read2_b32 v[54:55], v7 offset0:18 offset1:19
    s_waitcnt lgkmcnt(12)
    v_mfma_f32_32x32x16_bf16 v[12:27], v[100:103], v[68:71], v[12:27]
    ds_read_b128 v[88:91], v6 offset:3264
    ds_read2_b32 v[56:57], v7 offset0:24 offset1:25
    s_waitcnt lgkmcnt(12)
    ds_read2_b32 v[58:59], v7 offset0:26 offset1:27
    s_waitcnt lgkmcnt(12)
    v_mfma_f32_32x32x16_bf16 v[12:27], v[104:107], v[72:75], v[12:27]
    v_subrev_u32 v7, 128, v7
    ds_read_b128 v[92:95], v6 offset:3312
    ds_read2_b32 v[60:61], v7 offset0:0 offset1:1
    s_waitcnt lgkmcnt(12)
    ds_read2_b32 v[62:63], v7 offset0:2 offset1:3
    s_waitcnt lgkmcnt(12)
    v_mfma_f32_32x32x16_bf16 v[12:27], v[76:79], v[44:47], v[12:27]
    ds_read_b128 v[96:99], v6 offset:3344
    ds_read2_b32 v[64:65], v7 offset0:8 offset1:9
    s_waitcnt lgkmcnt(12)
    ds_read2_b32 v[66:67], v7 offset0:10 offset1:11
    s_waitcnt lgkmcnt(12)
    v_mfma_f32_32x32x16_bf16 v[12:27], v[80:83], v[48:51], v[12:27]
    ds_read_b128 v[100:103], v6 offset:3376
    ds_read2_b32 v[68:69], v7 offset0:16 offset1:17
    s_waitcnt lgkmcnt(12)
    ds_read2_b32 v[70:71], v7 offset0:18 offset1:19
    s_waitcnt lgkmcnt(12)
    v_mfma_f32_32x32x16_bf16 v[12:27], v[84:87], v[52:55], v[12:27]
    ds_read_b128 v[104:107], v6 offset:3408
    ds_read2_b32 v[72:73], v7 offset0:24 offset1:25
    s_waitcnt lgkmcnt(12)
    ds_read2_b32 v[74:75], v7 offset0:26 offset1:27
    s_waitcnt lgkmcnt(12)
    v_mfma_f32_32x32x16_bf16 v[12:27], v[88:91], v[56:59], v[12:27]
    v_subrev_u32 v7, 128, v7
    ds_read_b128 v[76:79], v6 offset:3456
    ds_read2_b32 v[44:45], v7 offset0:0 offset1:1
    s_waitcnt lgkmcnt(12)
    ds_read2_b32 v[46:47], v7 offset0:2 offset1:3
    s_waitcnt lgkmcnt(12)
    v_mfma_f32_32x32x16_bf16 v[12:27], v[92:95], v[60:63], v[12:27]
    ds_read_b128 v[80:83], v6 offset:3488
    ds_read2_b32 v[48:49], v7 offset0:8 offset1:9
    s_waitcnt lgkmcnt(12)
    ds_read2_b32 v[50:51], v7 offset0:10 offset1:11
    s_waitcnt lgkmcnt(12)
    v_mfma_f32_32x32x16_bf16 v[12:27], v[96:99], v[64:67], v[12:27]
    ds_read_b128 v[84:87], v6 offset:3520
    ds_read2_b32 v[52:53], v7 offset0:16 offset1:17
    s_waitcnt lgkmcnt(12)
    ds_read2_b32 v[54:55], v7 offset0:18 offset1:19
    s_waitcnt lgkmcnt(12)
    v_mfma_f32_32x32x16_bf16 v[12:27], v[100:103], v[68:71], v[12:27]
    ds_read_b128 v[88:91], v6 offset:3552
    ds_read2_b32 v[56:57], v7 offset0:24 offset1:25
    s_waitcnt lgkmcnt(12)
    ds_read2_b32 v[58:59], v7 offset0:26 offset1:27
    s_waitcnt lgkmcnt(12)
    v_mfma_f32_32x32x16_bf16 v[12:27], v[104:107], v[72:75], v[12:27]
    v_subrev_u32 v7, 128, v7
    ds_read_b128 v[92:95], v6 offset:3600
    ds_read2_b32 v[60:61], v7 offset0:0 offset1:1
    s_waitcnt lgkmcnt(12)
    ds_read2_b32 v[62:63], v7 offset0:2 offset1:3
    s_waitcnt lgkmcnt(12)
    v_mfma_f32_32x32x16_bf16 v[12:27], v[76:79], v[44:47], v[12:27]
    ds_read_b128 v[96:99], v6 offset:3632
    ds_read2_b32 v[64:65], v7 offset0:8 offset1:9
    s_waitcnt lgkmcnt(12)
    ds_read2_b32 v[66:67], v7 offset0:10 offset1:11
    s_waitcnt lgkmcnt(12)
    v_mfma_f32_32x32x16_bf16 v[12:27], v[80:83], v[48:51], v[12:27]
    ds_read_b128 v[100:103], v6 offset:3664
    ds_read2_b32 v[68:69], v7 offset0:16 offset1:17
    s_waitcnt lgkmcnt(12)
    ds_read2_b32 v[70:71], v7 offset0:18 offset1:19
    s_waitcnt lgkmcnt(12)
    v_mfma_f32_32x32x16_bf16 v[12:27], v[84:87], v[52:55], v[12:27]
    ds_read_b128 v[104:107], v6 offset:3696
    ds_read2_b32 v[72:73], v7 offset0:24 offset1:25
    s_waitcnt lgkmcnt(12)
    ds_read2_b32 v[74:75], v7 offset0:26 offset1:27
    s_waitcnt lgkmcnt(12)
    v_mfma_f32_32x32x16_bf16 v[12:27], v[88:91], v[56:59], v[12:27]
    v_subrev_u32 v7, 128, v7
    ds_read_b128 v[76:79], v6 offset:3744
    ds_read2_b32 v[44:45], v7 offset0:0 offset1:1
    s_waitcnt lgkmcnt(12)
    ds_read2_b32 v[46:47], v7 offset0:2 offset1:3
    s_waitcnt lgkmcnt(12)
    v_mfma_f32_32x32x16_bf16 v[12:27], v[92:95], v[60:63], v[12:27]
    ds_read_b128 v[80:83], v6 offset:3776
    ds_read2_b32 v[48:49], v7 offset0:8 offset1:9
    s_waitcnt lgkmcnt(12)
    ds_read2_b32 v[50:51], v7 offset0:10 offset1:11
    s_waitcnt lgkmcnt(12)
    v_mfma_f32_32x32x16_bf16 v[12:27], v[96:99], v[64:67], v[12:27]
    ds_read_b128 v[84:87], v6 offset:3808
    ds_read2_b32 v[52:53], v7 offset0:16 offset1:17
    s_waitcnt lgkmcnt(12)
    ds_read2_b32 v[54:55], v7 offset0:18 offset1:19
    s_waitcnt lgkmcnt(12)
    v_mfma_f32_32x32x16_bf16 v[12:27], v[100:103], v[68:71], v[12:27]
    ds_read_b128 v[88:91], v6 offset:3840
    ds_read2_b32 v[56:57], v7 offset0:24 offset1:25
    s_waitcnt lgkmcnt(12)
    ds_read2_b32 v[58:59], v7 offset0:26 offset1:27
    s_waitcnt lgkmcnt(12)
    v_mfma_f32_32x32x16_bf16 v[12:27], v[104:107], v[72:75], v[12:27]
    v_subrev_u32 v7, 128, v7
    ds_read_b128 v[92:95], v6 offset:3888
    ds_read2_b32 v[60:61], v7 offset0:0 offset1:1
    s_waitcnt lgkmcnt(12)
    ds_read2_b32 v[62:63], v7 offset0:2 offset1:3
    s_waitcnt lgkmcnt(12)
    v_mfma_f32_32x32x16_bf16 v[12:27], v[76:79], v[44:47], v[12:27]
    ds_read_b128 v[96:99], v6 offset:3920
    ds_read2_b32 v[64:65], v7 offset0:8 offset1:9
    s_waitcnt lgkmcnt(12)
    ds_read2_b32 v[66:67], v7 offset0:10 offset1:11
    s_waitcnt lgkmcnt(12)
    v_mfma_f32_32x32x16_bf16 v[12:27], v[80:83], v[48:51], v[12:27]
    ds_read_b128 v[100:103], v6 offset:3952
    ds_read2_b32 v[68:69], v7 offset0:16 offset1:17
    s_waitcnt lgkmcnt(12)
    ds_read2_b32 v[70:71], v7 offset0:18 offset1:19
    s_waitcnt lgkmcnt(12)
    v_mfma_f32_32x32x16_bf16 v[12:27], v[84:87], v[52:55], v[12:27]
    ds_read_b128 v[104:107], v6 offset:3984
    ds_read2_b32 v[72:73], v7 offset0:24 offset1:25
    s_waitcnt lgkmcnt(12)
    ds_read2_b32 v[74:75], v7 offset0:26 offset1:27
    s_waitcnt lgkmcnt(12)
    v_mfma_f32_32x32x16_bf16 v[12:27], v[88:91], v[56:59], v[12:27]
    v_subrev_u32 v7, 128, v7
    ds_read_b128 v[76:79], v6 offset:4032
    ds_read2_b32 v[44:45], v7 offset0:0 offset1:1
    s_waitcnt lgkmcnt(12)
    ds_read2_b32 v[46:47], v7 offset0:2 offset1:3
    s_waitcnt lgkmcnt(12)
    v_mfma_f32_32x32x16_bf16 v[12:27], v[92:95], v[60:63], v[12:27]
    ds_read_b128 v[80:83], v6 offset:4064
    ds_read2_b32 v[48:49], v7 offset0:8 offset1:9
    s_waitcnt lgkmcnt(12)
    ds_read2_b32 v[50:51], v7 offset0:10 offset1:11
    s_waitcnt lgkmcnt(12)
    v_mfma_f32_32x32x16_bf16 v[12:27], v[96:99], v[64:67], v[12:27]
    ds_read_b128 v[84:87], v6 offset:4096
    ds_read2_b32 v[52:53], v7 offset0:16 offset1:17
    s_waitcnt lgkmcnt(12)
    ds_read2_b32 v[54:55], v7 offset0:18 offset1:19
    s_waitcnt lgkmcnt(12)
    v_mfma_f32_32x32x16_bf16 v[12:27], v[100:103], v[68:71], v[12:27]
    ds_read_b128 v[88:91], v6 offset:4128
    ds_read2_b32 v[56:57], v7 offset0:24 offset1:25
    s_waitcnt lgkmcnt(12)
    ds_read2_b32 v[58:59], v7 offset0:26 offset1:27
    s_waitcnt lgkmcnt(12)
    v_mfma_f32_32x32x16_bf16 v[12:27], v[104:107], v[72:75], v[12:27]
    v_subrev_u32 v7, 128, v7
    ds_read_b128 v[92:95], v6 offset:4176
    ds_read2_b32 v[60:61], v7 offset0:0 offset1:1
    s_waitcnt lgkmcnt(12)
    ds_read2_b32 v[62:63], v7 offset0:2 offset1:3
    s_waitcnt lgkmcnt(12)
    v_mfma_f32_32x32x16_bf16 v[12:27], v[76:79], v[44:47], v[12:27]
    ds_read_b128 v[96:99], v6 offset:4208
    ds_read2_b32 v[64:65], v7 offset0:8 offset1:9
    s_waitcnt lgkmcnt(12)
    ds_read2_b32 v[66:67], v7 offset0:10 offset1:11
    s_waitcnt lgkmcnt(12)
    v_mfma_f32_32x32x16_bf16 v[12:27], v[80:83], v[48:51], v[12:27]
    ds_read_b128 v[100:103], v6 offset:4240
    ds_read2_b32 v[68:69], v7 offset0:16 offset1:17
    s_waitcnt lgkmcnt(12)
    ds_read2_b32 v[70:71], v7 offset0:18 offset1:19
    s_waitcnt lgkmcnt(12)
    v_mfma_f32_32x32x16_bf16 v[12:27], v[84:87], v[52:55], v[12:27]
    ds_read_b128 v[104:107], v6 offset:4272
    ds_read2_b32 v[72:73], v7 offset0:24 offset1:25
    s_waitcnt lgkmcnt(12)
    ds_read2_b32 v[74:75], v7 offset0:26 offset1:27
    s_waitcnt lgkmcnt(12)
    v_mfma_f32_32x32x16_bf16 v[12:27], v[88:91], v[56:59], v[12:27]
    v_subrev_u32 v7, 128, v7
    ds_read_b128 v[76:79], v6 offset:4320
    ds_read2_b32 v[44:45], v7 offset0:0 offset1:1
    s_waitcnt lgkmcnt(12)
    ds_read2_b32 v[46:47], v7 offset0:2 offset1:3
    s_waitcnt lgkmcnt(12)
    v_mfma_f32_32x32x16_bf16 v[12:27], v[92:95], v[60:63], v[12:27]
    ds_read_b128 v[80:83], v6 offset:4352
    ds_read2_b32 v[48:49], v7 offset0:8 offset1:9
    s_waitcnt lgkmcnt(12)
    ds_read2_b32 v[50:51], v7 offset0:10 offset1:11
    s_waitcnt lgkmcnt(12)
    v_mfma_f32_32x32x16_bf16 v[12:27], v[96:99], v[64:67], v[12:27]
    ds_read_b128 v[84:87], v6 offset:4384
    ds_read2_b32 v[52:53], v7 offset0:16 offset1:17
    s_waitcnt lgkmcnt(12)
    ds_read2_b32 v[54:55], v7 offset0:18 offset1:19
    s_waitcnt lgkmcnt(12)
    v_mfma_f32_32x32x16_bf16 v[12:27], v[100:103], v[68:71], v[12:27]
    ds_read_b128 v[88:91], v6 offset:4416
    ds_read2_b32 v[56:57], v7 offset0:24 offset1:25
    s_waitcnt lgkmcnt(12)
    ds_read2_b32 v[58:59], v7 offset0:26 offset1:27
    s_waitcnt lgkmcnt(12)
    v_mfma_f32_32x32x16_bf16 v[12:27], v[104:107], v[72:75], v[12:27]
    v_subrev_u32 v7, 128, v7
    ds_read_b128 v[92:95], v6 offset:4464
    ds_read2_b32 v[60:61], v7 offset0:0 offset1:1
    s_waitcnt lgkmcnt(12)
    ds_read2_b32 v[62:63], v7 offset0:2 offset1:3
    s_waitcnt lgkmcnt(12)
    v_mfma_f32_32x32x16_bf16 v[12:27], v[76:79], v[44:47], v[12:27]
    ds_read_b128 v[96:99], v6 offset:4496
    ds_read2_b32 v[64:65], v7 offset0:8 offset1:9
    s_waitcnt lgkmcnt(12)
    ds_read2_b32 v[66:67], v7 offset0:10 offset1:11
    s_waitcnt lgkmcnt(12)
    v_mfma_f32_32x32x16_bf16 v[12:27], v[80:83], v[48:51], v[12:27]
    ds_read_b128 v[100:103], v6 offset:4528
    ds_read2_b32 v[68:69], v7 offset0:16 offset1:17
    s_waitcnt lgkmcnt(12)
    ds_read2_b32 v[70:71], v7 offset0:18 offset1:19
    s_waitcnt lgkmcnt(12)
    v_mfma_f32_32x32x16_bf16 v[12:27], v[84:87], v[52:55], v[12:27]
    ds_read_b128 v[104:107], v6 offset:4560
    ds_read2_b32 v[72:73], v7 offset0:24 offset1:25
    s_waitcnt lgkmcnt(12)
    ds_read2_b32 v[74:75], v7 offset0:26 offset1:27
    s_waitcnt lgkmcnt(12)
    v_mfma_f32_32x32x16_bf16 v[12:27], v[88:91], v[56:59], v[12:27]
    s_waitcnt lgkmcnt(9)
    v_mfma_f32_32x32x16_bf16 v[12:27], v[92:95], v[60:63], v[12:27]
    s_waitcnt lgkmcnt(6)
    v_mfma_f32_32x32x16_bf16 v[12:27], v[96:99], v[64:67], v[12:27]
    s_waitcnt lgkmcnt(3)
    v_mfma_f32_32x32x16_bf16 v[12:27], v[100:103], v[68:71], v[12:27]
    s_waitcnt lgkmcnt(0)
    v_mfma_f32_32x32x16_bf16 v[12:27], v[104:107], v[72:75], v[12:27]
    v_mul_u32_u24 v6, 576, v9
    v_lshlrev_b32 v3, 1, v10
    v_sub_u32 v6, v3, v6
    v_add_u32 v6, 131648, v6
    s_lshl_b32 s63, s61, 6
    v_add_u32 v6, s63, v6
    v_lshlrev_b32 v7, 9, v9
    v_lshl_add_u32 v7, v10, 1, v7
    v_add_u32 v7, s63, v7
    s_lshl_b32 s63, s62, 12
    s_add_u32 s63, s63, 10485760
    ds_read_u16 v76, v6 offset:3888
    ds_read_u16 v77, v6 offset:3744
    ds_read_u16 v78, v6 offset:3600
    ds_read_u16 v79, v6 offset:3456
    ds_read_u16 v80, v6 offset:2736
    ds_read_u16 v81, v6 offset:2592
    ds_read_u16 v82, v6 offset:2448
    ds_read_u16 v83, v6 offset:2304
    ds_read_u16 v84, v6 offset:1584
    ds_read_u16 v85, v6 offset:1440
    ds_read_u16 v86, v6 offset:1296
    ds_read_u16 v87, v6 offset:1152
    ds_read_u16 v88, v6 offset:432
    ds_read_u16 v89, v6 offset:288
    s_waitcnt lgkmcnt(12)
    ds_read_u16 v90, v6 offset:144
    ds_read_u16 v91, v6 offset:0
    v_lshlrev_b32 v76, 16, v76
    v_lshlrev_b32 v77, 16, v77
    v_mul_f32 v76, v76, v8
    v_mul_f32 v77, v77, v8
    v_cvt_pk_bf16_f32 v44, v76, v77
    v_lshlrev_b32 v76, 16, v44
    v_and_b32 v77, 0xffff0000, v44
    v_cvt_pk_bf16_f32 v45, v12, v13
    v_lshlrev_b32 v46, 16, v45
    v_and_b32 v47, 0xffff0000, v45
    v_add_f32 v46, v46, v76
    v_add_f32 v47, v47, v77
    v_cvt_pk_bf16_f32 v44, v46, v47
    buffer_store_short v44, v7, s[48:51], s63 offen offset:0
    buffer_store_short_d16_hi v44, v7, s[48:51], s63 offen offset:128
    s_waitcnt lgkmcnt(13)
    v_lshlrev_b32 v78, 16, v78
    s_waitcnt lgkmcnt(12)
    v_lshlrev_b32 v79, 16, v79
    v_mul_f32 v78, v78, v8
    v_mul_f32 v79, v79, v8
    v_cvt_pk_bf16_f32 v44, v78, v79
    v_lshlrev_b32 v78, 16, v44
    v_and_b32 v79, 0xffff0000, v44
    v_cvt_pk_bf16_f32 v45, v14, v15
    v_lshlrev_b32 v46, 16, v45
    v_and_b32 v47, 0xffff0000, v45
    v_add_f32 v46, v46, v78
    v_add_f32 v47, v47, v79
    v_cvt_pk_bf16_f32 v44, v46, v47
    buffer_store_short v44, v7, s[48:51], s63 offen offset:256
    buffer_store_short_d16_hi v44, v7, s[48:51], s63 offen offset:384
    s_waitcnt lgkmcnt(11)
    v_lshlrev_b32 v80, 16, v80
    s_waitcnt lgkmcnt(10)
    v_lshlrev_b32 v81, 16, v81
    v_mul_f32 v80, v80, v8
    v_mul_f32 v81, v81, v8
    v_cvt_pk_bf16_f32 v44, v80, v81
    v_lshlrev_b32 v80, 16, v44
    v_and_b32 v81, 0xffff0000, v44
    v_cvt_pk_bf16_f32 v45, v16, v17
    v_lshlrev_b32 v46, 16, v45
    v_and_b32 v47, 0xffff0000, v45
    v_add_f32 v46, v46, v80
    v_add_f32 v47, v47, v81
    v_cvt_pk_bf16_f32 v44, v46, v47
    buffer_store_short v44, v7, s[48:51], s63 offen offset:1024
    buffer_store_short_d16_hi v44, v7, s[48:51], s63 offen offset:1152
    s_waitcnt lgkmcnt(9)
    v_lshlrev_b32 v82, 16, v82
    s_waitcnt lgkmcnt(8)
    v_lshlrev_b32 v83, 16, v83
    v_mul_f32 v82, v82, v8
    v_mul_f32 v83, v83, v8
    v_cvt_pk_bf16_f32 v44, v82, v83
    v_lshlrev_b32 v82, 16, v44
    v_and_b32 v83, 0xffff0000, v44
    v_cvt_pk_bf16_f32 v45, v18, v19
    v_lshlrev_b32 v46, 16, v45
    v_and_b32 v47, 0xffff0000, v45
    v_add_f32 v46, v46, v82
    v_add_f32 v47, v47, v83
    v_cvt_pk_bf16_f32 v44, v46, v47
    buffer_store_short v44, v7, s[48:51], s63 offen offset:1280
    buffer_store_short_d16_hi v44, v7, s[48:51], s63 offen offset:1408
    s_waitcnt lgkmcnt(7)
    v_lshlrev_b32 v84, 16, v84
    s_waitcnt lgkmcnt(6)
    v_lshlrev_b32 v85, 16, v85
    v_mul_f32 v84, v84, v8
    v_mul_f32 v85, v85, v8
    v_cvt_pk_bf16_f32 v44, v84, v85
    v_lshlrev_b32 v84, 16, v44
    v_and_b32 v85, 0xffff0000, v44
    v_cvt_pk_bf16_f32 v45, v20, v21
    v_lshlrev_b32 v46, 16, v45
    v_and_b32 v47, 0xffff0000, v45
    v_add_f32 v46, v46, v84
    v_add_f32 v47, v47, v85
    v_cvt_pk_bf16_f32 v44, v46, v47
    buffer_store_short v44, v7, s[48:51], s63 offen offset:2048
    buffer_store_short_d16_hi v44, v7, s[48:51], s63 offen offset:2176
    s_waitcnt lgkmcnt(5)
    v_lshlrev_b32 v86, 16, v86
    s_waitcnt lgkmcnt(4)
    v_lshlrev_b32 v87, 16, v87
    v_mul_f32 v86, v86, v8
    v_mul_f32 v87, v87, v8
    v_cvt_pk_bf16_f32 v44, v86, v87
    v_lshlrev_b32 v86, 16, v44
    v_and_b32 v87, 0xffff0000, v44
    v_cvt_pk_bf16_f32 v45, v22, v23
    v_lshlrev_b32 v46, 16, v45
    v_and_b32 v47, 0xffff0000, v45
    v_add_f32 v46, v46, v86
    v_add_f32 v47, v47, v87
    v_cvt_pk_bf16_f32 v44, v46, v47
    buffer_store_short v44, v7, s[48:51], s63 offen offset:2304
    buffer_store_short_d16_hi v44, v7, s[48:51], s63 offen offset:2432
    s_waitcnt lgkmcnt(3)
    v_lshlrev_b32 v88, 16, v88
    s_waitcnt lgkmcnt(2)
    v_lshlrev_b32 v89, 16, v89
    v_mul_f32 v88, v88, v8
    v_mul_f32 v89, v89, v8
    v_cvt_pk_bf16_f32 v44, v88, v89
    v_lshlrev_b32 v88, 16, v44
    v_and_b32 v89, 0xffff0000, v44
    v_cvt_pk_bf16_f32 v45, v24, v25
    v_lshlrev_b32 v46, 16, v45
    v_and_b32 v47, 0xffff0000, v45
    v_add_f32 v46, v46, v88
    v_add_f32 v47, v47, v89
    v_cvt_pk_bf16_f32 v44, v46, v47
    buffer_store_short v44, v7, s[48:51], s63 offen offset:3072
    buffer_store_short_d16_hi v44, v7, s[48:51], s63 offen offset:3200
    s_waitcnt lgkmcnt(1)
    v_lshlrev_b32 v90, 16, v90
    s_waitcnt lgkmcnt(0)
    v_lshlrev_b32 v91, 16, v91
    v_mul_f32 v90, v90, v8
    v_mul_f32 v91, v91, v8
    v_cvt_pk_bf16_f32 v44, v90, v91
    v_lshlrev_b32 v90, 16, v44
    v_and_b32 v91, 0xffff0000, v44
    v_cvt_pk_bf16_f32 v45, v26, v27
    v_lshlrev_b32 v46, 16, v45
    v_and_b32 v47, 0xffff0000, v45
    v_add_f32 v46, v46, v90
    v_add_f32 v47, v47, v91
    v_cvt_pk_bf16_f32 v44, v46, v47
    buffer_store_short v44, v7, s[48:51], s63 offen offset:3328
    buffer_store_short_d16_hi v44, v7, s[48:51], s63 offen offset:3456
    s_endpgm
L_a_exit:
    s_endpgm
.globl outp_kernel
.p2align 8
.type outp_kernel,@function
outp_kernel:
    s_cmp_ge_u32 s2, 256
    s_cbranch_scc1 L_o_exit
    s_load_dwordx2 s[4:5], s[0:1], 96
    s_load_dwordx2 s[6:7], s[0:1], 64
    s_load_dwordx2 s[8:9], s[0:1], 0
    s_load_dwordx2 s[10:11], s[0:1], 80
    v_and_b32 v1, 63, v0
    v_lshrrev_b32 v2, 6, v0
    s_nop 0
    v_readfirstlane_b32 s30, v2
    s_and_b32 s31, s2, 7
    s_lshr_b32 s37, s2, 3
    s_lshr_b32 s28, s37, 3
    s_lshl_b32 s31, s31, 2
    s_add_u32 s28, s28, s31
    s_and_b32 s29, s37, 7
    s_lshr_b32 s35, s30, 1
    s_and_b32 s36, s30, 1
    v_lshrrev_b32 v2, 3, v1
    v_and_b32 v3, 7, v1
    v_lshrrev_b32 v4, 4, v1
    v_xor_b32 v5, v3, v4
    v_lshlrev_b32 v5, 4, v5
    v_lshl_add_u32 v6, v2, 10, v5
    v_xor_b32 v7, 64, v6
    v_and_b32 v4, 1, v4
    v_lshlrev_b32 v4, 2, v4
    v_xor_b32 v5, v3, v4
    v_lshlrev_b32 v5, 4, v5
    v_lshl_add_u32 v8, v2, 10, v5
    v_and_b32 v2, 31, v1
    v_lshrrev_b32 v3, 5, v1
    v_lshrrev_b32 v4, 1, v2
    v_and_b32 v4, 7, v4
    s_lshl_b32 s31, s35, 12
    v_lshlrev_b32 v5, 7, v2
    v_add_u32 v5, s31, v5
    v_or_b32 v13, 0, v3
    v_xor_b32 v13, v13, v4
    v_lshl_add_u32 v9, v13, 4, v5
    v_or_b32 v13, 2, v3
    v_xor_b32 v13, v13, v4
    v_lshl_add_u32 v10, v13, 4, v5
    v_or_b32 v13, 4, v3
    v_xor_b32 v13, v13, v4
    v_lshl_add_u32 v11, v13, 4, v5
    v_or_b32 v13, 6, v3
    v_xor_b32 v13, v13, v4
    v_lshl_add_u32 v12, v13, 4, v5
    v_lshrrev_b32 v2, 4, v1
    v_and_b32 v3, 15, v1
    v_lshrrev_b32 v4, 2, v3
    v_and_b32 v3, 3, v3
    v_lshrrev_b32 v5, 1, v2
    v_lshl_add_u32 v5, v5, 3, v4
    v_lshlrev_b32 v5, 7, v5
    v_add_u32 v5, 8192, v5
    v_and_b32 v13, 1, v3
    v_lshl_add_u32 v5, v13, 3, v5
    v_and_b32 v2, 1, v2
    v_lshrrev_b32 v3, 1, v3
    v_lshl_add_u32 v2, v2, 1, v3
    s_lshl_b32 s31, s36, 2
    v_add_u32 v2, s31, v2
    v_lshrrev_b32 v4, 1, v4
    v_lshlrev_b32 v4, 2, v4
    v_xor_b32 v2, v2, v4
    v_lshl_add_u32 v13, v2, 4, v5
    s_waitcnt lgkmcnt(0)
    s_mov_b32 s12, s4
    s_and_b32 s13, s5, 0xffff
    s_mov_b32 s14, 13631488
    s_mov_b32 s15, 0x00020000
    s_mov_b32 s16, s6
    s_and_b32 s17, s7, 0xffff
    s_mov_b32 s18, 524288
    s_mov_b32 s19, 0x00020000
    s_mov_b32 s20, s8
    s_and_b32 s21, s9, 0xffff
    s_mov_b32 s22, 2097152
    s_mov_b32 s23, 0x00020000
    s_mov_b32 s24, s10
    s_and_b32 s25, s11, 0xffff
    s_mov_b32 s26, 2097152
    s_mov_b32 s27, 0x00020000
    s_lshl_b32 s32, s30, 11
    s_lshl_b32 s31, s28, 6
    s_lshl_b32 s37, s30, 4
    s_add_u32 s31, s31, s37
    s_lshl_b32 s33, s31, 10
    s_add_u32 s33, s33, 6291456
    s_lshl_b32 s34, s30, 14
    s_lshl_b32 s31, s29, 7
    s_add_u32 s34, s34, s31
    v_and_b32 v2, 31, v1
    v_lshrrev_b32 v3, 5, v1
    s_lshl_b32 s38, s28, 6
    s_lshl_b32 s31, s35, 5
    s_add_u32 s38, s38, s31
    v_add_u32 v14, s38, v2
    s_lshl_b32 s39, s29, 6
    s_lshl_b32 s31, s36, 5
    s_add_u32 s39, s39, s31
    v_lshlrev_b32 v4, 2, v14
    s_mov_b32 s31, 12582912
    buffer_load_dword v15, v4, s[12:15], s31 offen
    v_lshlrev_b32 v17, 10, v14
    v_lshl_add_u32 v17, v3, 3, v17
    s_lshl_b32 s31, s39, 1
    v_add_u32 v17, s31, v17
    buffer_load_dwordx2 v[20:21], v17, s[20:23], 0 offen offset:0
    buffer_load_dwordx2 v[22:23], v17, s[20:23], 0 offen offset:16
    buffer_load_dwordx2 v[24:25], v17, s[20:23], 0 offen offset:32
    buffer_load_dwordx2 v[26:27], v17, s[20:23], 0 offen offset:48
    v_lshlrev_b32 v18, 1, v14
    v_lshl_add_u32 v18, v3, 14, v18
    s_lshl_b32 s31, s39, 12
    s_add_u32 s31, s31, 10485760
    s_add_u32 s37, s31, 0
    buffer_load_ushort v28, v18, s[12:15], s37 offen
    s_add_u32 s37, s31, 4096
    buffer_load_ushort v29, v18, s[12:15], s37 offen
    s_add_u32 s37, s31, 8192
    buffer_load_ushort v30, v18, s[12:15], s37 offen
    s_add_u32 s37, s31, 12288
    buffer_load_ushort v31, v18, s[12:15], s37 offen
    s_add_u32 s37, s31, 32768
    buffer_load_ushort v32, v18, s[12:15], s37 offen
    s_add_u32 s37, s31, 36864
    buffer_load_ushort v33, v18, s[12:15], s37 offen
    s_add_u32 s37, s31, 40960
    buffer_load_ushort v34, v18, s[12:15], s37 offen
    s_add_u32 s37, s31, 45056
    buffer_load_ushort v35, v18, s[12:15], s37 offen
    s_add_u32 s37, s31, 65536
    buffer_load_ushort v36, v18, s[12:15], s37 offen
    s_add_u32 s37, s31, 69632
    buffer_load_ushort v37, v18, s[12:15], s37 offen
    s_add_u32 s37, s31, 73728
    buffer_load_ushort v38, v18, s[12:15], s37 offen
    s_add_u32 s37, s31, 77824
    buffer_load_ushort v39, v18, s[12:15], s37 offen
    s_add_u32 s37, s31, 98304
    buffer_load_ushort v40, v18, s[12:15], s37 offen
    s_add_u32 s37, s31, 102400
    buffer_load_ushort v41, v18, s[12:15], s37 offen
    s_add_u32 s37, s31, 106496
    buffer_load_ushort v42, v18, s[12:15], s37 offen
    s_add_u32 s37, s31, 110592
    buffer_load_ushort v43, v18, s[12:15], s37 offen
    s_add_u32 m0, s32, 0
    s_add_u32 s31, s33, 0
    buffer_load_dwordx4 v6, s[12:15], s31 offen lds
    s_add_u32 m0, s32, 1024
    s_add_u32 s31, s33, 8192
    buffer_load_dwordx4 v7, s[12:15], s31 offen lds
    s_add_u32 m0, s32, 8192
    s_add_u32 s31, s34, 0
    buffer_load_dwordx4 v8, s[16:19], s31 offen lds
    s_add_u32 m0, s32, 9216
    s_add_u32 s31, s34, 8192
    buffer_load_dwordx4 v8, s[16:19], s31 offen lds
    s_add_u32 m0, s32, 16384
    s_add_u32 s31, s33, 128
    buffer_load_dwordx4 v6, s[12:15], s31 offen lds
    s_add_u32 m0, s32, 17408
    s_add_u32 s31, s33, 8320
    buffer_load_dwordx4 v7, s[12:15], s31 offen lds
    s_add_u32 m0, s32, 24576
    s_add_u32 s31, s34, 65536
    buffer_load_dwordx4 v8, s[16:19], s31 offen lds
    s_add_u32 m0, s32, 25600
    s_add_u32 s31, s34, 73728
    buffer_load_dwordx4 v8, s[16:19], s31 offen lds
    s_add_u32 m0, s32, 32768
    s_add_u32 s31, s33, 256
    buffer_load_dwordx4 v6, s[12:15], s31 offen lds
    s_add_u32 m0, s32, 33792
    s_add_u32 s31, s33, 8448
    buffer_load_dwordx4 v7, s[12:15], s31 offen lds
    s_add_u32 m0, s32, 40960
    s_add_u32 s31, s34, 131072
    buffer_load_dwordx4 v8, s[16:19], s31 offen lds
    s_add_u32 m0, s32, 41984
    s_add_u32 s31, s34, 139264
    buffer_load_dwordx4 v8, s[16:19], s31 offen lds
    s_add_u32 m0, s32, 49152
    s_add_u32 s31, s33, 384
    buffer_load_dwordx4 v6, s[12:15], s31 offen lds
    s_add_u32 m0, s32, 50176
    s_add_u32 s31, s33, 8576
    buffer_load_dwordx4 v7, s[12:15], s31 offen lds
    s_add_u32 m0, s32, 57344
    s_add_u32 s31, s34, 196608
    buffer_load_dwordx4 v8, s[16:19], s31 offen lds
    s_add_u32 m0, s32, 58368
    s_add_u32 s31, s34, 204800
    buffer_load_dwordx4 v8, s[16:19], s31 offen lds
    s_add_u32 m0, s32, 65536
    s_add_u32 s31, s33, 512
    buffer_load_dwordx4 v6, s[12:15], s31 offen lds
    s_add_u32 m0, s32, 66560
    s_add_u32 s31, s33, 8704
    buffer_load_dwordx4 v7, s[12:15], s31 offen lds
    s_add_u32 m0, s32, 73728
    s_add_u32 s31, s34, 262144
    buffer_load_dwordx4 v8, s[16:19], s31 offen lds
    s_add_u32 m0, s32, 74752
    s_add_u32 s31, s34, 270336
    buffer_load_dwordx4 v8, s[16:19], s31 offen lds
    s_add_u32 m0, s32, 81920
    s_add_u32 s31, s33, 640
    buffer_load_dwordx4 v6, s[12:15], s31 offen lds
    s_add_u32 m0, s32, 82944
    s_add_u32 s31, s33, 8832
    buffer_load_dwordx4 v7, s[12:15], s31 offen lds
    s_add_u32 m0, s32, 90112
    s_add_u32 s31, s34, 327680
    buffer_load_dwordx4 v8, s[16:19], s31 offen lds
    s_add_u32 m0, s32, 91136
    s_add_u32 s31, s34, 335872
    buffer_load_dwordx4 v8, s[16:19], s31 offen lds
    s_add_u32 m0, s32, 98304
    s_add_u32 s31, s33, 768
    buffer_load_dwordx4 v6, s[12:15], s31 offen lds
    s_add_u32 m0, s32, 99328
    s_add_u32 s31, s33, 8960
    buffer_load_dwordx4 v7, s[12:15], s31 offen lds
    s_add_u32 m0, s32, 106496
    s_add_u32 s31, s34, 393216
    buffer_load_dwordx4 v8, s[16:19], s31 offen lds
    s_add_u32 m0, s32, 107520
    s_add_u32 s31, s34, 401408
    buffer_load_dwordx4 v8, s[16:19], s31 offen lds
    s_add_u32 m0, s32, 114688
    s_add_u32 s31, s33, 896
    buffer_load_dwordx4 v6, s[12:15], s31 offen lds
    s_add_u32 m0, s32, 115712
    s_add_u32 s31, s33, 9088
    buffer_load_dwordx4 v7, s[12:15], s31 offen lds
    s_add_u32 m0, s32, 122880
    s_add_u32 s31, s34, 458752
    buffer_load_dwordx4 v8, s[16:19], s31 offen lds
    s_add_u32 m0, s32, 123904
    s_add_u32 s31, s34, 466944
    buffer_load_dwordx4 v8, s[16:19], s31 offen lds
    s_waitcnt vmcnt(28)
    s_barrier
    ds_read_b128 v[60:63], v9 offset:0
    ds_read_b64_tr_b16 v[68:69], v13 offset:0
    ds_read_b64_tr_b16 v[70:71], v13 offset:512
    ds_read_b128 v[64:67], v10 offset:0
    ds_read_b64_tr_b16 v[72:73], v13 offset:2048
    ds_read_b64_tr_b16 v[74:75], v13 offset:2560
    s_waitcnt lgkmcnt(3)
    v_mfma_f32_32x32x16_bf16 v[44:59], v[68:71], v[60:63], 0
    ds_read_b128 v[60:63], v11 offset:0
    ds_read_b64_tr_b16 v[68:69], v13 offset:4096
    ds_read_b64_tr_b16 v[70:71], v13 offset:4608
    s_waitcnt lgkmcnt(3)
    v_mfma_f32_32x32x16_bf16 v[44:59], v[72:75], v[64:67], v[44:59]
    ds_read_b128 v[64:67], v12 offset:0
    ds_read_b64_tr_b16 v[72:73], v13 offset:6144
    ds_read_b64_tr_b16 v[74:75], v13 offset:6656
    s_waitcnt lgkmcnt(3)
    v_mfma_f32_32x32x16_bf16 v[44:59], v[68:71], v[60:63], v[44:59]
    s_waitcnt vmcnt(24)
    s_barrier
    ds_read_b128 v[60:63], v9 offset:16384
    ds_read_b64_tr_b16 v[68:69], v13 offset:16384
    ds_read_b64_tr_b16 v[70:71], v13 offset:16896
    s_waitcnt lgkmcnt(3)
    v_mfma_f32_32x32x16_bf16 v[44:59], v[72:75], v[64:67], v[44:59]
    ds_read_b128 v[64:67], v10 offset:16384
    ds_read_b64_tr_b16 v[72:73], v13 offset:18432
    ds_read_b64_tr_b16 v[74:75], v13 offset:18944
    s_waitcnt lgkmcnt(3)
    v_mfma_f32_32x32x16_bf16 v[44:59], v[68:71], v[60:63], v[44:59]
    ds_read_b128 v[60:63], v11 offset:16384
    ds_read_b64_tr_b16 v[68:69], v13 offset:20480
    ds_read_b64_tr_b16 v[70:71], v13 offset:20992
    s_waitcnt lgkmcnt(3)
    v_mfma_f32_32x32x16_bf16 v[44:59], v[72:75], v[64:67], v[44:59]
    ds_read_b128 v[64:67], v12 offset:16384
    ds_read_b64_tr_b16 v[72:73], v13 offset:22528
    ds_read_b64_tr_b16 v[74:75], v13 offset:23040
    s_waitcnt lgkmcnt(3)
    v_mfma_f32_32x32x16_bf16 v[44:59], v[68:71], v[60:63], v[44:59]
    s_waitcnt vmcnt(20)
    s_barrier
    ds_read_b128 v[60:63], v9 offset:32768
    ds_read_b64_tr_b16 v[68:69], v13 offset:32768
    ds_read_b64_tr_b16 v[70:71], v13 offset:33280
    s_waitcnt lgkmcnt(3)
    v_mfma_f32_32x32x16_bf16 v[44:59], v[72:75], v[64:67], v[44:59]
    ds_read_b128 v[64:67], v10 offset:32768
    ds_read_b64_tr_b16 v[72:73], v13 offset:34816
    ds_read_b64_tr_b16 v[74:75], v13 offset:35328
    s_waitcnt lgkmcnt(3)
    v_mfma_f32_32x32x16_bf16 v[44:59], v[68:71], v[60:63], v[44:59]
    ds_read_b128 v[60:63], v11 offset:32768
    ds_read_b64_tr_b16 v[68:69], v13 offset:36864
    ds_read_b64_tr_b16 v[70:71], v13 offset:37376
    s_waitcnt lgkmcnt(3)
    v_mfma_f32_32x32x16_bf16 v[44:59], v[72:75], v[64:67], v[44:59]
    ds_read_b128 v[64:67], v12 offset:32768
    ds_read_b64_tr_b16 v[72:73], v13 offset:38912
    ds_read_b64_tr_b16 v[74:75], v13 offset:39424
    s_waitcnt lgkmcnt(3)
    v_mfma_f32_32x32x16_bf16 v[44:59], v[68:71], v[60:63], v[44:59]
    s_waitcnt vmcnt(16)
    s_barrier
    ds_read_b128 v[60:63], v9 offset:49152
    ds_read_b64_tr_b16 v[68:69], v13 offset:49152
    ds_read_b64_tr_b16 v[70:71], v13 offset:49664
    s_waitcnt lgkmcnt(3)
    v_mfma_f32_32x32x16_bf16 v[44:59], v[72:75], v[64:67], v[44:59]
    ds_read_b128 v[64:67], v10 offset:49152
    ds_read_b64_tr_b16 v[72:73], v13 offset:51200
    ds_read_b64_tr_b16 v[74:75], v13 offset:51712
    s_waitcnt lgkmcnt(3)
    v_mfma_f32_32x32x16_bf16 v[44:59], v[68:71], v[60:63], v[44:59]
    ds_read_b128 v[60:63], v11 offset:49152
    ds_read_b64_tr_b16 v[68:69], v13 offset:53248
    ds_read_b64_tr_b16 v[70:71], v13 offset:53760
    s_waitcnt lgkmcnt(3)
    v_mfma_f32_32x32x16_bf16 v[44:59], v[72:75], v[64:67], v[44:59]
    ds_read_b128 v[64:67], v12 offset:49152
    ds_read_b64_tr_b16 v[72:73], v13 offset:55296
    ds_read_b64_tr_b16 v[74:75], v13 offset:55808
    s_waitcnt lgkmcnt(3)
    v_mfma_f32_32x32x16_bf16 v[44:59], v[68:71], v[60:63], v[44:59]
    s_waitcnt vmcnt(12)
    s_barrier
    v_add_u32 v9, 0x10000, v9
    v_add_u32 v10, 0x10000, v10
    v_add_u32 v11, 0x10000, v11
    v_add_u32 v12, 0x10000, v12
    v_add_u32 v13, 0x10000, v13
    ds_read_b128 v[60:63], v9 offset:0
    ds_read_b64_tr_b16 v[68:69], v13 offset:0
    ds_read_b64_tr_b16 v[70:71], v13 offset:512
    s_waitcnt lgkmcnt(3)
    v_mfma_f32_32x32x16_bf16 v[44:59], v[72:75], v[64:67], v[44:59]
    ds_read_b128 v[64:67], v10 offset:0
    ds_read_b64_tr_b16 v[72:73], v13 offset:2048
    ds_read_b64_tr_b16 v[74:75], v13 offset:2560
    s_waitcnt lgkmcnt(3)
    v_mfma_f32_32x32x16_bf16 v[44:59], v[68:71], v[60:63], v[44:59]
    ds_read_b128 v[60:63], v11 offset:0
    ds_read_b64_tr_b16 v[68:69], v13 offset:4096
    ds_read_b64_tr_b16 v[70:71], v13 offset:4608
    s_waitcnt lgkmcnt(3)
    v_mfma_f32_32x32x16_bf16 v[44:59], v[72:75], v[64:67], v[44:59]
    ds_read_b128 v[64:67], v12 offset:0
    ds_read_b64_tr_b16 v[72:73], v13 offset:6144
    ds_read_b64_tr_b16 v[74:75], v13 offset:6656
    s_waitcnt lgkmcnt(3)
    v_mfma_f32_32x32x16_bf16 v[44:59], v[68:71], v[60:63], v[44:59]
    s_waitcnt vmcnt(8)
    s_barrier
    ds_read_b128 v[60:63], v9 offset:16384
    ds_read_b64_tr_b16 v[68:69], v13 offset:16384
    ds_read_b64_tr_b16 v[70:71], v13 offset:16896
    s_waitcnt lgkmcnt(3)
    v_mfma_f32_32x32x16_bf16 v[44:59], v[72:75], v[64:67], v[44:59]
    ds_read_b128 v[64:67], v10 offset:16384
    ds_read_b64_tr_b16 v[72:73], v13 offset:18432
    ds_read_b64_tr_b16 v[74:75], v13 offset:18944
    s_waitcnt lgkmcnt(3)
    v_mfma_f32_32x32x16_bf16 v[44:59], v[68:71], v[60:63], v[44:59]
    ds_read_b128 v[60:63], v11 offset:16384
    ds_read_b64_tr_b16 v[68:69], v13 offset:20480
    ds_read_b64_tr_b16 v[70:71], v13 offset:20992
    s_waitcnt lgkmcnt(3)
    v_mfma_f32_32x32x16_bf16 v[44:59], v[72:75], v[64:67], v[44:59]
    ds_read_b128 v[64:67], v12 offset:16384
    ds_read_b64_tr_b16 v[72:73], v13 offset:22528
    ds_read_b64_tr_b16 v[74:75], v13 offset:23040
    s_waitcnt lgkmcnt(3)
    v_mfma_f32_32x32x16_bf16 v[44:59], v[68:71], v[60:63], v[44:59]
    s_waitcnt vmcnt(4)
    s_barrier
    ds_read_b128 v[60:63], v9 offset:32768
    ds_read_b64_tr_b16 v[68:69], v13 offset:32768
    ds_read_b64_tr_b16 v[70:71], v13 offset:33280
    s_waitcnt lgkmcnt(3)
    v_mfma_f32_32x32x16_bf16 v[44:59], v[72:75], v[64:67], v[44:59]
    ds_read_b128 v[64:67], v10 offset:32768
    ds_read_b64_tr_b16 v[72:73], v13 offset:34816
    ds_read_b64_tr_b16 v[74:75], v13 offset:35328
    s_waitcnt lgkmcnt(3)
    v_mfma_f32_32x32x16_bf16 v[44:59], v[68:71], v[60:63], v[44:59]
    ds_read_b128 v[60:63], v11 offset:32768
    ds_read_b64_tr_b16 v[68:69], v13 offset:36864
    ds_read_b64_tr_b16 v[70:71], v13 offset:37376
    s_waitcnt lgkmcnt(3)
    v_mfma_f32_32x32x16_bf16 v[44:59], v[72:75], v[64:67], v[44:59]
    ds_read_b128 v[64:67], v12 offset:32768
    ds_read_b64_tr_b16 v[72:73], v13 offset:38912
    ds_read_b64_tr_b16 v[74:75], v13 offset:39424
    s_waitcnt lgkmcnt(3)
    v_mfma_f32_32x32x16_bf16 v[44:59], v[68:71], v[60:63], v[44:59]
    s_waitcnt vmcnt(0)
    s_barrier
    ds_read_b128 v[60:63], v9 offset:49152
    ds_read_b64_tr_b16 v[68:69], v13 offset:49152
    ds_read_b64_tr_b16 v[70:71], v13 offset:49664
    s_waitcnt lgkmcnt(3)
    v_mfma_f32_32x32x16_bf16 v[44:59], v[72:75], v[64:67], v[44:59]
    ds_read_b128 v[64:67], v10 offset:49152
    ds_read_b64_tr_b16 v[72:73], v13 offset:51200
    ds_read_b64_tr_b16 v[74:75], v13 offset:51712
    s_waitcnt lgkmcnt(3)
    v_mfma_f32_32x32x16_bf16 v[44:59], v[68:71], v[60:63], v[44:59]
    ds_read_b128 v[60:63], v11 offset:49152
    ds_read_b64_tr_b16 v[68:69], v13 offset:53248
    ds_read_b64_tr_b16 v[70:71], v13 offset:53760
    s_waitcnt lgkmcnt(3)
    v_mfma_f32_32x32x16_bf16 v[44:59], v[72:75], v[64:67], v[44:59]
    ds_read_b128 v[64:67], v12 offset:49152
    ds_read_b64_tr_b16 v[72:73], v13 offset:55296
    ds_read_b64_tr_b16 v[74:75], v13 offset:55808
    s_waitcnt lgkmcnt(3)
    v_mfma_f32_32x32x16_bf16 v[44:59], v[68:71], v[60:63], v[44:59]
    s_waitcnt lgkmcnt(0)
    v_mfma_f32_32x32x16_bf16 v[44:59], v[72:75], v[64:67], v[44:59]
    v_sub_f32 v16, 1.0, v15
    v_cvt_pk_bf16_f32 v16, v16, v16
    v_lshlrev_b32 v16, 16, v16
    v_lshlrev_b32 v76, 16, v20
    v_and_b32 v77, 0xffff0000, v20
    v_lshlrev_b32 v78, 16, v28
    v_lshlrev_b32 v79, 16, v29
    v_mul_f32 v76, v76, v78
    v_mul_f32 v77, v77, v79
    v_cvt_pk_bf16_f32 v80, v76, v77
    v_lshlrev_b32 v76, 16, v80
    v_and_b32 v77, 0xffff0000, v80
    v_mul_f32 v76, v15, v76
    v_mul_f32 v77, v15, v77
    v_cvt_pk_bf16_f32 v80, v76, v77
    v_lshlrev_b32 v76, 16, v80
    v_and_b32 v77, 0xffff0000, v80
    v_cvt_pk_bf16_f32 v81, v44, v45
    v_lshlrev_b32 v78, 16, v81
    v_and_b32 v79, 0xffff0000, v81
    v_mul_f32 v78, v16, v78
    v_mul_f32 v79, v16, v79
    v_cvt_pk_bf16_f32 v81, v78, v79
    v_lshlrev_b32 v78, 16, v81
    v_and_b32 v79, 0xffff0000, v81
    v_add_f32 v76, v76, v78
    v_add_f32 v77, v77, v79
    v_cvt_pk_bf16_f32 v84, v76, v77
    v_lshlrev_b32 v76, 16, v21
    v_and_b32 v77, 0xffff0000, v21
    v_lshlrev_b32 v78, 16, v30
    v_lshlrev_b32 v79, 16, v31
    v_mul_f32 v76, v76, v78
    v_mul_f32 v77, v77, v79
    v_cvt_pk_bf16_f32 v80, v76, v77
    v_lshlrev_b32 v76, 16, v80
    v_and_b32 v77, 0xffff0000, v80
    v_mul_f32 v76, v15, v76
    v_mul_f32 v77, v15, v77
    v_cvt_pk_bf16_f32 v80, v76, v77
    v_lshlrev_b32 v76, 16, v80
    v_and_b32 v77, 0xffff0000, v80
    v_cvt_pk_bf16_f32 v81, v46, v47
    v_lshlrev_b32 v78, 16, v81
    v_and_b32 v79, 0xffff0000, v81
    v_mul_f32 v78, v16, v78
    v_mul_f32 v79, v16, v79
    v_cvt_pk_bf16_f32 v81, v78, v79
    v_lshlrev_b32 v78, 16, v81
    v_and_b32 v79, 0xffff0000, v81
    v_add_f32 v76, v76, v78
    v_add_f32 v77, v77, v79
    v_cvt_pk_bf16_f32 v85, v76, v77
    buffer_store_dwordx2 v[84:85], v17, s[24:27], 0 offen offset:0
    v_lshlrev_b32 v76, 16, v22
    v_and_b32 v77, 0xffff0000, v22
    v_lshlrev_b32 v78, 16, v32
    v_lshlrev_b32 v79, 16, v33
    v_mul_f32 v76, v76, v78
    v_mul_f32 v77, v77, v79
    v_cvt_pk_bf16_f32 v80, v76, v77
    v_lshlrev_b32 v76, 16, v80
    v_and_b32 v77, 0xffff0000, v80
    v_mul_f32 v76, v15, v76
    v_mul_f32 v77, v15, v77
    v_cvt_pk_bf16_f32 v80, v76, v77
    v_lshlrev_b32 v76, 16, v80
    v_and_b32 v77, 0xffff0000, v80
    v_cvt_pk_bf16_f32 v81, v48, v49
    v_lshlrev_b32 v78, 16, v81
    v_and_b32 v79, 0xffff0000, v81
    v_mul_f32 v78, v16, v78
    v_mul_f32 v79, v16, v79
    v_cvt_pk_bf16_f32 v81, v78, v79
    v_lshlrev_b32 v78, 16, v81
    v_and_b32 v79, 0xffff0000, v81
    v_add_f32 v76, v76, v78
    v_add_f32 v77, v77, v79
    v_cvt_pk_bf16_f32 v84, v76, v77
    v_lshlrev_b32 v76, 16, v23
    v_and_b32 v77, 0xffff0000, v23
    v_lshlrev_b32 v78, 16, v34
    v_lshlrev_b32 v79, 16, v35
    v_mul_f32 v76, v76, v78
    v_mul_f32 v77, v77, v79
    v_cvt_pk_bf16_f32 v80, v76, v77
    v_lshlrev_b32 v76, 16, v80
    v_and_b32 v77, 0xffff0000, v80
    v_mul_f32 v76, v15, v76
    v_mul_f32 v77, v15, v77
    v_cvt_pk_bf16_f32 v80, v76, v77
    v_lshlrev_b32 v76, 16, v80
    v_and_b32 v77, 0xffff0000, v80
    v_cvt_pk_bf16_f32 v81, v50, v51
    v_lshlrev_b32 v78, 16, v81
    v_and_b32 v79, 0xffff0000, v81
    v_mul_f32 v78, v16, v78
    v_mul_f32 v79, v16, v79
    v_cvt_pk_bf16_f32 v81, v78, v79
    v_lshlrev_b32 v78, 16, v81
    v_and_b32 v79, 0xffff0000, v81
    v_add_f32 v76, v76, v78
    v_add_f32 v77, v77, v79
    v_cvt_pk_bf16_f32 v85, v76, v77
    buffer_store_dwordx2 v[84:85], v17, s[24:27], 0 offen offset:16
    v_lshlrev_b32 v76, 16, v24
    v_and_b32 v77, 0xffff0000, v24
    v_lshlrev_b32 v78, 16, v36
    v_lshlrev_b32 v79, 16, v37
    v_mul_f32 v76, v76, v78
    v_mul_f32 v77, v77, v79
    v_cvt_pk_bf16_f32 v80, v76, v77
    v_lshlrev_b32 v76, 16, v80
    v_and_b32 v77, 0xffff0000, v80
    v_mul_f32 v76, v15, v76
    v_mul_f32 v77, v15, v77
    v_cvt_pk_bf16_f32 v80, v76, v77
    v_lshlrev_b32 v76, 16, v80
    v_and_b32 v77, 0xffff0000, v80
    v_cvt_pk_bf16_f32 v81, v52, v53
    v_lshlrev_b32 v78, 16, v81
    v_and_b32 v79, 0xffff0000, v81
    v_mul_f32 v78, v16, v78
    v_mul_f32 v79, v16, v79
    v_cvt_pk_bf16_f32 v81, v78, v79
    v_lshlrev_b32 v78, 16, v81
    v_and_b32 v79, 0xffff0000, v81
    v_add_f32 v76, v76, v78
    v_add_f32 v77, v77, v79
    v_cvt_pk_bf16_f32 v84, v76, v77
    v_lshlrev_b32 v76, 16, v25
    v_and_b32 v77, 0xffff0000, v25
    v_lshlrev_b32 v78, 16, v38
    v_lshlrev_b32 v79, 16, v39
    v_mul_f32 v76, v76, v78
    v_mul_f32 v77, v77, v79
    v_cvt_pk_bf16_f32 v80, v76, v77
    v_lshlrev_b32 v76, 16, v80
    v_and_b32 v77, 0xffff0000, v80
    v_mul_f32 v76, v15, v76
    v_mul_f32 v77, v15, v77
    v_cvt_pk_bf16_f32 v80, v76, v77
    v_lshlrev_b32 v76, 16, v80
    v_and_b32 v77, 0xffff0000, v80
    v_cvt_pk_bf16_f32 v81, v54, v55
    v_lshlrev_b32 v78, 16, v81
    v_and_b32 v79, 0xffff0000, v81
    v_mul_f32 v78, v16, v78
    v_mul_f32 v79, v16, v79
    v_cvt_pk_bf16_f32 v81, v78, v79
    v_lshlrev_b32 v78, 16, v81
    v_and_b32 v79, 0xffff0000, v81
    v_add_f32 v76, v76, v78
    v_add_f32 v77, v77, v79
    v_cvt_pk_bf16_f32 v85, v76, v77
    buffer_store_dwordx2 v[84:85], v17, s[24:27], 0 offen offset:32
    v_lshlrev_b32 v76, 16, v26
    v_and_b32 v77, 0xffff0000, v26
    v_lshlrev_b32 v78, 16, v40
    v_lshlrev_b32 v79, 16, v41
    v_mul_f32 v76, v76, v78
    v_mul_f32 v77, v77, v79
    v_cvt_pk_bf16_f32 v80, v76, v77
    v_lshlrev_b32 v76, 16, v80
    v_and_b32 v77, 0xffff0000, v80
    v_mul_f32 v76, v15, v76
    v_mul_f32 v77, v15, v77
    v_cvt_pk_bf16_f32 v80, v76, v77
    v_lshlrev_b32 v76, 16, v80
    v_and_b32 v77, 0xffff0000, v80
    v_cvt_pk_bf16_f32 v81, v56, v57
    v_lshlrev_b32 v78, 16, v81
    v_and_b32 v79, 0xffff0000, v81
    v_mul_f32 v78, v16, v78
    v_mul_f32 v79, v16, v79
    v_cvt_pk_bf16_f32 v81, v78, v79
    v_lshlrev_b32 v78, 16, v81
    v_and_b32 v79, 0xffff0000, v81
    v_add_f32 v76, v76, v78
    v_add_f32 v77, v77, v79
    v_cvt_pk_bf16_f32 v84, v76, v77
    v_lshlrev_b32 v76, 16, v27
    v_and_b32 v77, 0xffff0000, v27
    v_lshlrev_b32 v78, 16, v42
    v_lshlrev_b32 v79, 16, v43
    v_mul_f32 v76, v76, v78
    v_mul_f32 v77, v77, v79
    v_cvt_pk_bf16_f32 v80, v76, v77
    v_lshlrev_b32 v76, 16, v80
    v_and_b32 v77, 0xffff0000, v80
    v_mul_f32 v76, v15, v76
    v_mul_f32 v77, v15, v77
    v_cvt_pk_bf16_f32 v80, v76, v77
    v_lshlrev_b32 v76, 16, v80
    v_and_b32 v77, 0xffff0000, v80
    v_cvt_pk_bf16_f32 v81, v58, v59
    v_lshlrev_b32 v78, 16, v81
    v_and_b32 v79, 0xffff0000, v81
    v_mul_f32 v78, v16, v78
    v_mul_f32 v79, v16, v79
    v_cvt_pk_bf16_f32 v81, v78, v79
    v_lshlrev_b32 v78, 16, v81
    v_and_b32 v79, 0xffff0000, v81
    v_add_f32 v76, v76, v78
    v_add_f32 v77, v77, v79
    v_cvt_pk_bf16_f32 v85, v76, v77
    buffer_store_dwordx2 v[84:85], v17, s[24:27], 0 offen offset:48
L_o_exit:
    s_endpgm
.section .rodata,"a"
.p2align 6
.amdhsa_kernel proj_kernel
  .amdhsa_next_free_vgpr 192
  .amdhsa_next_free_sgpr 96
  .amdhsa_accum_offset 192
  .amdhsa_group_segment_fixed_size 0
  .amdhsa_kernarg_size 104
  .amdhsa_user_sgpr_count 2
  .amdhsa_user_sgpr_kernarg_segment_ptr 1
  .amdhsa_system_sgpr_workgroup_id_x 1
.end_amdhsa_kernel
.p2align 6
.amdhsa_kernel attn_kernel
  .amdhsa_next_free_vgpr 128
  .amdhsa_next_free_sgpr 96
  .amdhsa_accum_offset 128
  .amdhsa_group_segment_fixed_size 0
  .amdhsa_kernarg_size 104
  .amdhsa_user_sgpr_count 2
  .amdhsa_user_sgpr_kernarg_segment_ptr 1
  .amdhsa_system_sgpr_workgroup_id_x 1
.end_amdhsa_kernel
.p2align 6
.amdhsa_kernel outp_kernel
  .amdhsa_next_free_vgpr 88
  .amdhsa_next_free_sgpr 96
  .amdhsa_accum_offset 88
  .amdhsa_group_segment_fixed_size 0
  .amdhsa_kernarg_size 104
  .amdhsa_user_sgpr_count 2
  .amdhsa_user_sgpr_kernarg_segment_ptr 1
  .amdhsa_system_sgpr_workgroup_id_x 1
.end_amdhsa_kernel
```
